```python
import torch

def _softmax(x, axis=-1):
    return torch.softmax(x, dim=axis)

def _gelu(x):
    return torch.nn.functional.gelu(x, approximate='tanh')

def _silu(x):
    return torch.nn.functional.silu(x)

def _sigmoid(x):
    return torch.sigmoid(x)

def _layernorm(x, axis=-1, eps=1e-05):
    m = x.mean(dim=axis, keepdim=True)
    v = x.var(dim=axis, keepdim=True, unbiased=False)
    return (x - m) / torch.sqrt(v + eps)

def _scatter_add(tgt, idx, src, axis=0):
    return tgt.clone().index_add_(axis, idx, src)

def _segment_sum(src, seg, n):
    out = torch.zeros((n,) + src.shape[1:], dtype=src.dtype)
    return out.index_add_(0, seg, src)

def _pad(x, pw):
    flat = tuple((v for pair in reversed(pw) for v in pair))
    return torch.nn.functional.pad(x, flat)
kernel_name = 'concat_heads__ssm_conv_s4__memory_aug_recurrent_mem_tr__prompt'

def setup_inputs():

    _w = lambda a: (lambda t: t.to(torch.bfloat16) if t.is_floating_point() else t)(torch.as_tensor(a))

    def _A_setup():
        B, L, D, N = (1, 2048, 640, 128)
        A_re = -(lambda _x: torch.exp(torch.as_tensor(_x)))((lambda *s: torch.randn(*s, dtype=torch.bfloat16) * 6.4)(D, N))
        A_im = torch.pi * (lambda *s: torch.randn(*s, dtype=torch.bfloat16) * 0.05)(D, N)
        B_re = (lambda *s: torch.randn(*s, dtype=torch.bfloat16) * 0.1)(D, N)
        B_im = (lambda *s: torch.randn(*s, dtype=torch.bfloat16) * 0.1)(D, N)
        C_re = (lambda *s: torch.randn(*s, dtype=torch.bfloat16) * 0.1)(D, N)
        C_im = (lambda *s: torch.randn(*s, dtype=torch.bfloat16) * 0.1)(D, N)
        log_dt = (lambda *s: torch.randn(*s, dtype=torch.bfloat16) * 0.05)(D) * 0.5 - 4.0
        Dskip = (lambda *s: torch.randn(*s, dtype=torch.bfloat16) * 0.05)(D)
        return {'u': _w((lambda *s: torch.randn(*s, dtype=torch.bfloat16) * 0.05)(B, L, D)), 'A_re': _w(A_re), 'A_im': _w(A_im), 'B_re': _w(B_re), 'B_im': _w(B_im), 'C_re': _w(C_re), 'C_im': _w(C_im), 'log_dt': _w(log_dt), 'Dskip': _w(Dskip)}
    _A_in = _A_setup()

    def _B_setup():
        B, S, Dm = (1, 2048, 640)
        H, Dh = (32, 128)
        M, seg = (8, 32)
        seg = min(seg, S)
        S = S // seg * seg
        return {'x': _w((lambda *s: torch.randn(*s, dtype=torch.bfloat16) * 0.05)(B, S, Dm)), 'mem0': _w((lambda *s: torch.randn(*s, dtype=torch.bfloat16) * 0.4)(B, M, Dm)), 'Wq': _w((lambda *s: torch.randn(*s, dtype=torch.bfloat16) * 6.4)(Dm, H, Dh) * Dm ** (-0.5)), 'Wk': _w((lambda *s: torch.randn(*s, dtype=torch.bfloat16) * 6.4)(Dm, H, Dh) * Dm ** (-0.5)), 'Wv': _w((lambda *s: torch.randn(*s, dtype=torch.bfloat16) * 0.4)(Dm, H, Dh) * Dm ** (-0.5)), 'Wo': _w((lambda *s: torch.randn(*s, dtype=torch.bfloat16) * 0.4)(H, Dh, Dm) * (H * Dh) ** (-0.5)), 'seg_len': seg}
    _B_in = _B_setup()
    return {'A_u': _A_in['u'], 'A_A_re': _A_in['A_re'], 'A_A_im': _A_in['A_im'], 'A_B_re': _A_in['B_re'], 'A_B_im': _A_in['B_im'], 'A_C_re': _A_in['C_re'], 'A_C_im': _A_in['C_im'], 'A_log_dt': _A_in['log_dt'], 'A_Dskip': _A_in['Dskip'], 'B_x': _B_in['x'], 'B_mem0': _B_in['mem0'], 'B_Wq': _B_in['Wq'], 'B_Wk': _B_in['Wk'], 'B_Wv': _B_in['Wv'], 'B_Wo': _B_in['Wo'], 'B_seg_len': _B_in['seg_len']}

def reference(A_u, A_A_re, A_A_im, A_B_re, A_B_im, A_C_re, A_C_im, A_log_dt, A_Dskip, B_x, B_mem0, B_Wq, B_Wk, B_Wv, B_Wo, B_seg_len):

    def _A_ref(u, A_re, A_im, B_re, B_im, C_re, C_im, log_dt, Dskip):
        Bsz, L, D = u.shape
        dt = torch.exp(log_dt)[:, None]
        A = A_re + 1j * A_im
        Bc = B_re + 1j * B_im
        Cc = C_re + 1j * C_im
        logdA = dt * A
        dB = dt * Bc
        l = (lambda x, dt: x.to(dt))(torch.arange(L), A_re.dtype)
        P = torch.exp(logdA[:, :, None] * l[None, None, :])
        K = torch.einsum('dn,dnl,dn->dl', Cc, P, dB).real
        L2 = 2 * L
        Kp = _pad(K, ((0, 0), (0, L)))
        up = (lambda x, *d: x.permute(*d))(u, 0, 2, 1)
        up = _pad(up, ((0, 0), (0, 0), (0, L)))
        Kf = (lambda x, axes=(-2, -1): torch.fft.rfft2(x.float(), dim=axes))(Kp[:, None, :], axes=(-2, -1))
        Uf = (lambda x, axes=(-2, -1): torch.fft.rfft2(x.float(), dim=axes))(up[:, :, None, :], axes=(-2, -1))
        Yf = Uf * Kf[None, :, :, :]
        y = (lambda x, s, axes=(-2, -1): torch.fft.irfft2(x, s=s, dim=axes).to(torch.bfloat16))(Yf, (1, L2), axes=(-2, -1))[:, :, 0, :L]
        y = (lambda x, *d: x.permute(*d))(y, 0, 2, 1) + u * Dskip[None, None, :]
        return y

    def _B_ref(x, mem0, Wq, Wk, Wv, Wo, seg_len):
        B, S, Dm = x.shape
        H, Dh = (Wq.shape[1], Wq.shape[2])
        M = mem0.shape[1]
        scale = Dh ** (-0.5)
        n_seg = S // seg_len
        L = M + seg_len
        idx = torch.arange(L)
        mask = (idx[:, None] < M) | (idx[:, None] >= idx[None, :])
        mem = mem0
        outs = []
        for s in range(n_seg):
            xs = x[:, s * seg_len:(s + 1) * seg_len, :].clone()
            h = torch.concatenate([mem, xs], axis=1)
            q = torch.einsum('btd,dhe->bhte', h, Wq)
            k = torch.einsum('btd,dhe->bhte', h, Wk)
            v = torch.einsum('btd,dhe->bhte', h, Wv)
            scores = torch.einsum('bhqe,bhke->bhqk', q, k) * scale
            scores = torch.where(mask[None, None], scores, -1000000000.0)
            p = _softmax(scores, axis=-1)
            o = torch.einsum('bhqk,bhke->bhqe', p, v)
            o = torch.einsum('bhte,hed->btd', o, Wo)
            mem = o[:, :M, :].clone()
            outs.append(o[:, M:, :])
        return torch.concatenate(outs, axis=1)
    a = _A_ref(A_u, A_A_re, A_A_im, A_B_re, A_B_im, A_C_re, A_C_im, A_log_dt, A_Dskip)
    b = _B_ref(B_x, B_mem0, B_Wq, B_Wk, B_Wv, B_Wo, B_seg_len)
    return torch.concatenate([a, b], axis=-1)
```

```asm
; @launch grid=(256,1,1) block=(256,1,1) lds=143360
.amdgcn_target "amdgcn-amd-amdhsa--gfx950"
.text
.globl concat_heads__ssm_conv_s4__memory_aug_recurrent_mem_tr__prompt_kernel
.p2align 8
.type concat_heads__ssm_conv_s4__memory_aug_recurrent_mem_tr__prompt_kernel,@function
concat_heads__ssm_conv_s4__memory_aug_recurrent_mem_tr__prompt_kernel:
    s_cmp_ge_u32 s2, 256
    s_cbranch_scc1 CH_end
    s_load_dwordx2 s[46:47], s[0:1], 144
    s_load_dwordx2 s[96:97], s[0:1], 136
    s_getreg_b32 s12, hwreg(HW_REG_XCC_ID)
    s_and_b32 s12, s12, 7
    v_lshrrev_b32 v2, 6, v0
    v_and_b32 v1, 63, v0
    s_nop 0
    v_readfirstlane_b32 s14, v2
    s_waitcnt lgkmcnt(0)
    s_mov_b32 s4, s46
    s_and_b32 s5, s47, 0xffff
    s_mov_b32 s6, 268435456
    s_mov_b32 s7, 0x20000
    s_mov_b32 s65, 0
    s_mov_b32 s98, 0
    s_cmp_lg_u32 s14, 0
    s_cbranch_scc1 CH_tk2
    s_mov_b64 exec, 1
    s_lshl_b32 s15, s12, 5
    v_mov_b32 v8, s15
    v_mov_b32 v9, 1
    global_atomic_add v9, v8, v9, s[96:97] sc0
    s_mov_b64 exec, -1
    s_branch CH_tk2_w0
CH_tk2:
    s_cmp_lg_u32 s2, 0
    s_cbranch_scc1 CH_tk2_nc
    s_mov_b64 exec, 1
    v_mov_b32 v4, 0
    s_mov_b32 s30, -1
    s_mov_b32 s31, -1
    s_mul_i32 s28, s14, 49920
    s_add_u32 s28, s28, 84934656
    s_add_u32 s29, s28, 0
    v_mov_b32 v2, s29
    buffer_store_dword v4, v2, s[4:7], 0 offen sc1
    s_add_u32 s29, s28, 8192
    v_mov_b32 v2, s29
    buffer_store_dword v4, v2, s[4:7], 0 offen sc1
    s_add_u32 s29, s28, 16640
    v_mov_b32 v2, s29
    buffer_store_dword v4, v2, s[4:7], 0 offen sc1
    s_add_u32 s29, s28, 24832
    v_mov_b32 v2, s29
    buffer_store_dword v4, v2, s[4:7], 0 offen sc1
    s_add_u32 s29, s28, 33280
    v_mov_b32 v2, s29
    buffer_store_dword v4, v2, s[4:7], 0 offen sc1
    s_add_u32 s29, s28, 41472
    v_mov_b32 v2, s29
    buffer_store_dword v4, v2, s[4:7], 0 offen sc1
    s_waitcnt vmcnt(0)
    s_add_u32 s29, s28, 0
    v_mov_b32 v2, s29
    s_memtime s[32:33]
    s_waitcnt lgkmcnt(0)
    buffer_load_dword v5, v2, s[4:7], 0 offen sc1
    s_waitcnt vmcnt(0)
    s_memtime s[34:35]
    s_waitcnt lgkmcnt(0)
    s_sub_u32 s34, s34, s32
    s_min_u32 s30, s30, s34
    s_add_u32 s29, s28, 8192
    v_mov_b32 v2, s29
    s_memtime s[32:33]
    s_waitcnt lgkmcnt(0)
    buffer_load_dword v5, v2, s[4:7], 0 offen sc1
    s_waitcnt vmcnt(0)
    s_memtime s[34:35]
    s_waitcnt lgkmcnt(0)
    s_sub_u32 s34, s34, s32
    s_min_u32 s31, s31, s34
    s_add_u32 s29, s28, 16640
    v_mov_b32 v2, s29
    s_memtime s[32:33]
    s_waitcnt lgkmcnt(0)
    buffer_load_dword v5, v2, s[4:7], 0 offen sc1
    s_waitcnt vmcnt(0)
    s_memtime s[34:35]
    s_waitcnt lgkmcnt(0)
    s_sub_u32 s34, s34, s32
    s_min_u32 s30, s30, s34
    s_add_u32 s29, s28, 24832
    v_mov_b32 v2, s29
    s_memtime s[32:33]
    s_waitcnt lgkmcnt(0)
    buffer_load_dword v5, v2, s[4:7], 0 offen sc1
    s_waitcnt vmcnt(0)
    s_memtime s[34:35]
    s_waitcnt lgkmcnt(0)
    s_sub_u32 s34, s34, s32
    s_min_u32 s31, s31, s34
    s_add_u32 s29, s28, 33280
    v_mov_b32 v2, s29
    s_memtime s[32:33]
    s_waitcnt lgkmcnt(0)
    buffer_load_dword v5, v2, s[4:7], 0 offen sc1
    s_waitcnt vmcnt(0)
    s_memtime s[34:35]
    s_waitcnt lgkmcnt(0)
    s_sub_u32 s34, s34, s32
    s_min_u32 s30, s30, s34
    s_add_u32 s29, s28, 41472
    v_mov_b32 v2, s29
    s_memtime s[32:33]
    s_waitcnt lgkmcnt(0)
    buffer_load_dword v5, v2, s[4:7], 0 offen sc1
    s_waitcnt vmcnt(0)
    s_memtime s[34:35]
    s_waitcnt lgkmcnt(0)
    s_sub_u32 s34, s34, s32
    s_min_u32 s31, s31, s34
    v_mov_b32 v7, 17440
    s_lshl_b32 s29, s14, 3
    v_add_u32 v7, s29, v7
    v_mov_b32 v5, s30
    v_mov_b32 v6, s31
    ds_write_b32 v7, v5
    ds_write_b32 v7, v6 offset:4
    s_waitcnt lgkmcnt(0)
    s_mov_b64 exec, -1
CH_tk2_nc:
    v_mov_b32 v4, -1
    v_mov_b32 v5, -1
    v_mov_b32 v6, -1
    v_mov_b32 v7, -1
    v_lshlrev_b32 v2, 4, v1
    s_mul_i32 s15, s2, 3
    s_add_u32 s15, s15, s14
    s_sub_u32 s15, s15, 1
    s_mov_b32 s19, s15
CH_zz3_l:
    s_lshl_b32 s20, s19, 10
    s_add_u32 s21, s20, 79691776
    s_add_u32 s22, s20, 81788928
    s_cmp_lt_u32 s19, 2048
    s_cselect_b32 s20, s21, s22
    buffer_store_dwordx4 v[4:7], v2, s[4:7], s20 offen sc1
    s_add_u32 s19, s19, 768
    s_cmp_lt_u32 s19, 2720
    s_cbranch_scc1 CH_zz3_l
    s_cmp_ge_u32 s15, 72
    s_cbranch_scc1 CH_zz3_w
    v_mov_b32 v10, 0
    v_mov_b32 v11, 0
    v_mov_b32 v12, 0
    v_mov_b32 v13, 0
    s_lshl_b32 s20, s15, 10
    s_add_u32 s20, s20, 85991424
    buffer_store_dwordx4 v[10:13], v2, s[4:7], s20 offen sc1
CH_zz3_w:
    s_waitcnt vmcnt(0)
    s_branch CH_rolewait1
CH_tk2_w0:
    s_waitcnt vmcnt(0)
    s_mov_b64 exec, 1
    v_readfirstlane_b32 s13, v9
    s_nop 3
    s_lshl_b32 s15, s12, 5
    s_add_u32 s15, s15, s13
    s_cmp_ge_u32 s13, 32
    s_cselect_b32 s15, 999, s15
    v_mov_b32 v2, 17408
    v_mov_b32 v3, s15
    v_mov_b32 v4, s13
    ds_write_b32 v2, v3
    ds_write_b32 v2, v4 offset:12
    s_waitcnt lgkmcnt(0)
    s_mov_b64 exec, -1
CH_rolewait1:
    s_barrier
    s_cmp_eq_u32 s14, 0
    s_cbranch_scc1 CH_ini7
    s_getpc_b64 s[20:21]
CH_pc6:
    s_sub_u32 s20, s20, CH_pc6 - concat_heads__ssm_conv_s4__memory_aug_recurrent_mem_tr__prompt_kernel
    s_subb_u32 s21, s21, 0
    s_sub_u32 s22, s14, 1
    s_lshl_b32 s22, s22, 13
    v_lshlrev_b32 v2, 7, v1
    v_add_u32 v2, s22, v2
CH_cpl5:
    v_cmp_gt_u32 vcc, CH_codeend - concat_heads__ssm_conv_s4__memory_aug_recurrent_mem_tr__prompt_kernel, v2
    s_and_saveexec_b64 s[24:25], vcc
    s_cbranch_execz CH_cpl5_x
    global_load_dword v254, v2, s[20:21]
    s_mov_b64 exec, s[24:25]
    v_add_u32 v2, 24576, v2
    s_branch CH_cpl5
CH_cpl5_x:
    s_mov_b64 exec, s[24:25]
    s_branch CH_ncp4
CH_ini7:
    s_mov_b32 s98, 1
    s_mov_b64 exec, 1
    v_mov_b32 v2, 4
    v_mov_b32 v3, 1
    global_atomic_add v2, v3, s[96:97]
    s_cmp_lg_u32 s2, 0
    s_cbranch_scc1 CH_ini7_np
    v_mov_b32 v7, 17440
    ds_read2_b32 v[2:3], v7 offset0:2 offset1:3
    ds_read2_b32 v[4:5], v7 offset0:4 offset1:5
    ds_read2_b32 v[8:9], v7 offset0:6 offset1:7
    s_waitcnt lgkmcnt(0)
    v_min3_u32 v2, v2, v4, v8
    v_min3_u32 v3, v3, v5, v9
    s_nop 0
    v_readfirstlane_b32 s30, v2
    v_readfirstlane_b32 s31, v3
    s_nop 3
    s_cmp_lt_u32 s31, s30
    s_cselect_b32 s26, 1, 0
    s_lshr_b32 s29, s12, 2
    s_xor_b32 s26, s26, s29
    s_add_u32 s26, s26, 1
    v_mov_b32 v4, s26
    v_mov_b32 v5, 0
    v_mov_b32 v2, 8
    global_atomic_cmpswap v2, v[4:5], s[96:97]
CH_ini7_np:
    s_mov_b64 exec, -1
CH_ncp4:
    s_mov_b32 s98, 1
    v_mov_b32 v2, 17408
    ds_read_b32 v3, v2
    ds_read_b32 v4, v2 offset:12
    s_waitcnt lgkmcnt(0)
    s_nop 0
    v_readfirstlane_b32 s15, v3
    v_readfirstlane_b32 s13, v4
    s_nop 3
    s_mov_b32 s43, 1
    s_cmp_lg_u32 s15, 999
    s_cbranch_scc1 CH_dispatch
    s_barrier
    s_cmp_lg_u32 s14, 0
    s_cbranch_scc1 CH_dw8
    v_and_b32 v2, 63, v0
    v_lshlrev_b32 v3, 5, v2
    v_and_b32 v3, 0xff, v3
    v_cmp_eq_u32 vcc, 8, v2
    v_mov_b32 v4, 4
    s_nop 0
    v_cndmask_b32 v3, v3, v4, vcc
    v_cmp_eq_u32 vcc, 9, v2
    v_mov_b32 v4, 8
    s_nop 0
    v_cndmask_b32 v2, v3, v4, vcc
    s_mov_b32 s41, 0
CH_dpoll9:
    global_load_dword v3, v2, s[96:97] sc1
    s_waitcnt vmcnt(0)
    s_nop 0
    v_readlane_b32 s48, v3, 0
    v_readlane_b32 s49, v3, 1
    v_readlane_b32 s50, v3, 2
    v_readlane_b32 s51, v3, 3
    v_readlane_b32 s52, v3, 4
    v_readlane_b32 s53, v3, 5
    v_readlane_b32 s54, v3, 6
    v_readlane_b32 s55, v3, 7
    v_readlane_b32 s56, v3, 8
    v_readlane_b32 s42, v3, 9
    s_nop 3
    s_cmp_lt_u32 s56, 256
    s_cbranch_scc1 CH_dpoll9_r
    s_cmp_eq_u32 s42, 99
    s_cbranch_scc1 CH_dpoll9_r
    s_min_u32 s15, s48, s49
    s_min_u32 s15, s15, s50
    s_min_u32 s15, s15, s51
    s_min_u32 s15, s15, s52
    s_min_u32 s15, s15, s53
    s_min_u32 s15, s15, s54
    s_min_u32 s15, s15, s55
    s_cmp_ge_u32 s15, 32
    s_cbranch_scc1 CH_dfast10
    s_add_u32 s15, s48, s49
    s_add_u32 s15, s15, s50
    s_add_u32 s15, s15, s51
    s_add_u32 s15, s15, s52
    s_add_u32 s15, s15, s53
    s_add_u32 s15, s15, s54
    s_add_u32 s15, s15, s55
    s_cmp_ge_u32 s15, 256
    s_cbranch_scc1 CH_dslow11
CH_dpoll9_r:
    s_sleep 1
    s_add_u32 s41, s41, 1
    s_cmp_lt_u32 s41, 524288
    s_cbranch_scc1 CH_dpoll9
    s_mov_b32 s15, 999
    s_mov_b32 s56, 0
    s_branch CH_dwr12
CH_dfast10:
    s_mov_b32 s56, 1
    s_lshl_b32 s15, s12, 5
    s_add_u32 s15, s15, s13
    s_branch CH_dwr12
CH_dslow11:
    s_mov_b32 s15, s13
    s_cmp_gt_u32 s12, 0
    s_cselect_b32 s56, s48, 0
    s_add_u32 s15, s15, s56
    s_cmp_gt_u32 s12, 1
    s_cselect_b32 s56, s49, 0
    s_add_u32 s15, s15, s56
    s_cmp_gt_u32 s12, 2
    s_cselect_b32 s56, s50, 0
    s_add_u32 s15, s15, s56
    s_cmp_gt_u32 s12, 3
    s_cselect_b32 s56, s51, 0
    s_add_u32 s15, s15, s56
    s_cmp_gt_u32 s12, 4
    s_cselect_b32 s56, s52, 0
    s_add_u32 s15, s15, s56
    s_cmp_gt_u32 s12, 5
    s_cselect_b32 s56, s53, 0
    s_add_u32 s15, s15, s56
    s_cmp_gt_u32 s12, 6
    s_cselect_b32 s56, s54, 0
    s_add_u32 s15, s15, s56
    s_mov_b32 s56, 0
CH_dwr12:
    v_mov_b32 v2, 143328
    v_mov_b32 v3, s15
    v_mov_b32 v4, s56
    v_mov_b32 v5, s42
    ds_write_b32 v2, v3
    ds_write_b32 v2, v4 offset:4
    ds_write_b32 v2, v5 offset:8
    s_waitcnt lgkmcnt(0)
CH_dw8:
    s_barrier
    v_mov_b32 v2, 143328
    ds_read_b32 v3, v2
    ds_read_b32 v4, v2 offset:4
    ds_read_b32 v5, v2 offset:8
    s_waitcnt lgkmcnt(0)
    s_nop 0
    v_readfirstlane_b32 s15, v3
    v_readfirstlane_b32 s43, v4
    v_readfirstlane_b32 s42, v5
    s_nop 3
    s_mov_b32 s65, 1
CH_dispatch:
    s_cmp_ge_u32 s15, 128
    s_cbranch_scc1 CH_worker
    s_lshr_b32 s16, s15, 4
    s_and_b32 s17, s15, 15
    v_and_b32 v6, 15, v1
    v_lshrrev_b32 v7, 4, v1
    v_and_b32 v8, 7, v1
    v_cmp_gt_u32 vcc, 8, v6
    s_mov_b64 s[30:31], vcc
    v_cmp_gt_u32 vcc, 32, v1
    s_mov_b64 s[32:33], vcc
    s_mov_b32 s40, 0x3e0293ee
    s_mov_b32 s44, 0xfffffffe
    v_mov_b32 v30, -1
    v_mov_b32 v31, -1
    s_mov_b32 s40, 0x3e0293ee
    s_mul_i32 s15, s16, 65536
    s_add_u32 s15, s15, 79691776
    s_lshl_b32 s19, s14, 10
    v_lshlrev_b32 v2, 4, v1
    v_add_u32 v11, s19, v2
    v_add_u32 v10, s15, v11
    v_add_u32 v11, 0, v11
    v_lshlrev_b32 v3, 7, v7
    v_lshlrev_b32 v4, 4, v8
    v_lshlrev_b32 v12, 4, v1
    v_add_u32 v12, 0, v12
    s_mul_i32 s19, s17, 5
    s_lshl_b32 s45, s14, 1
    s_add_u32 s19, s19, s45
    s_lshl_b32 s19, s19, 7
    s_add_u32 s19, s19, s15
    v_lshrrev_b32 v2, 3, v6
    v_lshlrev_b32 v2, 7, v2
    v_lshlrev_b32 v3, 3, v7
    v_add3_u32 v28, v2, v3, v4
    v_add_u32 v28, s19, v28
    s_mov_b64 s[34:35], s[32:33]
    s_cmp_eq_u32 s14, 2
    s_cbranch_scc0 CH_e1m
    s_and_b64 s[34:35], s[32:33], s[30:31]
CH_e1m:
    s_mul_i32 s15, s16, 131072
    s_add_u32 s15, s15, 80740352
    s_and_b32 s19, s14, 1
    s_lshr_b32 s45, s14, 1
    v_lshrrev_b32 v2, 1, v7
    s_lshl_b32 s46, s19, 1
    v_add_u32 v2, s46, v2
    v_and_b32 v3, 1, v7
    v_lshlrev_b32 v3, 3, v3
    v_lshlrev_b32 v4, 4, v6
    v_lshlrev_b32 v5, 8, v2
    v_add3_u32 v5, v5, v3, v4
    s_lshl_b32 s46, s45, 7
    v_add_u32 v5, s46, v5
    s_lshl_b32 s46, s17, 10
    s_add_u32 s46, s46, s15
    v_add_u32 v13, s46, v5
    v_lshlrev_b32 v9, 7, v2
    v_add3_u32 v9, v9, v3, v4
    s_lshl_b32 s46, s17, 9
    s_add_u32 s46, s46, s15
    s_add_u32 s46, s46, 16384
    v_add_u32 v14, s46, v9
    s_lshl_b32 s46, s16, 4
    s_add_u32 s46, s46, s17
    s_lshl_b32 s47, s46, 10
    s_add_u32 s47, s47, 67108864
    v_add_u32 v15, s47, v5
    s_lshl_b32 s47, s46, 9
    s_add_u32 s47, s47, 75497472
    v_add_u32 v16, s47, v9
    s_lshl_b32 s47, s46, 3
    s_add_u32 s47, s47, 85999616
    v_mov_b32 v123, s47
    s_lshl_b32 s47, s16, 8
    s_add_u32 s47, s47, 85991424
    v_mov_b32 v124, s47
    v_subrev_u32 v121, 512, v15
    v_subrev_u32 v122, 256, v16
    v_lshlrev_b32 v127, 4, v1
    v_and_b32 v2, 1, v7
    v_cmp_eq_u32 vcc, 0, v2
    s_and_b64 s[60:61], vcc, s[30:31]
    v_mov_b32 v126, 0
    v_cmp_gt_u32 vcc, 16, v1
    s_and_b64 s[94:95], vcc, s[34:35]
    v_lshlrev_b32 v2, 4, v1
    s_lshl_b32 s46, s14, 12
    s_add_u32 s46, s46, s15
    v_add_u32 v17, s46, v2
    v_lshlrev_b32 v3, 7, v7
    v_lshlrev_b32 v4, 4, v8
    v_add_u32 v3, v3, v4
    s_lshl_b32 s46, s14, 11
    s_add_u32 s46, s46, s15
    s_add_u32 s46, s46, 16384
    v_add_u32 v18, s46, v3
    s_lshl_b32 s46, s16, 2
    s_add_u32 s46, s46, s14
    s_lshl_b32 s47, s46, 19
    v_add_u32 v19, s47, v2
    v_add_u32 v20, 4096, v19
    v_add_u32 v21, 16777216, v19
    v_add_u32 v22, 16777216, v20
    v_and_b32 v2, 31, v1
    s_lshl_b32 s46, s17, 5
    v_add_u32 v2, s46, v2
    v_lshrrev_b32 v3, 8, v2
    v_mul_u32_u24 v3, 0x1002, v3
    v_lshlrev_b32 v3, 12, v3
    v_lshrrev_b32 v4, 6, v2
    v_and_b32 v4, 3, v4
    s_lshl_b32 s46, s16, 2
    v_add_u32 v4, s46, v4
    v_lshlrev_b32 v4, 19, v4
    v_and_b32 v2, 63, v2
    v_lshlrev_b32 v2, 7, v2
    v_add3_u32 v29, v2, v3, v4
    v_lshlrev_b32 v105, 4, v1
    s_lshl_b32 s46, s14, 13
    s_add_u32 s46, s46, 20480
    v_add_u32 v120, s46, v105
    s_mul_i32 s47, s14, 768
    s_add_u32 s47, s47, 10240
    v_lshrrev_b32 v2, 1, v7
    v_lshlrev_b32 v2, 7, v2
    v_lshlrev_b32 v3, 4, v6
    v_and_b32 v4, 1, v7
    v_lshlrev_b32 v4, 3, v4
    v_add3_u32 v23, v2, v3, v4
    v_add_u32 v23, s47, v23
    v_mul_u32_u24 v2, 768, v7
    s_min_u32 s47, s14, 2
    s_lshl_b32 s47, s47, 8
    s_add_u32 s47, s47, 10240
    v_add3_u32 v24, v2, v3, s47
    s_mov_b32 s45, 83886080
    s_mul_i32 s46, s17, 5120
    s_mul_i32 s47, s16, 640
    s_add_u32 s47, s47, s46
    s_min_u32 s15, s14, 2
    s_lshl_b32 s15, s15, 8
    s_add_u32 s47, s47, s15
    v_lshlrev_b32 v3, 4, v6
    v_and_b32 v4, 1, v7
    v_lshlrev_b32 v4, 3, v4
    v_add3_u32 v25, v3, v4, s47
    v_min_u32 v25, 81912, v25
    v_lshrrev_b32 v2, 13, v25
    v_lshlrev_b32 v2, 14, v2
    v_and_b32 v25, 0x1fff, v25
    v_or_b32 v25, v2, v25
    v_add_u32 v25, s45, v25
    s_cmp_eq_u32 s14, 2
    s_cselect_b32 s47, 7, 15
    v_and_b32 v3, s47, v6
    s_min_u32 s47, s14, 2
    s_lshl_b32 s47, s47, 4
    v_add_u32 v3, s47, v3
    v_lshlrev_b32 v3, 4, v3
    v_mul_u32_u24 v4, 640, v7
    v_add3_u32 v26, v3, v4, s46
    v_add_u32 v27, 2560, v26
    v_lshrrev_b32 v2, 13, v26
    v_lshlrev_b32 v2, 14, v2
    v_and_b32 v26, 0x1fff, v26
    v_or_b32 v26, v2, v26
    v_add_u32 v26, s45, v26
    v_lshrrev_b32 v2, 13, v27
    v_lshlrev_b32 v2, 14, v2
    v_and_b32 v27, 0x1fff, v27
    v_or_b32 v27, v2, v27
    v_add_u32 v27, s45, v27
    v_mov_b32 v2, 0xff800000
    v_mov_b32 v3, 0
    v_cndmask_b32 v32, v3, v2, s[32:33]
    v_mov_b32 v33, v32
    v_mov_b32 v34, v32
    v_mov_b32 v35, v32
    v_mov_b32 v2, 0x3f803f80
    v_accvgpr_write_b32 a244, v2
    v_accvgpr_write_b32 a245, v2
    v_accvgpr_write_b32 a246, v2
    v_accvgpr_write_b32 a247, v2
    v_and_b32 v3, 1, v6
    v_lshlrev_b32 v3, 4, v3
    v_mov_b32 v4, 0x3f80
    v_lshlrev_b32 v4, v3, v4
    v_lshrrev_b32 v5, 1, v6
    v_cmp_eq_u32 vcc, 0, v5
    s_nop 1
    v_cndmask_b32 v2, 0, v4, vcc
    v_accvgpr_write_b32 a240, v2
    v_cmp_eq_u32 vcc, 1, v5
    s_nop 1
    v_cndmask_b32 v2, 0, v4, vcc
    v_accvgpr_write_b32 a241, v2
    v_cmp_eq_u32 vcc, 2, v5
    s_nop 1
    v_cndmask_b32 v2, 0, v4, vcc
    v_accvgpr_write_b32 a242, v2
    v_cmp_eq_u32 vcc, 3, v5
    s_nop 1
    v_cndmask_b32 v2, 0, v4, vcc
    v_accvgpr_write_b32 a243, v2
    s_load_dwordx2 s[46:47], s[0:1], 88
    s_load_dwordx2 s[48:49], s[0:1], 96
    s_load_dwordx2 s[50:51], s[0:1], 104
    s_load_dwordx2 s[52:53], s[0:1], 112
    s_load_dwordx2 s[54:55], s[0:1], 80
    s_lshr_b32 s15, s17, 2
    s_lshl_b32 s19, s16, 2
    s_add_u32 s15, s15, s19
    s_lshl_b32 s15, s15, 8
    s_and_b32 s19, s17, 3
    s_lshl_b32 s19, s19, 6
    s_add_u32 s15, s15, s19
    v_lshrrev_b32 v2, 2, v0
    v_lshlrev_b32 v2, 13, v2
    v_and_b32 v3, 3, v0
    v_lshlrev_b32 v3, 4, v3
    v_add3_u32 v2, v2, v3, s15
    v_lshlrev_b32 v3, 4, v0
    v_add_u32 v3, 20480, v3
    s_waitcnt lgkmcnt(0)
    s_mov_b32 s8, s46
    s_and_b32 s9, s47, 0xffff
    s_mov_b32 s10, 5242880
    s_mov_b32 s11, 0x20000
    s_mov_b32 s19, 0
    buffer_load_dwordx4 v[128:131], v2, s[8:11], s19 offen
    s_add_u32 s19, s19, 524288
    buffer_load_dwordx4 v[132:135], v2, s[8:11], s19 offen
    s_add_u32 s19, s19, 524288
    buffer_load_dwordx4 v[136:139], v2, s[8:11], s19 offen
    s_add_u32 s19, s19, 524288
    buffer_load_dwordx4 v[140:143], v2, s[8:11], s19 offen
    s_add_u32 s19, s19, 524288
    buffer_load_dwordx4 v[144:147], v2, s[8:11], s19 offen
    s_add_u32 s19, s19, 524288
    buffer_load_dwordx4 v[148:151], v2, s[8:11], s19 offen
    s_add_u32 s19, s19, 524288
    buffer_load_dwordx4 v[152:155], v2, s[8:11], s19 offen
    s_add_u32 s19, s19, 524288
    buffer_load_dwordx4 v[156:159], v2, s[8:11], s19 offen
    s_add_u32 s19, s19, 524288
    buffer_load_dwordx4 v[160:163], v2, s[8:11], s19 offen
    s_add_u32 s19, s19, 524288
    buffer_load_dwordx4 v[164:167], v2, s[8:11], s19 offen
    s_mov_b32 s8, s48
    s_and_b32 s9, s49, 0xffff
    s_mov_b32 s10, 5242880
    s_mov_b32 s11, 0x20000
    s_mov_b32 s19, 0
    buffer_load_dwordx4 v[168:171], v2, s[8:11], s19 offen
    s_add_u32 s19, s19, 524288
    buffer_load_dwordx4 v[172:175], v2, s[8:11], s19 offen
    s_add_u32 s19, s19, 524288
    buffer_load_dwordx4 v[176:179], v2, s[8:11], s19 offen
    s_add_u32 s19, s19, 524288
    buffer_load_dwordx4 v[180:183], v2, s[8:11], s19 offen
    s_add_u32 s19, s19, 524288
    buffer_load_dwordx4 v[184:187], v2, s[8:11], s19 offen
    s_add_u32 s19, s19, 524288
    buffer_load_dwordx4 v[188:191], v2, s[8:11], s19 offen
    s_add_u32 s19, s19, 524288
    buffer_load_dwordx4 v[192:195], v2, s[8:11], s19 offen
    s_add_u32 s19, s19, 524288
    buffer_load_dwordx4 v[196:199], v2, s[8:11], s19 offen
    s_add_u32 s19, s19, 524288
    buffer_load_dwordx4 v[200:203], v2, s[8:11], s19 offen
    s_add_u32 s19, s19, 524288
    buffer_load_dwordx4 v[204:207], v2, s[8:11], s19 offen
    s_mov_b32 s8, s50
    s_and_b32 s9, s51, 0xffff
    s_mov_b32 s10, 5242880
    s_mov_b32 s11, 0x20000
    s_mov_b32 s19, 0
    buffer_load_dwordx4 v[208:211], v2, s[8:11], s19 offen
    s_add_u32 s19, s19, 524288
    buffer_load_dwordx4 v[212:215], v2, s[8:11], s19 offen
    s_add_u32 s19, s19, 524288
    buffer_load_dwordx4 v[216:219], v2, s[8:11], s19 offen
    s_add_u32 s19, s19, 524288
    buffer_load_dwordx4 v[220:223], v2, s[8:11], s19 offen
    s_add_u32 s19, s19, 524288
    buffer_load_dwordx4 v[224:227], v2, s[8:11], s19 offen
    s_add_u32 s19, s19, 524288
    buffer_load_dwordx4 v[228:231], v2, s[8:11], s19 offen
    s_add_u32 s19, s19, 524288
    buffer_load_dwordx4 v[232:235], v2, s[8:11], s19 offen
    s_add_u32 s19, s19, 524288
    buffer_load_dwordx4 v[236:239], v2, s[8:11], s19 offen
    s_add_u32 s19, s19, 524288
    buffer_load_dwordx4 v[240:243], v2, s[8:11], s19 offen
    s_add_u32 s19, s19, 524288
    buffer_load_dwordx4 v[244:247], v2, s[8:11], s19 offen
    v_mov_b32 v125, v3
    s_mov_b32 s8, s52
    s_and_b32 s9, s53, 0xffff
    s_mov_b32 s10, 5242880
    s_mov_b32 s11, 0x20000
    s_lshl_b32 s15, s16, 2
    s_add_u32 s15, s15, s14
    s_mul_i32 s15, s15, 163840
    s_mul_i32 s19, s17, 80
    s_add_u32 s15, s15, s19
    s_mul_i32 s45, s14, 12288
    s_add_u32 s45, s45, 20480
    s_mov_b32 s56, 52429
    v_add_u32 v2, 0, v1
    v_mul_lo_u32 v3, v2, s56
    v_lshrrev_b32 v3, 18, v3
    v_mul_u32_u24 v4, 5, v3
    v_sub_u32 v4, v2, v4
    v_lshlrev_b32 v4, 4, v4
    v_mul_u32_u24 v5, 1280, v3
    v_add3_u32 v5, v5, v4, s15
    buffer_load_dwordx4 v[64:67], v5, s[8:11], 0 offen
    v_mul_u32_u24 v5, 96, v3
    v_add3_u32 v110, v5, v4, s45
    v_add_u32 v2, 64, v1
    v_mul_lo_u32 v3, v2, s56
    v_lshrrev_b32 v3, 18, v3
    v_mul_u32_u24 v4, 5, v3
    v_sub_u32 v4, v2, v4
    v_lshlrev_b32 v4, 4, v4
    v_mul_u32_u24 v5, 1280, v3
    v_add3_u32 v5, v5, v4, s15
    buffer_load_dwordx4 v[68:71], v5, s[8:11], 0 offen
    v_mul_u32_u24 v5, 96, v3
    v_add3_u32 v111, v5, v4, s45
    v_add_u32 v2, 128, v1
    v_mul_lo_u32 v3, v2, s56
    v_lshrrev_b32 v3, 18, v3
    v_mul_u32_u24 v4, 5, v3
    v_sub_u32 v4, v2, v4
    v_lshlrev_b32 v4, 4, v4
    v_mul_u32_u24 v5, 1280, v3
    v_add3_u32 v5, v5, v4, s15
    buffer_load_dwordx4 v[72:75], v5, s[8:11], 0 offen
    v_mul_u32_u24 v5, 96, v3
    v_add3_u32 v112, v5, v4, s45
    v_add_u32 v2, 192, v1
    v_mul_lo_u32 v3, v2, s56
    v_lshrrev_b32 v3, 18, v3
    v_mul_u32_u24 v4, 5, v3
    v_sub_u32 v4, v2, v4
    v_lshlrev_b32 v4, 4, v4
    v_mul_u32_u24 v5, 1280, v3
    v_add3_u32 v5, v5, v4, s15
    buffer_load_dwordx4 v[76:79], v5, s[8:11], 0 offen
    v_mul_u32_u24 v5, 96, v3
    v_add3_u32 v113, v5, v4, s45
    v_add_u32 v2, 256, v1
    v_mul_lo_u32 v3, v2, s56
    v_lshrrev_b32 v3, 18, v3
    v_mul_u32_u24 v4, 5, v3
    v_sub_u32 v4, v2, v4
    v_lshlrev_b32 v4, 4, v4
    v_mul_u32_u24 v5, 1280, v3
    v_add3_u32 v5, v5, v4, s15
    buffer_load_dwordx4 v[80:83], v5, s[8:11], 0 offen
    v_mul_u32_u24 v5, 96, v3
    v_add3_u32 v114, v5, v4, s45
    v_add_u32 v2, 320, v1
    v_mul_lo_u32 v3, v2, s56
    v_lshrrev_b32 v3, 18, v3
    v_mul_u32_u24 v4, 5, v3
    v_sub_u32 v4, v2, v4
    v_lshlrev_b32 v4, 4, v4
    v_mul_u32_u24 v5, 1280, v3
    v_add3_u32 v5, v5, v4, s15
    buffer_load_dwordx4 v[84:87], v5, s[8:11], 0 offen
    v_mul_u32_u24 v5, 96, v3
    v_add3_u32 v115, v5, v4, s45
    v_add_u32 v2, 384, v1
    v_mul_lo_u32 v3, v2, s56
    v_lshrrev_b32 v3, 18, v3
    v_mul_u32_u24 v4, 5, v3
    v_sub_u32 v4, v2, v4
    v_lshlrev_b32 v4, 4, v4
    v_mul_u32_u24 v5, 1280, v3
    v_add3_u32 v5, v5, v4, s15
    buffer_load_dwordx4 v[88:91], v5, s[8:11], 0 offen
    v_mul_u32_u24 v5, 96, v3
    v_add3_u32 v116, v5, v4, s45
    v_add_u32 v2, 448, v1
    v_mul_lo_u32 v3, v2, s56
    v_lshrrev_b32 v3, 18, v3
    v_mul_u32_u24 v4, 5, v3
    v_sub_u32 v4, v2, v4
    v_lshlrev_b32 v4, 4, v4
    v_mul_u32_u24 v5, 1280, v3
    v_add3_u32 v5, v5, v4, s15
    buffer_load_dwordx4 v[92:95], v5, s[8:11], 0 offen
    v_mul_u32_u24 v5, 96, v3
    v_add3_u32 v117, v5, v4, s45
    v_add_u32 v2, 512, v1
    v_mul_lo_u32 v3, v2, s56
    v_lshrrev_b32 v3, 18, v3
    v_mul_u32_u24 v4, 5, v3
    v_sub_u32 v4, v2, v4
    v_lshlrev_b32 v4, 4, v4
    v_mul_u32_u24 v5, 1280, v3
    v_add3_u32 v5, v5, v4, s15
    buffer_load_dwordx4 v[96:99], v5, s[8:11], 0 offen
    v_mul_u32_u24 v5, 96, v3
    v_add3_u32 v118, v5, v4, s45
    v_add_u32 v2, 576, v1
    v_mul_lo_u32 v3, v2, s56
    v_lshrrev_b32 v3, 18, v3
    v_mul_u32_u24 v4, 5, v3
    v_sub_u32 v4, v2, v4
    v_lshlrev_b32 v4, 4, v4
    v_mul_u32_u24 v5, 1280, v3
    v_add3_u32 v5, v5, v4, s15
    buffer_load_dwordx4 v[100:103], v5, s[8:11], 0 offen
    v_mul_u32_u24 v5, 96, v3
    v_add3_u32 v119, v5, v4, s45
    v_add_u32 v4, 0x10000, v125
    s_waitcnt vmcnt(30)
    ds_write_b128 v125, v[128:131] offset:0
    ds_write_b128 v125, v[132:135] offset:4096
    ds_write_b128 v125, v[136:139] offset:8192
    ds_write_b128 v125, v[140:143] offset:12288
    ds_write_b128 v125, v[144:147] offset:16384
    ds_write_b128 v125, v[148:151] offset:20480
    ds_write_b128 v125, v[152:155] offset:24576
    ds_write_b128 v125, v[156:159] offset:28672
    ds_write_b128 v125, v[160:163] offset:32768
    ds_write_b128 v125, v[164:167] offset:36864
    s_waitcnt vmcnt(20)
    ds_write_b128 v125, v[168:171] offset:40960
    ds_write_b128 v125, v[172:175] offset:45056
    ds_write_b128 v125, v[176:179] offset:49152
    ds_write_b128 v125, v[180:183] offset:53248
    ds_write_b128 v125, v[184:187] offset:57344
    ds_write_b128 v125, v[188:191] offset:61440
    ds_write_b128 v4, v[192:195] offset:0
    ds_write_b128 v4, v[196:199] offset:4096
    ds_write_b128 v4, v[200:203] offset:8192
    ds_write_b128 v4, v[204:207] offset:12288
    s_waitcnt vmcnt(10)
    ds_write_b128 v4, v[208:211] offset:16384
    ds_write_b128 v4, v[212:215] offset:20480
    ds_write_b128 v4, v[216:219] offset:24576
    ds_write_b128 v4, v[220:223] offset:28672
    ds_write_b128 v4, v[224:227] offset:32768
    ds_write_b128 v4, v[228:231] offset:36864
    ds_write_b128 v4, v[232:235] offset:40960
    ds_write_b128 v4, v[236:239] offset:45056
    ds_write_b128 v4, v[240:243] offset:49152
    ds_write_b128 v4, v[244:247] offset:53248
    s_waitcnt lgkmcnt(0)
    s_barrier
    v_lshrrev_b32 v2, 2, v6
    v_lshrrev_b32 v3, 1, v7
    v_lshlrev_b32 v3, 4, v3
    v_add_u32 v2, v2, v3
    v_and_b32 v3, 1, v7
    v_lshlrev_b32 v3, 2, v3
    v_add_u32 v2, v2, v3
    v_lshlrev_b32 v2, 6, v2
    v_and_b32 v3, 3, v1
    v_lshlrev_b32 v3, 3, v3
    s_and_b32 s15, s14, 1
    s_lshl_b32 s15, s15, 5
    s_lshr_b32 s19, s14, 1
    s_mul_i32 s19, s19, 40960
    s_add_u32 s19, s19, s15
    s_add_u32 s19, s19, 20480
    v_add3_u32 v4, v2, v3, s19
    s_add_u32 s15, s15, 102400
    v_add3_u32 v5, v2, v3, s15
    ds_read_b64_tr_b16 v[128:129], v4 offset:0
    ds_read_b64_tr_b16 v[130:131], v4 offset:512
    ds_read_b64_tr_b16 v[132:133], v4 offset:2048
    ds_read_b64_tr_b16 v[134:135], v4 offset:2560
    ds_read_b64_tr_b16 v[136:137], v5 offset:0
    ds_read_b64_tr_b16 v[138:139], v5 offset:512
    ds_read_b64_tr_b16 v[140:141], v5 offset:2048
    ds_read_b64_tr_b16 v[142:143], v5 offset:2560
    s_waitcnt lgkmcnt(0)
    v_accvgpr_write_b32 a0, v128
    v_accvgpr_write_b32 a2, v129
    v_accvgpr_write_b32 a1, v130
    v_accvgpr_write_b32 a3, v131
    v_accvgpr_write_b32 a4, v132
    v_accvgpr_write_b32 a6, v133
    v_accvgpr_write_b32 a5, v134
    v_accvgpr_write_b32 a7, v135
    v_accvgpr_write_b32 a80, v136
    v_accvgpr_write_b32 a82, v137
    v_accvgpr_write_b32 a81, v138
    v_accvgpr_write_b32 a83, v139
    v_accvgpr_write_b32 a84, v140
    v_accvgpr_write_b32 a86, v141
    v_accvgpr_write_b32 a85, v142
    v_accvgpr_write_b32 a87, v143
    ds_read_b64_tr_b16 v[128:129], v4 offset:4096
    ds_read_b64_tr_b16 v[130:131], v4 offset:4608
    ds_read_b64_tr_b16 v[132:133], v4 offset:6144
    ds_read_b64_tr_b16 v[134:135], v4 offset:6656
    ds_read_b64_tr_b16 v[136:137], v5 offset:4096
    ds_read_b64_tr_b16 v[138:139], v5 offset:4608
    ds_read_b64_tr_b16 v[140:141], v5 offset:6144
    ds_read_b64_tr_b16 v[142:143], v5 offset:6656
    s_waitcnt lgkmcnt(0)
    v_accvgpr_write_b32 a8, v128
    v_accvgpr_write_b32 a10, v129
    v_accvgpr_write_b32 a9, v130
    v_accvgpr_write_b32 a11, v131
    v_accvgpr_write_b32 a12, v132
    v_accvgpr_write_b32 a14, v133
    v_accvgpr_write_b32 a13, v134
    v_accvgpr_write_b32 a15, v135
    v_accvgpr_write_b32 a88, v136
    v_accvgpr_write_b32 a90, v137
    v_accvgpr_write_b32 a89, v138
    v_accvgpr_write_b32 a91, v139
    v_accvgpr_write_b32 a92, v140
    v_accvgpr_write_b32 a94, v141
    v_accvgpr_write_b32 a93, v142
    v_accvgpr_write_b32 a95, v143
    ds_read_b64_tr_b16 v[128:129], v4 offset:8192
    ds_read_b64_tr_b16 v[130:131], v4 offset:8704
    ds_read_b64_tr_b16 v[132:133], v4 offset:10240
    ds_read_b64_tr_b16 v[134:135], v4 offset:10752
    ds_read_b64_tr_b16 v[136:137], v5 offset:8192
    ds_read_b64_tr_b16 v[138:139], v5 offset:8704
    ds_read_b64_tr_b16 v[140:141], v5 offset:10240
    ds_read_b64_tr_b16 v[142:143], v5 offset:10752
    s_waitcnt lgkmcnt(0)
    v_accvgpr_write_b32 a16, v128
    v_accvgpr_write_b32 a18, v129
    v_accvgpr_write_b32 a17, v130
    v_accvgpr_write_b32 a19, v131
    v_accvgpr_write_b32 a20, v132
    v_accvgpr_write_b32 a22, v133
    v_accvgpr_write_b32 a21, v134
    v_accvgpr_write_b32 a23, v135
    v_accvgpr_write_b32 a96, v136
    v_accvgpr_write_b32 a98, v137
    v_accvgpr_write_b32 a97, v138
    v_accvgpr_write_b32 a99, v139
    v_accvgpr_write_b32 a100, v140
    v_accvgpr_write_b32 a102, v141
    v_accvgpr_write_b32 a101, v142
    v_accvgpr_write_b32 a103, v143
    ds_read_b64_tr_b16 v[128:129], v4 offset:12288
    ds_read_b64_tr_b16 v[130:131], v4 offset:12800
    ds_read_b64_tr_b16 v[132:133], v4 offset:14336
    ds_read_b64_tr_b16 v[134:135], v4 offset:14848
    ds_read_b64_tr_b16 v[136:137], v5 offset:12288
    ds_read_b64_tr_b16 v[138:139], v5 offset:12800
    ds_read_b64_tr_b16 v[140:141], v5 offset:14336
    ds_read_b64_tr_b16 v[142:143], v5 offset:14848
    s_waitcnt lgkmcnt(0)
    v_accvgpr_write_b32 a24, v128
    v_accvgpr_write_b32 a26, v129
    v_accvgpr_write_b32 a25, v130
    v_accvgpr_write_b32 a27, v131
    v_accvgpr_write_b32 a28, v132
    v_accvgpr_write_b32 a30, v133
    v_accvgpr_write_b32 a29, v134
    v_accvgpr_write_b32 a31, v135
    v_accvgpr_write_b32 a104, v136
    v_accvgpr_write_b32 a106, v137
    v_accvgpr_write_b32 a105, v138
    v_accvgpr_write_b32 a107, v139
    v_accvgpr_write_b32 a108, v140
    v_accvgpr_write_b32 a110, v141
    v_accvgpr_write_b32 a109, v142
    v_accvgpr_write_b32 a111, v143
    ds_read_b64_tr_b16 v[128:129], v4 offset:16384
    ds_read_b64_tr_b16 v[130:131], v4 offset:16896
    ds_read_b64_tr_b16 v[132:133], v4 offset:18432
    ds_read_b64_tr_b16 v[134:135], v4 offset:18944
    ds_read_b64_tr_b16 v[136:137], v5 offset:16384
    ds_read_b64_tr_b16 v[138:139], v5 offset:16896
    ds_read_b64_tr_b16 v[140:141], v5 offset:18432
    ds_read_b64_tr_b16 v[142:143], v5 offset:18944
    s_waitcnt lgkmcnt(0)
    v_accvgpr_write_b32 a32, v128
    v_accvgpr_write_b32 a34, v129
    v_accvgpr_write_b32 a33, v130
    v_accvgpr_write_b32 a35, v131
    v_accvgpr_write_b32 a36, v132
    v_accvgpr_write_b32 a38, v133
    v_accvgpr_write_b32 a37, v134
    v_accvgpr_write_b32 a39, v135
    v_accvgpr_write_b32 a112, v136
    v_accvgpr_write_b32 a114, v137
    v_accvgpr_write_b32 a113, v138
    v_accvgpr_write_b32 a115, v139
    v_accvgpr_write_b32 a116, v140
    v_accvgpr_write_b32 a118, v141
    v_accvgpr_write_b32 a117, v142
    v_accvgpr_write_b32 a119, v143
    ds_read_b64_tr_b16 v[128:129], v4 offset:20480
    ds_read_b64_tr_b16 v[130:131], v4 offset:20992
    ds_read_b64_tr_b16 v[132:133], v4 offset:22528
    ds_read_b64_tr_b16 v[134:135], v4 offset:23040
    ds_read_b64_tr_b16 v[136:137], v5 offset:20480
    ds_read_b64_tr_b16 v[138:139], v5 offset:20992
    ds_read_b64_tr_b16 v[140:141], v5 offset:22528
    ds_read_b64_tr_b16 v[142:143], v5 offset:23040
    s_waitcnt lgkmcnt(0)
    v_accvgpr_write_b32 a40, v128
    v_accvgpr_write_b32 a42, v129
    v_accvgpr_write_b32 a41, v130
    v_accvgpr_write_b32 a43, v131
    v_accvgpr_write_b32 a44, v132
    v_accvgpr_write_b32 a46, v133
    v_accvgpr_write_b32 a45, v134
    v_accvgpr_write_b32 a47, v135
    v_accvgpr_write_b32 a120, v136
    v_accvgpr_write_b32 a122, v137
    v_accvgpr_write_b32 a121, v138
    v_accvgpr_write_b32 a123, v139
    v_accvgpr_write_b32 a124, v140
    v_accvgpr_write_b32 a126, v141
    v_accvgpr_write_b32 a125, v142
    v_accvgpr_write_b32 a127, v143
    ds_read_b64_tr_b16 v[128:129], v4 offset:24576
    ds_read_b64_tr_b16 v[130:131], v4 offset:25088
    ds_read_b64_tr_b16 v[132:133], v4 offset:26624
    ds_read_b64_tr_b16 v[134:135], v4 offset:27136
    ds_read_b64_tr_b16 v[136:137], v5 offset:24576
    ds_read_b64_tr_b16 v[138:139], v5 offset:25088
    ds_read_b64_tr_b16 v[140:141], v5 offset:26624
    ds_read_b64_tr_b16 v[142:143], v5 offset:27136
    s_waitcnt lgkmcnt(0)
    v_accvgpr_write_b32 a48, v128
    v_accvgpr_write_b32 a50, v129
    v_accvgpr_write_b32 a49, v130
    v_accvgpr_write_b32 a51, v131
    v_accvgpr_write_b32 a52, v132
    v_accvgpr_write_b32 a54, v133
    v_accvgpr_write_b32 a53, v134
    v_accvgpr_write_b32 a55, v135
    v_accvgpr_write_b32 a128, v136
    v_accvgpr_write_b32 a130, v137
    v_accvgpr_write_b32 a129, v138
    v_accvgpr_write_b32 a131, v139
    v_accvgpr_write_b32 a132, v140
    v_accvgpr_write_b32 a134, v141
    v_accvgpr_write_b32 a133, v142
    v_accvgpr_write_b32 a135, v143
    ds_read_b64_tr_b16 v[128:129], v4 offset:28672
    ds_read_b64_tr_b16 v[130:131], v4 offset:29184
    ds_read_b64_tr_b16 v[132:133], v4 offset:30720
    ds_read_b64_tr_b16 v[134:135], v4 offset:31232
    ds_read_b64_tr_b16 v[136:137], v5 offset:28672
    ds_read_b64_tr_b16 v[138:139], v5 offset:29184
    ds_read_b64_tr_b16 v[140:141], v5 offset:30720
    ds_read_b64_tr_b16 v[142:143], v5 offset:31232
    s_waitcnt lgkmcnt(0)
    v_accvgpr_write_b32 a56, v128
    v_accvgpr_write_b32 a58, v129
    v_accvgpr_write_b32 a57, v130
    v_accvgpr_write_b32 a59, v131
    v_accvgpr_write_b32 a60, v132
    v_accvgpr_write_b32 a62, v133
    v_accvgpr_write_b32 a61, v134
    v_accvgpr_write_b32 a63, v135
    v_accvgpr_write_b32 a136, v136
    v_accvgpr_write_b32 a138, v137
    v_accvgpr_write_b32 a137, v138
    v_accvgpr_write_b32 a139, v139
    v_accvgpr_write_b32 a140, v140
    v_accvgpr_write_b32 a142, v141
    v_accvgpr_write_b32 a141, v142
    v_accvgpr_write_b32 a143, v143
    ds_read_b64_tr_b16 v[128:129], v4 offset:32768
    ds_read_b64_tr_b16 v[130:131], v4 offset:33280
    ds_read_b64_tr_b16 v[132:133], v4 offset:34816
    ds_read_b64_tr_b16 v[134:135], v4 offset:35328
    ds_read_b64_tr_b16 v[136:137], v5 offset:32768
    ds_read_b64_tr_b16 v[138:139], v5 offset:33280
    ds_read_b64_tr_b16 v[140:141], v5 offset:34816
    ds_read_b64_tr_b16 v[142:143], v5 offset:35328
    s_waitcnt lgkmcnt(0)
    v_accvgpr_write_b32 a64, v128
    v_accvgpr_write_b32 a66, v129
    v_accvgpr_write_b32 a65, v130
    v_accvgpr_write_b32 a67, v131
    v_accvgpr_write_b32 a68, v132
    v_accvgpr_write_b32 a70, v133
    v_accvgpr_write_b32 a69, v134
    v_accvgpr_write_b32 a71, v135
    v_accvgpr_write_b32 a144, v136
    v_accvgpr_write_b32 a146, v137
    v_accvgpr_write_b32 a145, v138
    v_accvgpr_write_b32 a147, v139
    v_accvgpr_write_b32 a148, v140
    v_accvgpr_write_b32 a150, v141
    v_accvgpr_write_b32 a149, v142
    v_accvgpr_write_b32 a151, v143
    ds_read_b64_tr_b16 v[128:129], v4 offset:36864
    ds_read_b64_tr_b16 v[130:131], v4 offset:37376
    ds_read_b64_tr_b16 v[132:133], v4 offset:38912
    ds_read_b64_tr_b16 v[134:135], v4 offset:39424
    ds_read_b64_tr_b16 v[136:137], v5 offset:36864
    ds_read_b64_tr_b16 v[138:139], v5 offset:37376
    ds_read_b64_tr_b16 v[140:141], v5 offset:38912
    ds_read_b64_tr_b16 v[142:143], v5 offset:39424
    s_waitcnt lgkmcnt(0)
    v_accvgpr_write_b32 a72, v128
    v_accvgpr_write_b32 a74, v129
    v_accvgpr_write_b32 a73, v130
    v_accvgpr_write_b32 a75, v131
    v_accvgpr_write_b32 a76, v132
    v_accvgpr_write_b32 a78, v133
    v_accvgpr_write_b32 a77, v134
    v_accvgpr_write_b32 a79, v135
    v_accvgpr_write_b32 a152, v136
    v_accvgpr_write_b32 a154, v137
    v_accvgpr_write_b32 a153, v138
    v_accvgpr_write_b32 a155, v139
    v_accvgpr_write_b32 a156, v140
    v_accvgpr_write_b32 a158, v141
    v_accvgpr_write_b32 a157, v142
    v_accvgpr_write_b32 a159, v143
    s_barrier
    v_mov_b32 v2, 0
    v_mov_b32 v3, 0
    v_mov_b32 v4, 0
    v_mov_b32 v5, 0
    v_mul_u32_u24 v9, 96, v1
    v_add_u32 v9, s45, v9
    ds_write_b128 v9, v[2:5] offset:80
    ds_write_b128 v9, v[2:5] offset:6224
    s_waitcnt vmcnt(0)
    ds_write_b128 v110, v[64:67]
    ds_write_b128 v111, v[68:71]
    ds_write_b128 v112, v[72:75]
    ds_write_b128 v113, v[76:79]
    ds_write_b128 v114, v[80:83]
    ds_write_b128 v115, v[84:87]
    ds_write_b128 v116, v[88:91]
    ds_write_b128 v117, v[92:95]
    ds_write_b128 v118, v[96:99]
    ds_write_b128 v119, v[100:103]
    s_waitcnt lgkmcnt(0)
    v_lshrrev_b32 v2, 2, v6
    v_lshlrev_b32 v3, 3, v7
    v_add_u32 v2, v2, v3
    v_mul_u32_u24 v2, 96, v2
    v_and_b32 v3, 3, v1
    v_lshlrev_b32 v3, 3, v3
    v_add3_u32 v4, v2, v3, s45
    ds_read_b64_tr_b16 a[160:161], v4 offset:0
    ds_read_b64_tr_b16 a[162:163], v4 offset:384
    ds_read_b64_tr_b16 a[164:165], v4 offset:32
    ds_read_b64_tr_b16 a[166:167], v4 offset:416
    ds_read_b64_tr_b16 a[168:169], v4 offset:64
    ds_read_b64_tr_b16 a[170:171], v4 offset:448
    s_waitcnt lgkmcnt(0)
    ds_read_b64_tr_b16 a[172:173], v4 offset:3072
    ds_read_b64_tr_b16 a[174:175], v4 offset:3456
    ds_read_b64_tr_b16 a[176:177], v4 offset:3104
    ds_read_b64_tr_b16 a[178:179], v4 offset:3488
    ds_read_b64_tr_b16 a[180:181], v4 offset:3136
    ds_read_b64_tr_b16 a[182:183], v4 offset:3520
    s_waitcnt lgkmcnt(0)
    ds_read_b64_tr_b16 a[184:185], v4 offset:6144
    ds_read_b64_tr_b16 a[186:187], v4 offset:6528
    ds_read_b64_tr_b16 a[188:189], v4 offset:6176
    ds_read_b64_tr_b16 a[190:191], v4 offset:6560
    ds_read_b64_tr_b16 a[192:193], v4 offset:6208
    ds_read_b64_tr_b16 a[194:195], v4 offset:6592
    s_waitcnt lgkmcnt(0)
    ds_read_b64_tr_b16 a[196:197], v4 offset:9216
    ds_read_b64_tr_b16 a[198:199], v4 offset:9600
    ds_read_b64_tr_b16 a[200:201], v4 offset:9248
    ds_read_b64_tr_b16 a[202:203], v4 offset:9632
    ds_read_b64_tr_b16 a[204:205], v4 offset:9280
    ds_read_b64_tr_b16 a[206:207], v4 offset:9664
    s_waitcnt lgkmcnt(0)
    s_mov_b32 s8, s54
    s_and_b32 s9, s55, 0xffff
    s_mov_b32 s10, 10240
    s_mov_b32 s11, 0x20000
    v_mul_u32_u24 v2, 1280, v8
    v_lshrrev_b32 v3, 3, v1
    v_lshlrev_b32 v3, 4, v3
    s_lshl_b32 s15, s14, 7
    v_add3_u32 v2, v2, v3, s15
    buffer_load_dwordx4 v[40:43], v2, s[8:11], 0 offen
    buffer_load_dwordx4 v[44:47], v2, s[8:11], 0 offen offset:384
    buffer_load_dwordx4 v[48:51], v2, s[8:11], 0 offen offset:768
    v_mov_b32 v56, 0
    v_mov_b32 v57, 0
    v_mov_b32 v58, 0
    v_mov_b32 v59, 0
    s_cmp_lg_u32 s14, 0
    s_cbranch_scc1 CH_m0
    buffer_load_dwordx4 v[56:59], v2, s[8:11], 0 offen offset:1152
CH_m0:
    s_cmp_lg_u32 s65, 0
    s_cbranch_scc1 CH_vf13
    s_barrier
    s_cmp_lg_u32 s14, 0
    s_cbranch_scc1 CH_dw14
    v_and_b32 v2, 63, v0
    v_lshlrev_b32 v3, 5, v2
    v_and_b32 v3, 0xff, v3
    v_cmp_eq_u32 vcc, 8, v2
    v_mov_b32 v4, 4
    s_nop 0
    v_cndmask_b32 v3, v3, v4, vcc
    v_cmp_eq_u32 vcc, 9, v2
    v_mov_b32 v4, 8
    s_nop 0
    v_cndmask_b32 v2, v3, v4, vcc
    s_mov_b32 s41, 0
CH_dpoll15:
    global_load_dword v3, v2, s[96:97] sc1
    s_waitcnt vmcnt(0)
    s_nop 0
    v_readlane_b32 s48, v3, 0
    v_readlane_b32 s49, v3, 1
    v_readlane_b32 s50, v3, 2
    v_readlane_b32 s51, v3, 3
    v_readlane_b32 s52, v3, 4
    v_readlane_b32 s53, v3, 5
    v_readlane_b32 s54, v3, 6
    v_readlane_b32 s55, v3, 7
    v_readlane_b32 s56, v3, 8
    v_readlane_b32 s42, v3, 9
    s_nop 3
    s_cmp_lt_u32 s56, 256
    s_cbranch_scc1 CH_dpoll15_r
    s_cmp_eq_u32 s42, 99
    s_cbranch_scc1 CH_dpoll15_r
    s_min_u32 s15, s48, s49
    s_min_u32 s15, s15, s50
    s_min_u32 s15, s15, s51
    s_min_u32 s15, s15, s52
    s_min_u32 s15, s15, s53
    s_min_u32 s15, s15, s54
    s_min_u32 s15, s15, s55
    s_cmp_ge_u32 s15, 32
    s_cbranch_scc1 CH_dfast16
    s_add_u32 s15, s48, s49
    s_add_u32 s15, s15, s50
    s_add_u32 s15, s15, s51
    s_add_u32 s15, s15, s52
    s_add_u32 s15, s15, s53
    s_add_u32 s15, s15, s54
    s_add_u32 s15, s15, s55
    s_cmp_ge_u32 s15, 256
    s_cbranch_scc1 CH_dslow17
CH_dpoll15_r:
    s_sleep 1
    s_add_u32 s41, s41, 1
    s_cmp_lt_u32 s41, 524288
    s_cbranch_scc1 CH_dpoll15
    s_mov_b32 s15, 999
    s_mov_b32 s56, 0
    s_branch CH_dwr18
CH_dfast16:
    s_mov_b32 s56, 1
    s_lshl_b32 s15, s12, 5
    s_add_u32 s15, s15, s13
    s_branch CH_dwr18
CH_dslow17:
    s_mov_b32 s15, s13
    s_cmp_gt_u32 s12, 0
    s_cselect_b32 s56, s48, 0
    s_add_u32 s15, s15, s56
    s_cmp_gt_u32 s12, 1
    s_cselect_b32 s56, s49, 0
    s_add_u32 s15, s15, s56
    s_cmp_gt_u32 s12, 2
    s_cselect_b32 s56, s50, 0
    s_add_u32 s15, s15, s56
    s_cmp_gt_u32 s12, 3
    s_cselect_b32 s56, s51, 0
    s_add_u32 s15, s15, s56
    s_cmp_gt_u32 s12, 4
    s_cselect_b32 s56, s52, 0
    s_add_u32 s15, s15, s56
    s_cmp_gt_u32 s12, 5
    s_cselect_b32 s56, s53, 0
    s_add_u32 s15, s15, s56
    s_cmp_gt_u32 s12, 6
    s_cselect_b32 s56, s54, 0
    s_add_u32 s15, s15, s56
    s_mov_b32 s56, 0
CH_dwr18:
    v_mov_b32 v2, 143328
    v_mov_b32 v3, s15
    v_mov_b32 v4, s56
    v_mov_b32 v5, s42
    ds_write_b32 v2, v3
    ds_write_b32 v2, v4 offset:4
    ds_write_b32 v2, v5 offset:8
    s_waitcnt lgkmcnt(0)
CH_dw14:
    s_barrier
    v_mov_b32 v2, 143328
    ds_read_b32 v3, v2
    ds_read_b32 v4, v2 offset:4
    ds_read_b32 v5, v2 offset:8
    s_waitcnt lgkmcnt(0)
    s_nop 0
    v_readfirstlane_b32 s15, v3
    v_readfirstlane_b32 s43, v4
    v_readfirstlane_b32 s42, v5
    s_nop 3
    s_mov_b32 s65, 1
    s_cmp_eq_u32 s43, 0
    s_cbranch_scc1 CH_dispatch
CH_vf13:
    v_mov_b32 v2, 8
    s_mov_b32 s41, 0
CH_par19:
    global_load_dword v3, v2, s[96:97] sc1
    s_waitcnt vmcnt(0)
    s_nop 0
    v_readfirstlane_b32 s42, v3
    s_nop 3
    s_cmp_lg_u32 s42, 0
    s_cbranch_scc1 CH_par19_ok
    s_sleep 1
    s_add_u32 s41, s41, 1
    s_cmp_lt_u32 s41, 524288
    s_cbranch_scc1 CH_par19
    s_branch CH_abort
CH_par19_ok:
    s_sub_u32 s42, s42, 1
    s_and_b32 s42, s42, 1
    s_lshl_b32 s15, s42, 13
    v_add_u32 v25, s15, v25
    v_add_u32 v26, s15, v26
    v_add_u32 v27, s15, v27
    s_mov_b32 s47, 0
    s_lshl_b32 s48, s47, 2
    s_mov_b32 s41, 0
CH_kvw20:
    buffer_load_dword v2, v124, s[4:7], s48 offen sc1
    s_waitcnt vmcnt(0)
    s_nop 0
    v_readfirstlane_b32 s15, v2
    s_nop 3
    s_cmp_ge_u32 s15, 4
    s_cbranch_scc1 CH_kvok21
    s_sleep 2
    s_add_u32 s41, s41, 1
    s_cmp_lt_u32 s41, 524288
    s_cbranch_scc1 CH_kvw20
    s_branch CH_abort
CH_kvok21:
    s_mov_b32 s47, 1
    s_lshl_b32 s48, s47, 2
    s_mov_b32 s41, 0
CH_kvw22:
    buffer_load_dword v2, v124, s[4:7], s48 offen sc1
    s_waitcnt vmcnt(0)
    s_nop 0
    v_readfirstlane_b32 s15, v2
    s_nop 3
    s_cmp_ge_u32 s15, 4
    s_cbranch_scc1 CH_kvok23
    s_sleep 2
    s_add_u32 s41, s41, 1
    s_cmp_lt_u32 s41, 524288
    s_cbranch_scc1 CH_kvw22
    s_branch CH_abort
CH_kvok23:
    s_mov_b32 s47, 2
    s_lshl_b32 s48, s47, 2
    s_mov_b32 s41, 0
CH_kvw24:
    buffer_load_dword v2, v124, s[4:7], s48 offen sc1
    s_waitcnt vmcnt(0)
    s_nop 0
    v_readfirstlane_b32 s15, v2
    s_nop 3
    s_cmp_ge_u32 s15, 4
    s_cbranch_scc1 CH_kvok25
    s_sleep 2
    s_add_u32 s41, s41, 1
    s_cmp_lt_u32 s41, 524288
    s_cbranch_scc1 CH_kvw24
    s_branch CH_abort
CH_kvok25:
    buffer_load_dwordx4 a[208:211], v19, s[4:7], 0 offen offset:0
    buffer_load_dwordx4 a[212:215], v19, s[4:7], 0 offen offset:1024
    buffer_load_dwordx4 a[216:219], v19, s[4:7], 0 offen offset:2048
    buffer_load_dwordx4 a[220:223], v19, s[4:7], 0 offen offset:3072
    buffer_load_dwordx4 a[224:227], v20, s[4:7], 0 offen offset:0
    buffer_load_dwordx4 a[228:231], v20, s[4:7], 0 offen offset:1024
    buffer_load_dwordx4 a[232:235], v20, s[4:7], 0 offen offset:2048
    buffer_load_dwordx4 a[236:239], v20, s[4:7], 0 offen offset:3072
    buffer_load_dwordx4 v[144:147], v21, s[4:7], 0 offen offset:0
    buffer_load_dwordx4 v[148:151], v21, s[4:7], 0 offen offset:1024
    buffer_load_dwordx4 v[152:155], v21, s[4:7], 0 offen offset:2048
    buffer_load_dwordx4 v[156:159], v21, s[4:7], 0 offen offset:3072
    buffer_load_dwordx4 v[160:163], v22, s[4:7], 0 offen offset:0
    buffer_load_dwordx4 v[164:167], v22, s[4:7], 0 offen offset:1024
    buffer_load_dwordx4 v[168:171], v22, s[4:7], 0 offen offset:2048
    buffer_load_dwordx4 v[172:175], v22, s[4:7], 0 offen offset:3072
    s_mov_b64 exec, s[32:33]
    s_mov_b32 s19, 8192
    buffer_load_dword v9, v29, s[4:7], s19 offen
    buffer_load_dword v9, v29, s[4:7], 0 offen
    s_mov_b64 exec, -1
    s_waitcnt vmcnt(0)
    v_mfma_f32_16x16x32_bf16 v[64:67], v[144:147], a[160:163], 0
    v_mfma_f32_16x16x32_bf16 v[64:67], v[148:151], a[172:175], v[64:67]
    v_mfma_f32_16x16x32_bf16 v[64:67], v[152:155], a[184:187], v[64:67]
    v_mfma_f32_16x16x32_bf16 v[64:67], v[156:159], a[196:199], v[64:67]
    v_mfma_f32_16x16x32_bf16 v[68:71], v[144:147], a[164:167], 0
    v_mfma_f32_16x16x32_bf16 v[68:71], v[148:151], a[176:179], v[68:71]
    v_mfma_f32_16x16x32_bf16 v[68:71], v[152:155], a[188:191], v[68:71]
    v_mfma_f32_16x16x32_bf16 v[68:71], v[156:159], a[200:203], v[68:71]
    v_mfma_f32_16x16x32_bf16 v[72:75], v[144:147], a[168:171], 0
    v_mfma_f32_16x16x32_bf16 v[72:75], v[148:151], a[180:183], v[72:75]
    v_mfma_f32_16x16x32_bf16 v[72:75], v[152:155], a[192:195], v[72:75]
    v_mfma_f32_16x16x32_bf16 v[72:75], v[156:159], a[204:207], v[72:75]
    v_mfma_f32_16x16x32_bf16 v[76:79], v[160:163], a[160:163], 0
    v_mfma_f32_16x16x32_bf16 v[76:79], v[164:167], a[172:175], v[76:79]
    v_mfma_f32_16x16x32_bf16 v[76:79], v[168:171], a[184:187], v[76:79]
    v_mfma_f32_16x16x32_bf16 v[76:79], v[172:175], a[196:199], v[76:79]
    v_mfma_f32_16x16x32_bf16 v[80:83], v[160:163], a[164:167], 0
    v_mfma_f32_16x16x32_bf16 v[80:83], v[164:167], a[176:179], v[80:83]
    v_mfma_f32_16x16x32_bf16 v[80:83], v[168:171], a[188:191], v[80:83]
    v_mfma_f32_16x16x32_bf16 v[80:83], v[172:175], a[200:203], v[80:83]
    v_mfma_f32_16x16x32_bf16 v[84:87], v[160:163], a[168:171], 0
    v_mfma_f32_16x16x32_bf16 v[84:87], v[164:167], a[180:183], v[84:87]
    v_mfma_f32_16x16x32_bf16 v[84:87], v[168:171], a[192:195], v[84:87]
    v_mfma_f32_16x16x32_bf16 v[84:87], v[172:175], a[204:207], v[84:87]
    s_nop 7
    v_cvt_pk_bf16_f32 v208, v64, v65
    v_cvt_pk_bf16_f32 v209, v66, v67
    v_cvt_pk_bf16_f32 v210, v76, v77
    v_cvt_pk_bf16_f32 v211, v78, v79
    v_cvt_pk_bf16_f32 v212, v68, v69
    v_cvt_pk_bf16_f32 v213, v70, v71
    v_cvt_pk_bf16_f32 v214, v80, v81
    v_cvt_pk_bf16_f32 v215, v82, v83
    v_cvt_pk_bf16_f32 v216, v72, v73
    v_cvt_pk_bf16_f32 v217, v74, v75
    v_cvt_pk_bf16_f32 v218, v84, v85
    v_cvt_pk_bf16_f32 v219, v86, v87
    s_mov_b32 s18, 0
    s_mov_b32 s52, 0
    v_and_b32 v6, 15, v1
    v_lshrrev_b32 v7, 4, v1
    v_mov_b32 v2, 0xeeee
    v_mov_b32 v3, 0x4444
    v_cndmask_b32 v125, v2, v3, s[30:31]
    v_and_b32 v2, 1, v7
    v_lshlrev_b32 v2, 2, v2
    v_sub_u32 v2, v6, v2
    v_and_b32 v3, 1, v2
    v_lshlrev_b32 v3, 4, v3
    v_mov_b32 v4, 0x3f80
    v_lshlrev_b32 v4, v3, v4
    v_lshrrev_b32 v5, 1, v2
    v_cmp_eq_u32 vcc, 0, v5
    s_nop 1
    v_cndmask_b32 v3, 0, v4, vcc
    v_accvgpr_write_b32 a248, v3
    v_cmp_eq_u32 vcc, 1, v5
    s_nop 1
    v_cndmask_b32 v3, 0, v4, vcc
    v_accvgpr_write_b32 a249, v3
    v_mov_b32 v108, -1
    v_mov_b32 v109, -1
    v_mov_b32 v110, -1
    v_mov_b32 v111, -1
    s_barrier
    s_cmp_eq_u32 s43, 0
    s_cbranch_scc1 CH_slowloop
CH_top26:
    s_and_b32 s15, s18, 3
    s_lshl_b32 s20, s15, 14
    s_add_u32 s21, s20, 6144
    s_add_u32 s22, s20, 9216
    s_lshl_b32 s25, s15, 15
    s_mul_i32 s27, s15, 163840
    s_add_u32 s15, s18, 1
    s_lshl_b32 s29, s15, 13
    s_and_b32 s15, s15, 3
    s_lshl_b32 s23, s15, 14
    s_add_u32 s15, s18, 2
    s_lshl_b32 s45, s15, 13
    s_and_b32 s15, s15, 3
    s_lshl_b32 s26, s15, 15
    s_mul_i32 s28, s15, 163840
    s_add_u32 s15, s18, 3
    s_and_b32 s15, s15, 3
    s_lshl_b32 s24, s15, 14
    s_lshl_b32 s38, s18, 17
    s_lshl_b32 s39, s18, 16
    buffer_load_dwordx4 v[144:147], v21, s[4:7], s29 offen offset:0
    buffer_load_dwordx4 v[148:151], v21, s[4:7], s29 offen offset:1024
    s_cmp_eq_u32 s18, 0
    s_cbranch_scc1 CH_stage27
    s_cmp_eq_u32 s14, 3
    s_cbranch_scc1 CH_e1skip31
    s_mov_b32 s41, 0
    s_sleep 3
CH_e1poll28:
    buffer_load_dwordx4 v[40:43], v10, s[4:7], s20 offen sc1
    buffer_load_dwordx4 v[44:47], v10, s[4:7], s20 offen offset:3072 sc1
    buffer_load_dwordx4 v[48:51], v10, s[4:7], s21 offen sc1
    s_cmp_lg_u32 s14, 0
    s_cbranch_scc1 CH_e1two30
    buffer_load_dwordx4 v[56:59], v10, s[4:7], s22 offen sc1
CH_e1two30:
    s_waitcnt vmcnt(0)
    v_max3_u32 v2, v40, v41, v42
    v_max3_u32 v2, v2, v43, v44
    v_max3_u32 v2, v2, v45, v46
    v_max3_u32 v2, v2, v47, v48
    v_max3_u32 v2, v2, v49, v50
    v_max3_u32 v2, v2, v51, v56
    v_max3_u32 v2, v2, v57, v58
    v_max_u32 v2, v2, v59
    v_cmp_eq_u32 vcc, -1, v2
    s_cbranch_vccz CH_e1ok29
    s_add_u32 s41, s41, 1
    s_cmp_lt_u32 s41, 524288
    s_cbranch_scc1 CH_e1poll28
    s_branch CH_abort
CH_e1ok29:
CH_stage27:
    s_cmp_eq_u32 s14, 3
    s_cbranch_scc1 CH_e1skip31
    ds_write_b128 v11, v[40:43]
    ds_write_b128 v11, v[44:47] offset:3072
    ds_write_b128 v11, v[48:51] offset:6144
    s_cmp_lg_u32 s14, 0
    s_cbranch_scc1 CH_n332
    ds_write_b128 v11, v[56:59] offset:9216
CH_n332:
CH_e1skip31:
    s_waitcnt lgkmcnt(0)
    s_barrier
    ds_read_b128 v[64:67], v12 offset:0
    ds_read_b128 v[68:71], v12 offset:1024
    ds_read_b128 v[72:75], v12 offset:2048
    ds_read_b128 v[76:79], v12 offset:3072
    ds_read_b128 v[80:83], v12 offset:4096
    ds_read_b128 v[84:87], v12 offset:5120
    ds_read_b128 v[88:91], v12 offset:6144
    ds_read_b128 v[92:95], v12 offset:7168
    ds_read_b128 v[96:99], v12 offset:8192
    ds_read_b128 v[100:103], v12 offset:9216
    v_mov_b32 v36, 0
    v_mov_b32 v37, 0
    v_mov_b32 v38, 0
    v_mov_b32 v39, 0
    buffer_load_dwordx4 v[152:155], v21, s[4:7], s29 offen offset:2048
    s_waitcnt lgkmcnt(9)
    v_smfmac_f32_16x16x64_bf16 v[36:39], v[64:67], a[0:7], v125
    s_waitcnt lgkmcnt(8)
    v_smfmac_f32_16x16x64_bf16 v[36:39], v[68:71], a[8:15], v125
    s_waitcnt lgkmcnt(7)
    v_smfmac_f32_16x16x64_bf16 v[36:39], v[72:75], a[16:23], v125
    s_waitcnt lgkmcnt(6)
    v_smfmac_f32_16x16x64_bf16 v[36:39], v[76:79], a[24:31], v125
    buffer_load_dwordx4 v[156:159], v21, s[4:7], s29 offen offset:3072
    s_waitcnt lgkmcnt(5)
    v_smfmac_f32_16x16x64_bf16 v[36:39], v[80:83], a[32:39], v125
    s_waitcnt lgkmcnt(4)
    v_smfmac_f32_16x16x64_bf16 v[36:39], v[84:87], a[40:47], v125
    s_waitcnt lgkmcnt(3)
    v_smfmac_f32_16x16x64_bf16 v[36:39], v[88:91], a[48:55], v125
    s_waitcnt lgkmcnt(2)
    v_smfmac_f32_16x16x64_bf16 v[36:39], v[92:95], a[56:63], v125
    buffer_load_dwordx4 v[160:163], v22, s[4:7], s29 offen offset:0
    s_waitcnt lgkmcnt(1)
    v_smfmac_f32_16x16x64_bf16 v[36:39], v[96:99], a[64:71], v125
    s_waitcnt lgkmcnt(0)
    v_smfmac_f32_16x16x64_bf16 v[36:39], v[100:103], a[72:79], v125
    s_nop 7
    v_cvt_pk_bf16_f32 v104, v36, v37
    v_cvt_pk_bf16_f32 v105, v38, v39
    s_nop 1
    v_mfma_f32_16x16x16_bf16 v[36:39], v[104:105], a[248:249], 0
    s_nop 7
    v_cvt_pk_bf16_f32 v2, v36, v37
    v_cvt_pk_bf16_f32 v3, v38, v39
    v_min_u32 v2, s44, v2
    v_min_u32 v3, s44, v3
    s_mov_b64 exec, s[30:31]
    buffer_store_dwordx2 v[2:3], v13, s[4:7], s25 offen
    buffer_store_dwordx2 v[30:31], v13, s[4:7], s26 offen
    s_cmp_lt_u32 s14, 2
    s_cbranch_scc1 CH_w0133
    s_mov_b64 exec, -1
    v_mov_b32 v112, v2
    v_mov_b32 v113, v3
    v_mov_b32 v36, 0
    v_mov_b32 v37, 0
    v_mov_b32 v38, 0
    v_mov_b32 v39, 0
    s_nop 1
    v_smfmac_f32_16x16x64_bf16 v[36:39], v[64:67], a[80:87], v125
    v_smfmac_f32_16x16x64_bf16 v[36:39], v[68:71], a[88:95], v125
    buffer_load_dwordx4 v[164:167], v22, s[4:7], s29 offen offset:1024
    v_smfmac_f32_16x16x64_bf16 v[36:39], v[72:75], a[96:103], v125
    v_smfmac_f32_16x16x64_bf16 v[36:39], v[76:79], a[104:111], v125
    v_smfmac_f32_16x16x64_bf16 v[36:39], v[80:83], a[112:119], v125
    buffer_load_dwordx4 v[168:171], v22, s[4:7], s29 offen offset:2048
    v_smfmac_f32_16x16x64_bf16 v[36:39], v[84:87], a[120:127], v125
    v_smfmac_f32_16x16x64_bf16 v[36:39], v[88:91], a[128:135], v125
    v_smfmac_f32_16x16x64_bf16 v[36:39], v[92:95], a[136:143], v125
    buffer_load_dwordx4 v[172:175], v22, s[4:7], s29 offen offset:3072
    v_smfmac_f32_16x16x64_bf16 v[36:39], v[96:99], a[144:151], v125
    v_smfmac_f32_16x16x64_bf16 v[36:39], v[100:103], a[152:159], v125
    s_nop 7
    v_cvt_pk_bf16_f32 v104, v36, v37
    v_cvt_pk_bf16_f32 v105, v38, v39
    s_nop 1
    v_mfma_f32_16x16x16_bf16 v[36:39], v[104:105], a[248:249], 0
    s_nop 7
    v_cvt_pk_bf16_f32 v4, v36, v37
    v_cvt_pk_bf16_f32 v5, v38, v39
    v_min_u32 v4, s44, v4
    v_min_u32 v5, s44, v5
    s_mov_b64 exec, s[30:31]
    buffer_store_dwordx2 v[4:5], v14, s[4:7], s25 offen
    buffer_store_dwordx2 v[30:31], v14, s[4:7], s26 offen
    s_mov_b64 exec, -1
    v_mov_b32 v114, v4
    v_mov_b32 v115, v5
    buffer_load_dwordx4 v[176:179], v17, s[4:7], s25 offen offset:0 sc1
    buffer_load_dwordx4 v[180:183], v17, s[4:7], s25 offen offset:1024 sc1
    buffer_load_dwordx4 v[184:187], v17, s[4:7], s25 offen offset:2048 sc1
    buffer_load_dwordx4 v[188:191], v17, s[4:7], s25 offen offset:3072 sc1
    s_cmp_ge_u32 s18, 63
    s_cbranch_scc1 CH_last2335
    s_mov_b32 s41, 0
    s_waitcnt vmcnt(3)
    v_mfma_f32_16x16x32_bf16 v[226:229], v[176:179], v[176:179], v[32:35]
    v_mfma_f32_16x16x32_bf16 v[230:233], a[208:211], v[176:179], 0
    v_mfma_f32_16x16x32_bf16 v[234:237], a[224:227], v[176:179], 0
    s_waitcnt vmcnt(2)
    v_mfma_f32_16x16x32_bf16 v[226:229], v[180:183], v[180:183], v[226:229]
    v_mfma_f32_16x16x32_bf16 v[230:233], a[212:215], v[180:183], v[230:233]
    v_mfma_f32_16x16x32_bf16 v[234:237], a[228:231], v[180:183], v[234:237]
    s_waitcnt vmcnt(1)
    v_mfma_f32_16x16x32_bf16 v[226:229], v[184:187], v[184:187], v[226:229]
    v_mfma_f32_16x16x32_bf16 v[230:233], a[216:219], v[184:187], v[230:233]
    v_mfma_f32_16x16x32_bf16 v[234:237], a[232:235], v[184:187], v[234:237]
    s_waitcnt vmcnt(0)
    v_mfma_f32_16x16x32_bf16 v[226:229], v[188:191], v[188:191], v[226:229]
    v_mfma_f32_16x16x32_bf16 v[230:233], a[220:223], v[188:191], v[230:233]
    v_mfma_f32_16x16x32_bf16 v[234:237], a[236:239], v[188:191], v[234:237]
    v_max3_u32 v2, v176, v177, v178
    v_max3_u32 v2, v2, v179, v180
    v_max3_u32 v2, v2, v181, v182
    v_max3_u32 v2, v2, v183, v184
    v_max3_u32 v2, v2, v185, v186
    v_max3_u32 v2, v2, v187, v188
    v_max3_u32 v2, v2, v189, v190
    v_max_u32 v2, v2, v191
    v_cmp_eq_u32 vcc, -1, v2
    s_cbranch_vccz CH_e2ok38
    s_branch CH_e2poll39
CH_w0133:
    s_mov_b64 exec, -1
    buffer_load_dwordx4 v[164:167], v22, s[4:7], s29 offen offset:1024
    buffer_load_dwordx4 v[168:171], v22, s[4:7], s29 offen offset:2048
    buffer_load_dwordx4 v[172:175], v22, s[4:7], s29 offen offset:3072
    s_sleep 4
    s_cmp_ge_u32 s18, 63
    s_cbranch_scc1 CH_bd40
    s_mov_b32 s41, 0
    buffer_load_dwordx4 v[176:179], v17, s[4:7], s25 offen offset:0 sc1
    buffer_load_dwordx4 v[180:183], v17, s[4:7], s25 offen offset:1024 sc1
    buffer_load_dwordx4 v[184:187], v17, s[4:7], s25 offen offset:2048 sc1
    buffer_load_dwordx4 v[188:191], v17, s[4:7], s25 offen offset:3072 sc1
    s_waitcnt vmcnt(3)
    v_mfma_f32_16x16x32_bf16 v[226:229], v[176:179], v[176:179], v[32:35]
    v_mfma_f32_16x16x32_bf16 v[230:233], a[208:211], v[176:179], 0
    v_mfma_f32_16x16x32_bf16 v[234:237], a[224:227], v[176:179], 0
    s_waitcnt vmcnt(2)
    v_mfma_f32_16x16x32_bf16 v[226:229], v[180:183], v[180:183], v[226:229]
    v_mfma_f32_16x16x32_bf16 v[230:233], a[212:215], v[180:183], v[230:233]
    v_mfma_f32_16x16x32_bf16 v[234:237], a[228:231], v[180:183], v[234:237]
    s_waitcnt vmcnt(1)
    v_mfma_f32_16x16x32_bf16 v[226:229], v[184:187], v[184:187], v[226:229]
    v_mfma_f32_16x16x32_bf16 v[230:233], a[216:219], v[184:187], v[230:233]
    v_mfma_f32_16x16x32_bf16 v[234:237], a[232:235], v[184:187], v[234:237]
    s_waitcnt vmcnt(0)
    v_mfma_f32_16x16x32_bf16 v[226:229], v[188:191], v[188:191], v[226:229]
    v_mfma_f32_16x16x32_bf16 v[230:233], a[220:223], v[188:191], v[230:233]
    v_mfma_f32_16x16x32_bf16 v[234:237], a[236:239], v[188:191], v[234:237]
    v_max3_u32 v2, v176, v177, v178
    v_max3_u32 v2, v2, v179, v180
    v_max3_u32 v2, v2, v181, v182
    v_max3_u32 v2, v2, v183, v184
    v_max3_u32 v2, v2, v185, v186
    v_max3_u32 v2, v2, v187, v188
    v_max3_u32 v2, v2, v189, v190
    v_max_u32 v2, v2, v191
    v_cmp_eq_u32 vcc, -1, v2
    s_cbranch_vccz CH_e2ok38
CH_e2poll39:
    buffer_load_dwordx4 v[176:179], v17, s[4:7], s25 offen offset:0 sc1
    buffer_load_dwordx4 v[180:183], v17, s[4:7], s25 offen offset:1024 sc1
    buffer_load_dwordx4 v[184:187], v17, s[4:7], s25 offen offset:2048 sc1
    buffer_load_dwordx4 v[188:191], v17, s[4:7], s25 offen offset:3072 sc1
    s_waitcnt vmcnt(3)
    v_mfma_f32_16x16x32_bf16 v[226:229], v[176:179], v[176:179], v[32:35]
    v_mfma_f32_16x16x32_bf16 v[230:233], a[208:211], v[176:179], 0
    v_mfma_f32_16x16x32_bf16 v[234:237], a[224:227], v[176:179], 0
    s_waitcnt vmcnt(2)
    v_mfma_f32_16x16x32_bf16 v[226:229], v[180:183], v[180:183], v[226:229]
    v_mfma_f32_16x16x32_bf16 v[230:233], a[212:215], v[180:183], v[230:233]
    v_mfma_f32_16x16x32_bf16 v[234:237], a[228:231], v[180:183], v[234:237]
    s_waitcnt vmcnt(1)
    v_mfma_f32_16x16x32_bf16 v[226:229], v[184:187], v[184:187], v[226:229]
    v_mfma_f32_16x16x32_bf16 v[230:233], a[216:219], v[184:187], v[230:233]
    v_mfma_f32_16x16x32_bf16 v[234:237], a[232:235], v[184:187], v[234:237]
    s_waitcnt vmcnt(0)
    v_mfma_f32_16x16x32_bf16 v[226:229], v[188:191], v[188:191], v[226:229]
    v_mfma_f32_16x16x32_bf16 v[230:233], a[220:223], v[188:191], v[230:233]
    v_mfma_f32_16x16x32_bf16 v[234:237], a[236:239], v[188:191], v[234:237]
    v_max3_u32 v2, v176, v177, v178
    v_max3_u32 v2, v2, v179, v180
    v_max3_u32 v2, v2, v181, v182
    v_max3_u32 v2, v2, v183, v184
    v_max3_u32 v2, v2, v185, v186
    v_max3_u32 v2, v2, v187, v188
    v_max3_u32 v2, v2, v189, v190
    v_max_u32 v2, v2, v191
    v_cmp_eq_u32 vcc, -1, v2
    s_cbranch_vccz CH_e2ok38
    s_add_u32 s41, s41, 1
    s_cmp_lt_u32 s41, 524288
    s_cbranch_scc1 CH_e2poll39
    s_branch CH_abort
CH_e2ok38:
    buffer_load_dwordx4 v[192:195], v18, s[4:7], s25 offen offset:0 sc1
    buffer_load_dwordx4 v[196:199], v18, s[4:7], s25 offen offset:512 sc1
    buffer_load_dwordx4 v[200:203], v18, s[4:7], s25 offen offset:1024 sc1
    buffer_load_dwordx4 v[204:207], v18, s[4:7], s25 offen offset:1536 sc1
    v_readfirstlane_b32 s52, v126
    v_max3_f32 v2, v226, v227, v228
    v_max3_f32 v3, v229, v230, v231
    v_max3_f32 v4, v232, v233, v234
    v_max3_f32 v5, v235, v236, v237
    v_max3_f32 v2, v2, v3, v4
    v_max_f32 v2, v2, v5
    v_mov_b32 v3, v2
    s_nop 1
    v_permlane16_swap_b32 v2, v3
    v_max_f32 v2, v2, v3
    v_mov_b32 v3, v2
    s_nop 1
    v_permlane32_swap_b32 v2, v3
    v_max_f32 v2, v2, v3
    v_mul_f32 v2, s40, v2
    v_fma_f32 v226, v226, s40, -v2
    v_fma_f32 v227, v227, s40, -v2
    v_fma_f32 v228, v228, s40, -v2
    v_fma_f32 v229, v229, s40, -v2
    v_fma_f32 v230, v230, s40, -v2
    v_fma_f32 v231, v231, s40, -v2
    v_fma_f32 v232, v232, s40, -v2
    v_fma_f32 v233, v233, s40, -v2
    v_fma_f32 v234, v234, s40, -v2
    v_fma_f32 v235, v235, s40, -v2
    v_fma_f32 v236, v236, s40, -v2
    v_fma_f32 v237, v237, s40, -v2
    buffer_load_dwordx4 a[208:211], v19, s[4:7], s29 offen offset:0
    s_waitcnt vmcnt(4)
    v_mfma_f32_16x16x32_bf16 v[88:91], v[192:195], a[160:163], 0
    v_exp_f32 v226, v226
    v_mfma_f32_16x16x32_bf16 v[92:95], v[192:195], a[164:167], 0
    v_exp_f32 v227, v227
    v_mfma_f32_16x16x32_bf16 v[96:99], v[192:195], a[168:171], 0
    v_exp_f32 v228, v228
    s_waitcnt vmcnt(3)
    v_mfma_f32_16x16x32_bf16 v[88:91], v[196:199], a[172:175], v[88:91]
    v_exp_f32 v229, v229
    v_mfma_f32_16x16x32_bf16 v[92:95], v[196:199], a[176:179], v[92:95]
    v_exp_f32 v230, v230
    v_mfma_f32_16x16x32_bf16 v[96:99], v[196:199], a[180:183], v[96:99]
    v_exp_f32 v231, v231
    s_waitcnt vmcnt(2)
    v_mfma_f32_16x16x32_bf16 v[88:91], v[200:203], a[184:187], v[88:91]
    v_exp_f32 v232, v232
    v_mfma_f32_16x16x32_bf16 v[92:95], v[200:203], a[188:191], v[92:95]
    v_exp_f32 v233, v233
    v_mfma_f32_16x16x32_bf16 v[96:99], v[200:203], a[192:195], v[96:99]
    v_exp_f32 v234, v234
    s_waitcnt vmcnt(1)
    v_mfma_f32_16x16x32_bf16 v[88:91], v[204:207], a[196:199], v[88:91]
    v_exp_f32 v235, v235
    v_mfma_f32_16x16x32_bf16 v[92:95], v[204:207], a[200:203], v[92:95]
    v_exp_f32 v236, v236
    v_mfma_f32_16x16x32_bf16 v[96:99], v[204:207], a[204:207], v[96:99]
    v_exp_f32 v237, v237
    buffer_load_dwordx4 a[212:215], v19, s[4:7], s29 offen offset:1024
    v_cvt_pk_bf16_f32 v238, v230, v231
    v_cvt_pk_bf16_f32 v239, v232, v233
    v_cvt_pk_bf16_f32 v242, v226, v227
    v_cvt_pk_bf16_f32 v243, v228, v229
    v_cvt_pk_bf16_f32 v240, v234, v235
    v_cvt_pk_bf16_f32 v241, v236, v237
    s_nop 1
    v_mfma_f32_16x16x32_bf16 v[244:247], v[208:211], v[238:241], 0
    v_mfma_f32_16x16x32_bf16 v[248:251], v[212:215], v[238:241], 0
    v_mfma_f32_16x16x32_bf16 v[252:255], v[216:219], v[238:241], 0
    v_mfma_f32_16x16x32_bf16 v[226:229], a[244:247], v[238:241], 0
    s_mov_b32 s41, 0
    v_max3_u32 v2, v192, v193, v194
    v_max3_u32 v2, v2, v195, v196
    v_max3_u32 v2, v2, v197, v198
    v_max3_u32 v2, v2, v199, v200
    v_max3_u32 v2, v2, v201, v202
    v_max3_u32 v2, v2, v203, v204
    v_max3_u32 v2, v2, v205, v206
    v_max_u32 v2, v2, v207
    v_cmp_eq_u32 vcc, -1, v2
    s_cbranch_vccz CH_fvok42
CH_fvgo41:
    buffer_load_dwordx4 v[192:195], v18, s[4:7], s25 offen offset:0 sc1
    buffer_load_dwordx4 v[196:199], v18, s[4:7], s25 offen offset:512 sc1
    buffer_load_dwordx4 v[200:203], v18, s[4:7], s25 offen offset:1024 sc1
    buffer_load_dwordx4 v[204:207], v18, s[4:7], s25 offen offset:1536 sc1
    s_waitcnt vmcnt(0)
    s_waitcnt vmcnt(3)
    v_mfma_f32_16x16x32_bf16 v[88:91], v[192:195], a[160:163], 0
    v_mfma_f32_16x16x32_bf16 v[92:95], v[192:195], a[164:167], 0
    v_mfma_f32_16x16x32_bf16 v[96:99], v[192:195], a[168:171], 0
    s_waitcnt vmcnt(2)
    v_mfma_f32_16x16x32_bf16 v[88:91], v[196:199], a[172:175], v[88:91]
    v_mfma_f32_16x16x32_bf16 v[92:95], v[196:199], a[176:179], v[92:95]
    v_mfma_f32_16x16x32_bf16 v[96:99], v[196:199], a[180:183], v[96:99]
    s_waitcnt vmcnt(1)
    v_mfma_f32_16x16x32_bf16 v[88:91], v[200:203], a[184:187], v[88:91]
    v_mfma_f32_16x16x32_bf16 v[92:95], v[200:203], a[188:191], v[92:95]
    v_mfma_f32_16x16x32_bf16 v[96:99], v[200:203], a[192:195], v[96:99]
    s_waitcnt vmcnt(0)
    v_mfma_f32_16x16x32_bf16 v[88:91], v[204:207], a[196:199], v[88:91]
    v_mfma_f32_16x16x32_bf16 v[92:95], v[204:207], a[200:203], v[92:95]
    v_mfma_f32_16x16x32_bf16 v[96:99], v[204:207], a[204:207], v[96:99]
    v_max3_u32 v2, v192, v193, v194
    v_max3_u32 v2, v2, v195, v196
    v_max3_u32 v2, v2, v197, v198
    v_max3_u32 v2, v2, v199, v200
    v_max3_u32 v2, v2, v201, v202
    v_max3_u32 v2, v2, v203, v204
    v_max3_u32 v2, v2, v205, v206
    v_max_u32 v2, v2, v207
    v_cmp_eq_u32 vcc, -1, v2
    s_cbranch_vccz CH_fvok42
    s_add_u32 s41, s41, 1
    s_cmp_lt_u32 s41, 524288
    s_cbranch_scc1 CH_fvgo41
    s_branch CH_abort
CH_fvok42:
    v_mfma_f32_16x16x16_bf16 v[226:229], a[244:245], v[242:243], v[226:229]
    v_cvt_pk_bf16_f32 v220, v88, v89
    v_cvt_pk_bf16_f32 v221, v90, v91
    v_cvt_pk_bf16_f32 v222, v92, v93
    v_cvt_pk_bf16_f32 v223, v94, v95
    v_cvt_pk_bf16_f32 v224, v96, v97
    v_cvt_pk_bf16_f32 v225, v98, v99
    s_nop 1
    v_rcp_f32 v2, v226
    s_nop 0
    v_mfma_f32_16x16x16_bf16 v[244:247], v[220:221], v[242:243], v[244:247]
    v_mfma_f32_16x16x16_bf16 v[248:251], v[222:223], v[242:243], v[248:251]
    v_mfma_f32_16x16x16_bf16 v[252:255], v[224:225], v[242:243], v[252:255]
    buffer_load_dwordx4 a[216:219], v19, s[4:7], s29 offen offset:2048
    s_nop 4
    v_pk_mul_f32 v[244:245], v[244:245], v[2:3] op_sel_hi:[1,0]
    v_pk_mul_f32 v[246:247], v[246:247], v[2:3] op_sel_hi:[1,0]
    v_cvt_pk_bf16_f32 v230, v244, v245
    v_cvt_pk_bf16_f32 v231, v246, v247
    v_pk_mul_f32 v[248:249], v[248:249], v[2:3] op_sel_hi:[1,0]
    v_pk_mul_f32 v[250:251], v[250:251], v[2:3] op_sel_hi:[1,0]
    v_cvt_pk_bf16_f32 v232, v248, v249
    v_cvt_pk_bf16_f32 v233, v250, v251
    v_pk_mul_f32 v[252:253], v[252:253], v[2:3] op_sel_hi:[1,0]
    v_pk_mul_f32 v[254:255], v[254:255], v[2:3] op_sel_hi:[1,0]
    v_cvt_pk_bf16_f32 v234, v252, v253
    v_cvt_pk_bf16_f32 v235, v254, v255
    s_mov_b64 exec, s[30:31]
    ds_write_b64 v23, v[230:231] offset:0
    ds_write_b64 v23, v[232:233] offset:256
    ds_write_b64 v23, v[234:235] offset:512
    s_mov_b64 exec, -1
    s_cmp_lg_u32 s14, 2
    s_cbranch_scc1 CH_h243
    ds_write_b128 v127, v[112:115] offset:18432
CH_h243:
    buffer_load_dwordx4 a[220:223], v19, s[4:7], s29 offen offset:3072
    s_waitcnt lgkmcnt(0)
    s_barrier
    s_cmp_ge_u32 s14, 3
    s_cbranch_scc1 CH_w345
    ds_read_b128 v[176:179], v24
    s_waitcnt lgkmcnt(0)
    v_mfma_f32_16x16x32_bf16 v[60:63], a[240:243], v[176:179], 0
    s_nop 7
    v_cvt_pk_bf16_f32 v2, v60, v61
    v_cvt_pk_bf16_f32 v3, v62, v63
    v_min_u32 v2, s44, v2
    v_min_u32 v3, s44, v3
    s_mov_b64 exec, s[34:35]
    buffer_store_dwordx2 v[2:3], v25, s[4:7], s27 offen sc1
    buffer_store_dwordx2 v[30:31], v25, s[4:7], s28 offen sc1
    s_mov_b64 exec, -1
    v_mfma_f32_16x16x32_bf16 v[64:67], v[144:147], a[160:163], 0
    v_mfma_f32_16x16x32_bf16 v[64:67], v[148:151], a[172:175], v[64:67]
    buffer_load_dwordx4 a[224:227], v20, s[4:7], s29 offen offset:0
    v_mfma_f32_16x16x32_bf16 v[64:67], v[152:155], a[184:187], v[64:67]
    v_mfma_f32_16x16x32_bf16 v[64:67], v[156:159], a[196:199], v[64:67]
    v_mfma_f32_16x16x32_bf16 v[68:71], v[144:147], a[164:167], 0
    v_mfma_f32_16x16x32_bf16 v[68:71], v[148:151], a[176:179], v[68:71]
    buffer_load_dwordx4 a[228:231], v20, s[4:7], s29 offen offset:1024
    v_mfma_f32_16x16x32_bf16 v[68:71], v[152:155], a[188:191], v[68:71]
    v_mfma_f32_16x16x32_bf16 v[68:71], v[156:159], a[200:203], v[68:71]
    v_mfma_f32_16x16x32_bf16 v[72:75], v[144:147], a[168:171], 0
    v_mfma_f32_16x16x32_bf16 v[72:75], v[148:151], a[180:183], v[72:75]
    buffer_load_dwordx4 a[232:235], v20, s[4:7], s29 offen offset:2048
    v_mfma_f32_16x16x32_bf16 v[72:75], v[152:155], a[192:195], v[72:75]
    v_mfma_f32_16x16x32_bf16 v[72:75], v[156:159], a[204:207], v[72:75]
    v_mfma_f32_16x16x32_bf16 v[76:79], v[160:163], a[160:163], 0
    v_mfma_f32_16x16x32_bf16 v[76:79], v[164:167], a[172:175], v[76:79]
    buffer_load_dwordx4 a[236:239], v20, s[4:7], s29 offen offset:3072
    v_mfma_f32_16x16x32_bf16 v[76:79], v[168:171], a[184:187], v[76:79]
    v_mfma_f32_16x16x32_bf16 v[76:79], v[172:175], a[196:199], v[76:79]
    v_mfma_f32_16x16x32_bf16 v[80:83], v[160:163], a[164:167], 0
    v_mfma_f32_16x16x32_bf16 v[80:83], v[164:167], a[176:179], v[80:83]
    v_mfma_f32_16x16x32_bf16 v[80:83], v[168:171], a[188:191], v[80:83]
    v_mfma_f32_16x16x32_bf16 v[80:83], v[172:175], a[200:203], v[80:83]
    v_mfma_f32_16x16x32_bf16 v[84:87], v[160:163], a[168:171], 0
    v_mfma_f32_16x16x32_bf16 v[84:87], v[164:167], a[180:183], v[84:87]
    v_mfma_f32_16x16x32_bf16 v[84:87], v[168:171], a[192:195], v[84:87]
    v_mfma_f32_16x16x32_bf16 v[84:87], v[172:175], a[204:207], v[84:87]
    s_nop 7
    v_cvt_pk_bf16_f32 v208, v64, v65
    v_cvt_pk_bf16_f32 v209, v66, v67
    v_cvt_pk_bf16_f32 v210, v76, v77
    v_cvt_pk_bf16_f32 v211, v78, v79
    v_cvt_pk_bf16_f32 v212, v68, v69
    v_cvt_pk_bf16_f32 v213, v70, v71
    v_cvt_pk_bf16_f32 v214, v80, v81
    v_cvt_pk_bf16_f32 v215, v82, v83
    v_cvt_pk_bf16_f32 v216, v72, v73
    v_cvt_pk_bf16_f32 v217, v74, v75
    v_cvt_pk_bf16_f32 v218, v84, v85
    v_cvt_pk_bf16_f32 v219, v86, v87
    s_sleep 5
    buffer_load_dwordx4 v[52:55], v26, s[4:7], s27 offen sc1
    buffer_load_dwordx4 v[56:59], v27, s[4:7], s27 offen sc1
    s_mov_b32 s41, 0
    s_waitcnt vmcnt(0)
    v_max3_u32 v2, v52, v53, v54
    v_max3_u32 v2, v2, v55, v56
    v_max3_u32 v2, v2, v57, v58
    v_max_u32 v2, v2, v59
    v_cmp_eq_u32 vcc, -1, v2
    s_cbranch_vccz CH_e3ok47
CH_e3poll46:
    buffer_load_dwordx4 v[52:55], v26, s[4:7], s27 offen sc1
    buffer_load_dwordx4 v[56:59], v27, s[4:7], s27 offen sc1
    s_waitcnt vmcnt(0)
    v_max3_u32 v2, v52, v53, v54
    v_max3_u32 v2, v2, v55, v56
    v_max3_u32 v2, v2, v57, v58
    v_max_u32 v2, v2, v59
    v_cmp_eq_u32 vcc, -1, v2
    s_cbranch_vccz CH_e3ok47
    s_add_u32 s41, s41, 1
    s_cmp_lt_u32 s41, 524288
    s_cbranch_scc1 CH_e3poll46
    s_branch CH_abort
CH_e3ok47:
    v_mfma_f32_16x16x32_bf16 v[60:63], a[240:243], v[52:55], 0
    v_mfma_f32_16x16x32_bf16 v[60:63], a[240:243], v[56:59], v[60:63]
    s_nop 7
    v_cvt_pk_bf16_f32 v2, v60, v61
    v_cvt_pk_bf16_f32 v3, v62, v63
    v_min_u32 v2, s44, v2
    v_min_u32 v3, s44, v3
    s_mov_b64 exec, s[34:35]
    buffer_store_dwordx2 v[2:3], v28, s[4:7], s23 offen
    buffer_store_dwordx2 v[30:31], v28, s[4:7], s24 offen
    s_mov_b64 exec, -1
    s_branch CH_e48
CH_w345:
    s_cmp_eq_u32 s18, 0
    s_cbranch_scc1 CH_hp49
    s_sub_u32 s47, s18, 1
    s_lshl_b32 s47, s47, 10
    v_mov_b32 v2, 1
    v_mov_b32 v3, 1
    s_mov_b64 exec, 1
    buffer_store_dwordx2 v[2:3], v123, s[4:7], s47 offen sc1
    s_mov_b64 exec, -1
CH_hp49:
    ds_read_b128 v[100:103], v127 offset:18432
    v_mov_b32 v116, v112
    v_mov_b32 v117, v113
    v_mov_b32 v118, v112
    v_mov_b32 v119, v113
    s_nop 1
    v_permlane16_swap_b32 v116, v118
    v_permlane16_swap_b32 v117, v119
    s_mov_b64 exec, s[60:61]
    buffer_store_dwordx4 v[116:119], v15, s[4:7], s38 offen sc1
    s_mov_b64 exec, -1
    s_nop 1
    v_mov_b32 v116, v114
    v_mov_b32 v117, v115
    v_mov_b32 v118, v114
    v_mov_b32 v119, v115
    s_nop 1
    v_permlane16_swap_b32 v116, v118
    v_permlane16_swap_b32 v117, v119
    s_mov_b64 exec, s[60:61]
    buffer_store_dwordx4 v[116:119], v16, s[4:7], s39 offen sc1
    s_mov_b64 exec, -1
    s_nop 1
    s_waitcnt lgkmcnt(0)
    v_mov_b32 v116, v100
    v_mov_b32 v117, v101
    v_mov_b32 v118, v100
    v_mov_b32 v119, v101
    s_nop 1
    v_permlane16_swap_b32 v116, v118
    v_permlane16_swap_b32 v117, v119
    s_mov_b64 exec, s[60:61]
    buffer_store_dwordx4 v[116:119], v121, s[4:7], s38 offen sc1
    s_mov_b64 exec, -1
    s_nop 1
    v_mov_b32 v116, v102
    v_mov_b32 v117, v103
    v_mov_b32 v118, v102
    v_mov_b32 v119, v103
    s_nop 1
    v_permlane16_swap_b32 v116, v118
    v_permlane16_swap_b32 v117, v119
    s_mov_b64 exec, s[60:61]
    buffer_store_dwordx4 v[116:119], v122, s[4:7], s39 offen sc1
    s_mov_b64 exec, -1
    s_nop 1
    s_add_u32 s47, s18, 3
    s_cmp_gt_u32 s47, 63
    s_cbranch_scc1 CH_npf50
    s_cmp_ge_u32 s52, 4
    s_cbranch_scc1 CH_pf51
    s_lshl_b32 s48, s47, 2
    s_mov_b32 s41, 0
CH_kvw52:
    buffer_load_dword v2, v124, s[4:7], s48 offen sc1
    s_waitcnt vmcnt(0)
    s_nop 0
    v_readfirstlane_b32 s15, v2
    s_nop 3
    s_cmp_ge_u32 s15, 4
    s_cbranch_scc1 CH_kvok53
    s_sleep 2
    s_add_u32 s41, s41, 1
    s_cmp_lt_u32 s41, 524288
    s_cbranch_scc1 CH_kvw52
    s_branch CH_abort
CH_kvok53:
CH_pf51:
    s_mov_b64 exec, s[32:33]
    buffer_load_dword v9, v29, s[4:7], s45 offen
    s_mov_b64 exec, -1
CH_npf50:
    s_add_u32 s48, s18, 4
    s_min_u32 s48, s48, 63
    s_lshl_b32 s48, s48, 2
    buffer_load_dword v126, v124, s[4:7], s48 offen sc1
    v_mfma_f32_16x16x32_bf16 v[64:67], v[144:147], a[160:163], 0
    v_mfma_f32_16x16x32_bf16 v[64:67], v[148:151], a[172:175], v[64:67]
    v_mfma_f32_16x16x32_bf16 v[64:67], v[152:155], a[184:187], v[64:67]
    buffer_load_dwordx4 a[224:227], v20, s[4:7], s29 offen offset:0
    v_mfma_f32_16x16x32_bf16 v[64:67], v[156:159], a[196:199], v[64:67]
    v_mfma_f32_16x16x32_bf16 v[68:71], v[144:147], a[164:167], 0
    v_mfma_f32_16x16x32_bf16 v[68:71], v[148:151], a[176:179], v[68:71]
    v_mfma_f32_16x16x32_bf16 v[68:71], v[152:155], a[188:191], v[68:71]
    v_mfma_f32_16x16x32_bf16 v[68:71], v[156:159], a[200:203], v[68:71]
    v_mfma_f32_16x16x32_bf16 v[72:75], v[144:147], a[168:171], 0
    buffer_load_dwordx4 a[228:231], v20, s[4:7], s29 offen offset:1024
    v_mfma_f32_16x16x32_bf16 v[72:75], v[148:151], a[180:183], v[72:75]
    v_mfma_f32_16x16x32_bf16 v[72:75], v[152:155], a[192:195], v[72:75]
    v_mfma_f32_16x16x32_bf16 v[72:75], v[156:159], a[204:207], v[72:75]
    v_mfma_f32_16x16x32_bf16 v[76:79], v[160:163], a[160:163], 0
    v_mfma_f32_16x16x32_bf16 v[76:79], v[164:167], a[172:175], v[76:79]
    v_mfma_f32_16x16x32_bf16 v[76:79], v[168:171], a[184:187], v[76:79]
    buffer_load_dwordx4 a[232:235], v20, s[4:7], s29 offen offset:2048
    v_mfma_f32_16x16x32_bf16 v[76:79], v[172:175], a[196:199], v[76:79]
    v_mfma_f32_16x16x32_bf16 v[80:83], v[160:163], a[164:167], 0
    v_mfma_f32_16x16x32_bf16 v[80:83], v[164:167], a[176:179], v[80:83]
    v_mfma_f32_16x16x32_bf16 v[80:83], v[168:171], a[188:191], v[80:83]
    v_mfma_f32_16x16x32_bf16 v[80:83], v[172:175], a[200:203], v[80:83]
    v_mfma_f32_16x16x32_bf16 v[84:87], v[160:163], a[168:171], 0
    buffer_load_dwordx4 a[236:239], v20, s[4:7], s29 offen offset:3072
    v_mfma_f32_16x16x32_bf16 v[84:87], v[164:167], a[180:183], v[84:87]
    v_mfma_f32_16x16x32_bf16 v[84:87], v[168:171], a[192:195], v[84:87]
    v_mfma_f32_16x16x32_bf16 v[84:87], v[172:175], a[204:207], v[84:87]
    s_nop 7
    v_cvt_pk_bf16_f32 v208, v64, v65
    v_cvt_pk_bf16_f32 v209, v66, v67
    v_cvt_pk_bf16_f32 v210, v76, v77
    v_cvt_pk_bf16_f32 v211, v78, v79
    v_cvt_pk_bf16_f32 v212, v68, v69
    v_cvt_pk_bf16_f32 v213, v70, v71
    v_cvt_pk_bf16_f32 v214, v80, v81
    v_cvt_pk_bf16_f32 v215, v82, v83
    v_cvt_pk_bf16_f32 v216, v72, v73
    v_cvt_pk_bf16_f32 v217, v74, v75
    v_cvt_pk_bf16_f32 v218, v84, v85
    v_cvt_pk_bf16_f32 v219, v86, v87
CH_e48:
    s_add_u32 s18, s18, 1
    s_branch CH_top26
CH_bd40:
    s_barrier
    s_branch CH_done
CH_last2335:
    s_cmp_lg_u32 s14, 2
    s_cbranch_scc1 CH_l354
    ds_write_b128 v127, v[112:115] offset:18432
    s_waitcnt lgkmcnt(0)
    s_barrier
    s_branch CH_done
CH_l354:
    s_barrier
    s_cmp_eq_u32 s18, 0
    s_cbranch_scc1 CH_hp55
    s_sub_u32 s47, s18, 1
    s_lshl_b32 s47, s47, 10
    v_mov_b32 v2, 1
    v_mov_b32 v3, 1
    s_mov_b64 exec, 1
    buffer_store_dwordx2 v[2:3], v123, s[4:7], s47 offen sc1
    s_mov_b64 exec, -1
CH_hp55:
    ds_read_b128 v[100:103], v127 offset:18432
    v_mov_b32 v116, v112
    v_mov_b32 v117, v113
    v_mov_b32 v118, v112
    v_mov_b32 v119, v113
    s_nop 1
    v_permlane16_swap_b32 v116, v118
    v_permlane16_swap_b32 v117, v119
    s_mov_b64 exec, s[60:61]
    buffer_store_dwordx4 v[116:119], v15, s[4:7], s38 offen sc1
    s_mov_b64 exec, -1
    s_nop 1
    v_mov_b32 v116, v114
    v_mov_b32 v117, v115
    v_mov_b32 v118, v114
    v_mov_b32 v119, v115
    s_nop 1
    v_permlane16_swap_b32 v116, v118
    v_permlane16_swap_b32 v117, v119
    s_mov_b64 exec, s[60:61]
    buffer_store_dwordx4 v[116:119], v16, s[4:7], s39 offen sc1
    s_mov_b64 exec, -1
    s_nop 1
    s_waitcnt lgkmcnt(0)
    v_mov_b32 v116, v100
    v_mov_b32 v117, v101
    v_mov_b32 v118, v100
    v_mov_b32 v119, v101
    s_nop 1
    v_permlane16_swap_b32 v116, v118
    v_permlane16_swap_b32 v117, v119
    s_mov_b64 exec, s[60:61]
    buffer_store_dwordx4 v[116:119], v121, s[4:7], s38 offen sc1
    s_mov_b64 exec, -1
    s_nop 1
    v_mov_b32 v116, v102
    v_mov_b32 v117, v103
    v_mov_b32 v118, v102
    v_mov_b32 v119, v103
    s_nop 1
    v_permlane16_swap_b32 v116, v118
    v_permlane16_swap_b32 v117, v119
    s_mov_b64 exec, s[60:61]
    buffer_store_dwordx4 v[116:119], v122, s[4:7], s39 offen sc1
    s_mov_b64 exec, -1
    s_nop 1
    s_waitcnt vmcnt(0)
    s_lshl_b32 s47, s18, 10
    v_mov_b32 v2, 1
    v_mov_b32 v3, 1
    s_mov_b64 exec, 1
    buffer_store_dwordx2 v[2:3], v123, s[4:7], s47 offen sc1
    s_mov_b64 exec, -1
    s_branch CH_done
CH_slowloop:
CH_top56:
    s_and_b32 s15, s18, 3
    s_lshl_b32 s20, s15, 14
    s_add_u32 s21, s20, 6144
    s_add_u32 s22, s20, 9216
    s_lshl_b32 s25, s15, 15
    s_mul_i32 s27, s15, 163840
    s_add_u32 s15, s18, 1
    s_lshl_b32 s29, s15, 13
    s_and_b32 s15, s15, 3
    s_lshl_b32 s23, s15, 14
    s_add_u32 s15, s18, 2
    s_lshl_b32 s45, s15, 13
    s_and_b32 s15, s15, 3
    s_lshl_b32 s26, s15, 15
    s_mul_i32 s28, s15, 163840
    s_add_u32 s15, s18, 3
    s_and_b32 s15, s15, 3
    s_lshl_b32 s24, s15, 14
    s_lshl_b32 s38, s18, 17
    s_lshl_b32 s39, s18, 16
    buffer_load_dwordx4 v[144:147], v21, s[4:7], s29 offen offset:0
    buffer_load_dwordx4 v[148:151], v21, s[4:7], s29 offen offset:1024
    s_cmp_eq_u32 s18, 0
    s_cbranch_scc1 CH_stage57
    s_cmp_eq_u32 s14, 3
    s_cbranch_scc1 CH_e1skip61
    s_mov_b32 s41, 0
    s_sleep 3
CH_e1poll58:
    buffer_load_dwordx4 v[40:43], v10, s[4:7], s20 offen sc1
    buffer_load_dwordx4 v[44:47], v10, s[4:7], s20 offen offset:3072 sc1
    buffer_load_dwordx4 v[48:51], v10, s[4:7], s21 offen sc1
    s_cmp_lg_u32 s14, 0
    s_cbranch_scc1 CH_e1two60
    buffer_load_dwordx4 v[56:59], v10, s[4:7], s22 offen sc1
CH_e1two60:
    s_waitcnt vmcnt(0)
    v_max3_u32 v2, v40, v41, v42
    v_max3_u32 v2, v2, v43, v44
    v_max3_u32 v2, v2, v45, v46
    v_max3_u32 v2, v2, v47, v48
    v_max3_u32 v2, v2, v49, v50
    v_max3_u32 v2, v2, v51, v56
    v_max3_u32 v2, v2, v57, v58
    v_max_u32 v2, v2, v59
    v_cmp_eq_u32 vcc, -1, v2
    s_cbranch_vccz CH_e1ok59
    s_add_u32 s41, s41, 1
    s_cmp_lt_u32 s41, 524288
    s_cbranch_scc1 CH_e1poll58
    s_branch CH_abort
CH_e1ok59:
CH_stage57:
    s_cmp_eq_u32 s14, 3
    s_cbranch_scc1 CH_e1skip61
    ds_write_b128 v11, v[40:43]
    ds_write_b128 v11, v[44:47] offset:3072
    ds_write_b128 v11, v[48:51] offset:6144
    s_cmp_lg_u32 s14, 0
    s_cbranch_scc1 CH_n362
    ds_write_b128 v11, v[56:59] offset:9216
CH_n362:
CH_e1skip61:
    s_waitcnt lgkmcnt(0)
    s_barrier
    ds_read_b128 v[64:67], v12 offset:0
    ds_read_b128 v[68:71], v12 offset:1024
    ds_read_b128 v[72:75], v12 offset:2048
    ds_read_b128 v[76:79], v12 offset:3072
    ds_read_b128 v[80:83], v12 offset:4096
    ds_read_b128 v[84:87], v12 offset:5120
    ds_read_b128 v[88:91], v12 offset:6144
    ds_read_b128 v[92:95], v12 offset:7168
    ds_read_b128 v[96:99], v12 offset:8192
    ds_read_b128 v[100:103], v12 offset:9216
    v_mov_b32 v36, 0
    v_mov_b32 v37, 0
    v_mov_b32 v38, 0
    v_mov_b32 v39, 0
    buffer_load_dwordx4 v[152:155], v21, s[4:7], s29 offen offset:2048
    s_waitcnt lgkmcnt(9)
    v_smfmac_f32_16x16x64_bf16 v[36:39], v[64:67], a[0:7], v125
    s_waitcnt lgkmcnt(8)
    v_smfmac_f32_16x16x64_bf16 v[36:39], v[68:71], a[8:15], v125
    s_waitcnt lgkmcnt(7)
    v_smfmac_f32_16x16x64_bf16 v[36:39], v[72:75], a[16:23], v125
    s_waitcnt lgkmcnt(6)
    v_smfmac_f32_16x16x64_bf16 v[36:39], v[76:79], a[24:31], v125
    buffer_load_dwordx4 v[156:159], v21, s[4:7], s29 offen offset:3072
    s_waitcnt lgkmcnt(5)
    v_smfmac_f32_16x16x64_bf16 v[36:39], v[80:83], a[32:39], v125
    s_waitcnt lgkmcnt(4)
    v_smfmac_f32_16x16x64_bf16 v[36:39], v[84:87], a[40:47], v125
    s_waitcnt lgkmcnt(3)
    v_smfmac_f32_16x16x64_bf16 v[36:39], v[88:91], a[48:55], v125
    s_waitcnt lgkmcnt(2)
    v_smfmac_f32_16x16x64_bf16 v[36:39], v[92:95], a[56:63], v125
    buffer_load_dwordx4 v[160:163], v22, s[4:7], s29 offen offset:0
    s_waitcnt lgkmcnt(1)
    v_smfmac_f32_16x16x64_bf16 v[36:39], v[96:99], a[64:71], v125
    s_waitcnt lgkmcnt(0)
    v_smfmac_f32_16x16x64_bf16 v[36:39], v[100:103], a[72:79], v125
    s_nop 7
    v_cvt_pk_bf16_f32 v104, v36, v37
    v_cvt_pk_bf16_f32 v105, v38, v39
    s_nop 1
    v_mfma_f32_16x16x16_bf16 v[36:39], v[104:105], a[248:249], 0
    s_nop 7
    v_cvt_pk_bf16_f32 v2, v36, v37
    v_cvt_pk_bf16_f32 v3, v38, v39
    v_min_u32 v2, s44, v2
    v_min_u32 v3, s44, v3
    s_mov_b64 exec, s[30:31]
    buffer_store_dwordx2 v[2:3], v13, s[4:7], s25 offen sc1
    buffer_store_dwordx2 v[30:31], v13, s[4:7], s26 offen sc1
    s_cmp_lt_u32 s14, 2
    s_cbranch_scc1 CH_w0163
    s_mov_b64 exec, -1
    v_mov_b32 v112, v2
    v_mov_b32 v113, v3
    v_mov_b32 v36, 0
    v_mov_b32 v37, 0
    v_mov_b32 v38, 0
    v_mov_b32 v39, 0
    s_nop 1
    v_smfmac_f32_16x16x64_bf16 v[36:39], v[64:67], a[80:87], v125
    v_smfmac_f32_16x16x64_bf16 v[36:39], v[68:71], a[88:95], v125
    buffer_load_dwordx4 v[164:167], v22, s[4:7], s29 offen offset:1024
    v_smfmac_f32_16x16x64_bf16 v[36:39], v[72:75], a[96:103], v125
    v_smfmac_f32_16x16x64_bf16 v[36:39], v[76:79], a[104:111], v125
    v_smfmac_f32_16x16x64_bf16 v[36:39], v[80:83], a[112:119], v125
    buffer_load_dwordx4 v[168:171], v22, s[4:7], s29 offen offset:2048
    v_smfmac_f32_16x16x64_bf16 v[36:39], v[84:87], a[120:127], v125
    v_smfmac_f32_16x16x64_bf16 v[36:39], v[88:91], a[128:135], v125
    v_smfmac_f32_16x16x64_bf16 v[36:39], v[92:95], a[136:143], v125
    buffer_load_dwordx4 v[172:175], v22, s[4:7], s29 offen offset:3072
    v_smfmac_f32_16x16x64_bf16 v[36:39], v[96:99], a[144:151], v125
    v_smfmac_f32_16x16x64_bf16 v[36:39], v[100:103], a[152:159], v125
    s_nop 7
    v_cvt_pk_bf16_f32 v104, v36, v37
    v_cvt_pk_bf16_f32 v105, v38, v39
    s_nop 1
    v_mfma_f32_16x16x16_bf16 v[36:39], v[104:105], a[248:249], 0
    s_nop 7
    v_cvt_pk_bf16_f32 v4, v36, v37
    v_cvt_pk_bf16_f32 v5, v38, v39
    v_min_u32 v4, s44, v4
    v_min_u32 v5, s44, v5
    s_mov_b64 exec, s[30:31]
    buffer_store_dwordx2 v[4:5], v14, s[4:7], s25 offen sc1
    buffer_store_dwordx2 v[30:31], v14, s[4:7], s26 offen sc1
    s_mov_b64 exec, -1
    v_mov_b32 v114, v4
    v_mov_b32 v115, v5
    buffer_load_dwordx4 v[176:179], v17, s[4:7], s25 offen offset:0 sc1
    buffer_load_dwordx4 v[180:183], v17, s[4:7], s25 offen offset:1024 sc1
    buffer_load_dwordx4 v[184:187], v17, s[4:7], s25 offen offset:2048 sc1
    buffer_load_dwordx4 v[188:191], v17, s[4:7], s25 offen offset:3072 sc1
    s_cmp_ge_u32 s18, 63
    s_cbranch_scc1 CH_last2365
    s_mov_b32 s41, 0
    s_waitcnt vmcnt(3)
    v_mfma_f32_16x16x32_bf16 v[226:229], v[176:179], v[176:179], v[32:35]
    v_mfma_f32_16x16x32_bf16 v[230:233], a[208:211], v[176:179], 0
    v_mfma_f32_16x16x32_bf16 v[234:237], a[224:227], v[176:179], 0
    s_waitcnt vmcnt(2)
    v_mfma_f32_16x16x32_bf16 v[226:229], v[180:183], v[180:183], v[226:229]
    v_mfma_f32_16x16x32_bf16 v[230:233], a[212:215], v[180:183], v[230:233]
    v_mfma_f32_16x16x32_bf16 v[234:237], a[228:231], v[180:183], v[234:237]
    s_waitcnt vmcnt(1)
    v_mfma_f32_16x16x32_bf16 v[226:229], v[184:187], v[184:187], v[226:229]
    v_mfma_f32_16x16x32_bf16 v[230:233], a[216:219], v[184:187], v[230:233]
    v_mfma_f32_16x16x32_bf16 v[234:237], a[232:235], v[184:187], v[234:237]
    s_waitcnt vmcnt(0)
    v_mfma_f32_16x16x32_bf16 v[226:229], v[188:191], v[188:191], v[226:229]
    v_mfma_f32_16x16x32_bf16 v[230:233], a[220:223], v[188:191], v[230:233]
    v_mfma_f32_16x16x32_bf16 v[234:237], a[236:239], v[188:191], v[234:237]
    v_max3_u32 v2, v176, v177, v178
    v_max3_u32 v2, v2, v179, v180
    v_max3_u32 v2, v2, v181, v182
    v_max3_u32 v2, v2, v183, v184
    v_max3_u32 v2, v2, v185, v186
    v_max3_u32 v2, v2, v187, v188
    v_max3_u32 v2, v2, v189, v190
    v_max_u32 v2, v2, v191
    v_cmp_eq_u32 vcc, -1, v2
    s_cbranch_vccz CH_e2ok68
    s_branch CH_e2poll69
CH_w0163:
    s_mov_b64 exec, -1
    buffer_load_dwordx4 v[164:167], v22, s[4:7], s29 offen offset:1024
    buffer_load_dwordx4 v[168:171], v22, s[4:7], s29 offen offset:2048
    buffer_load_dwordx4 v[172:175], v22, s[4:7], s29 offen offset:3072
    s_sleep 4
    s_cmp_ge_u32 s18, 63
    s_cbranch_scc1 CH_bd70
    s_mov_b32 s41, 0
    buffer_load_dwordx4 v[176:179], v17, s[4:7], s25 offen offset:0 sc1
    buffer_load_dwordx4 v[180:183], v17, s[4:7], s25 offen offset:1024 sc1
    buffer_load_dwordx4 v[184:187], v17, s[4:7], s25 offen offset:2048 sc1
    buffer_load_dwordx4 v[188:191], v17, s[4:7], s25 offen offset:3072 sc1
    s_waitcnt vmcnt(3)
    v_mfma_f32_16x16x32_bf16 v[226:229], v[176:179], v[176:179], v[32:35]
    v_mfma_f32_16x16x32_bf16 v[230:233], a[208:211], v[176:179], 0
    v_mfma_f32_16x16x32_bf16 v[234:237], a[224:227], v[176:179], 0
    s_waitcnt vmcnt(2)
    v_mfma_f32_16x16x32_bf16 v[226:229], v[180:183], v[180:183], v[226:229]
    v_mfma_f32_16x16x32_bf16 v[230:233], a[212:215], v[180:183], v[230:233]
    v_mfma_f32_16x16x32_bf16 v[234:237], a[228:231], v[180:183], v[234:237]
    s_waitcnt vmcnt(1)
    v_mfma_f32_16x16x32_bf16 v[226:229], v[184:187], v[184:187], v[226:229]
    v_mfma_f32_16x16x32_bf16 v[230:233], a[216:219], v[184:187], v[230:233]
    v_mfma_f32_16x16x32_bf16 v[234:237], a[232:235], v[184:187], v[234:237]
    s_waitcnt vmcnt(0)
    v_mfma_f32_16x16x32_bf16 v[226:229], v[188:191], v[188:191], v[226:229]
    v_mfma_f32_16x16x32_bf16 v[230:233], a[220:223], v[188:191], v[230:233]
    v_mfma_f32_16x16x32_bf16 v[234:237], a[236:239], v[188:191], v[234:237]
    v_max3_u32 v2, v176, v177, v178
    v_max3_u32 v2, v2, v179, v180
    v_max3_u32 v2, v2, v181, v182
    v_max3_u32 v2, v2, v183, v184
    v_max3_u32 v2, v2, v185, v186
    v_max3_u32 v2, v2, v187, v188
    v_max3_u32 v2, v2, v189, v190
    v_max_u32 v2, v2, v191
    v_cmp_eq_u32 vcc, -1, v2
    s_cbranch_vccz CH_e2ok68
CH_e2poll69:
    buffer_load_dwordx4 v[176:179], v17, s[4:7], s25 offen offset:0 sc1
    buffer_load_dwordx4 v[180:183], v17, s[4:7], s25 offen offset:1024 sc1
    buffer_load_dwordx4 v[184:187], v17, s[4:7], s25 offen offset:2048 sc1
    buffer_load_dwordx4 v[188:191], v17, s[4:7], s25 offen offset:3072 sc1
    s_waitcnt vmcnt(3)
    v_mfma_f32_16x16x32_bf16 v[226:229], v[176:179], v[176:179], v[32:35]
    v_mfma_f32_16x16x32_bf16 v[230:233], a[208:211], v[176:179], 0
    v_mfma_f32_16x16x32_bf16 v[234:237], a[224:227], v[176:179], 0
    s_waitcnt vmcnt(2)
    v_mfma_f32_16x16x32_bf16 v[226:229], v[180:183], v[180:183], v[226:229]
    v_mfma_f32_16x16x32_bf16 v[230:233], a[212:215], v[180:183], v[230:233]
    v_mfma_f32_16x16x32_bf16 v[234:237], a[228:231], v[180:183], v[234:237]
    s_waitcnt vmcnt(1)
    v_mfma_f32_16x16x32_bf16 v[226:229], v[184:187], v[184:187], v[226:229]
    v_mfma_f32_16x16x32_bf16 v[230:233], a[216:219], v[184:187], v[230:233]
    v_mfma_f32_16x16x32_bf16 v[234:237], a[232:235], v[184:187], v[234:237]
    s_waitcnt vmcnt(0)
    v_mfma_f32_16x16x32_bf16 v[226:229], v[188:191], v[188:191], v[226:229]
    v_mfma_f32_16x16x32_bf16 v[230:233], a[220:223], v[188:191], v[230:233]
    v_mfma_f32_16x16x32_bf16 v[234:237], a[236:239], v[188:191], v[234:237]
    v_max3_u32 v2, v176, v177, v178
    v_max3_u32 v2, v2, v179, v180
    v_max3_u32 v2, v2, v181, v182
    v_max3_u32 v2, v2, v183, v184
    v_max3_u32 v2, v2, v185, v186
    v_max3_u32 v2, v2, v187, v188
    v_max3_u32 v2, v2, v189, v190
    v_max_u32 v2, v2, v191
    v_cmp_eq_u32 vcc, -1, v2
    s_cbranch_vccz CH_e2ok68
    s_add_u32 s41, s41, 1
    s_cmp_lt_u32 s41, 524288
    s_cbranch_scc1 CH_e2poll69
    s_branch CH_abort
CH_e2ok68:
    buffer_load_dwordx4 v[192:195], v18, s[4:7], s25 offen offset:0 sc1
    buffer_load_dwordx4 v[196:199], v18, s[4:7], s25 offen offset:512 sc1
    buffer_load_dwordx4 v[200:203], v18, s[4:7], s25 offen offset:1024 sc1
    buffer_load_dwordx4 v[204:207], v18, s[4:7], s25 offen offset:1536 sc1
    v_readfirstlane_b32 s52, v126
    v_max3_f32 v2, v226, v227, v228
    v_max3_f32 v3, v229, v230, v231
    v_max3_f32 v4, v232, v233, v234
    v_max3_f32 v5, v235, v236, v237
    v_max3_f32 v2, v2, v3, v4
    v_max_f32 v2, v2, v5
    v_mov_b32 v3, v2
    s_nop 1
    v_permlane16_swap_b32 v2, v3
    v_max_f32 v2, v2, v3
    v_mov_b32 v3, v2
    s_nop 1
    v_permlane32_swap_b32 v2, v3
    v_max_f32 v2, v2, v3
    v_mul_f32 v2, s40, v2
    v_fma_f32 v226, v226, s40, -v2
    v_fma_f32 v227, v227, s40, -v2
    v_fma_f32 v228, v228, s40, -v2
    v_fma_f32 v229, v229, s40, -v2
    v_fma_f32 v230, v230, s40, -v2
    v_fma_f32 v231, v231, s40, -v2
    v_fma_f32 v232, v232, s40, -v2
    v_fma_f32 v233, v233, s40, -v2
    v_fma_f32 v234, v234, s40, -v2
    v_fma_f32 v235, v235, s40, -v2
    v_fma_f32 v236, v236, s40, -v2
    v_fma_f32 v237, v237, s40, -v2
    buffer_load_dwordx4 a[208:211], v19, s[4:7], s29 offen offset:0
    s_waitcnt vmcnt(4)
    v_mfma_f32_16x16x32_bf16 v[88:91], v[192:195], a[160:163], 0
    v_exp_f32 v226, v226
    v_mfma_f32_16x16x32_bf16 v[92:95], v[192:195], a[164:167], 0
    v_exp_f32 v227, v227
    v_mfma_f32_16x16x32_bf16 v[96:99], v[192:195], a[168:171], 0
    v_exp_f32 v228, v228
    s_waitcnt vmcnt(3)
    v_mfma_f32_16x16x32_bf16 v[88:91], v[196:199], a[172:175], v[88:91]
    v_exp_f32 v229, v229
    v_mfma_f32_16x16x32_bf16 v[92:95], v[196:199], a[176:179], v[92:95]
    v_exp_f32 v230, v230
    v_mfma_f32_16x16x32_bf16 v[96:99], v[196:199], a[180:183], v[96:99]
    v_exp_f32 v231, v231
    s_waitcnt vmcnt(2)
    v_mfma_f32_16x16x32_bf16 v[88:91], v[200:203], a[184:187], v[88:91]
    v_exp_f32 v232, v232
    v_mfma_f32_16x16x32_bf16 v[92:95], v[200:203], a[188:191], v[92:95]
    v_exp_f32 v233, v233
    v_mfma_f32_16x16x32_bf16 v[96:99], v[200:203], a[192:195], v[96:99]
    v_exp_f32 v234, v234
    s_waitcnt vmcnt(1)
    v_mfma_f32_16x16x32_bf16 v[88:91], v[204:207], a[196:199], v[88:91]
    v_exp_f32 v235, v235
    v_mfma_f32_16x16x32_bf16 v[92:95], v[204:207], a[200:203], v[92:95]
    v_exp_f32 v236, v236
    v_mfma_f32_16x16x32_bf16 v[96:99], v[204:207], a[204:207], v[96:99]
    v_exp_f32 v237, v237
    buffer_load_dwordx4 a[212:215], v19, s[4:7], s29 offen offset:1024
    v_cvt_pk_bf16_f32 v238, v230, v231
    v_cvt_pk_bf16_f32 v239, v232, v233
    v_cvt_pk_bf16_f32 v242, v226, v227
    v_cvt_pk_bf16_f32 v243, v228, v229
    v_cvt_pk_bf16_f32 v240, v234, v235
    v_cvt_pk_bf16_f32 v241, v236, v237
    s_nop 1
    v_mfma_f32_16x16x32_bf16 v[244:247], v[208:211], v[238:241], 0
    v_mfma_f32_16x16x32_bf16 v[248:251], v[212:215], v[238:241], 0
    v_mfma_f32_16x16x32_bf16 v[252:255], v[216:219], v[238:241], 0
    v_mfma_f32_16x16x32_bf16 v[226:229], a[244:247], v[238:241], 0
    s_mov_b32 s41, 0
    v_max3_u32 v2, v192, v193, v194
    v_max3_u32 v2, v2, v195, v196
    v_max3_u32 v2, v2, v197, v198
    v_max3_u32 v2, v2, v199, v200
    v_max3_u32 v2, v2, v201, v202
    v_max3_u32 v2, v2, v203, v204
    v_max3_u32 v2, v2, v205, v206
    v_max_u32 v2, v2, v207
    v_cmp_eq_u32 vcc, -1, v2
    s_cbranch_vccz CH_fvok72
CH_fvgo71:
    buffer_load_dwordx4 v[192:195], v18, s[4:7], s25 offen offset:0 sc1
    buffer_load_dwordx4 v[196:199], v18, s[4:7], s25 offen offset:512 sc1
    buffer_load_dwordx4 v[200:203], v18, s[4:7], s25 offen offset:1024 sc1
    buffer_load_dwordx4 v[204:207], v18, s[4:7], s25 offen offset:1536 sc1
    s_waitcnt vmcnt(0)
    s_waitcnt vmcnt(3)
    v_mfma_f32_16x16x32_bf16 v[88:91], v[192:195], a[160:163], 0
    v_mfma_f32_16x16x32_bf16 v[92:95], v[192:195], a[164:167], 0
    v_mfma_f32_16x16x32_bf16 v[96:99], v[192:195], a[168:171], 0
    s_waitcnt vmcnt(2)
    v_mfma_f32_16x16x32_bf16 v[88:91], v[196:199], a[172:175], v[88:91]
    v_mfma_f32_16x16x32_bf16 v[92:95], v[196:199], a[176:179], v[92:95]
    v_mfma_f32_16x16x32_bf16 v[96:99], v[196:199], a[180:183], v[96:99]
    s_waitcnt vmcnt(1)
    v_mfma_f32_16x16x32_bf16 v[88:91], v[200:203], a[184:187], v[88:91]
    v_mfma_f32_16x16x32_bf16 v[92:95], v[200:203], a[188:191], v[92:95]
    v_mfma_f32_16x16x32_bf16 v[96:99], v[200:203], a[192:195], v[96:99]
    s_waitcnt vmcnt(0)
    v_mfma_f32_16x16x32_bf16 v[88:91], v[204:207], a[196:199], v[88:91]
    v_mfma_f32_16x16x32_bf16 v[92:95], v[204:207], a[200:203], v[92:95]
    v_mfma_f32_16x16x32_bf16 v[96:99], v[204:207], a[204:207], v[96:99]
    v_max3_u32 v2, v192, v193, v194
    v_max3_u32 v2, v2, v195, v196
    v_max3_u32 v2, v2, v197, v198
    v_max3_u32 v2, v2, v199, v200
    v_max3_u32 v2, v2, v201, v202
    v_max3_u32 v2, v2, v203, v204
    v_max3_u32 v2, v2, v205, v206
    v_max_u32 v2, v2, v207
    v_cmp_eq_u32 vcc, -1, v2
    s_cbranch_vccz CH_fvok72
    s_add_u32 s41, s41, 1
    s_cmp_lt_u32 s41, 524288
    s_cbranch_scc1 CH_fvgo71
    s_branch CH_abort
CH_fvok72:
    v_mfma_f32_16x16x16_bf16 v[226:229], a[244:245], v[242:243], v[226:229]
    v_cvt_pk_bf16_f32 v220, v88, v89
    v_cvt_pk_bf16_f32 v221, v90, v91
    v_cvt_pk_bf16_f32 v222, v92, v93
    v_cvt_pk_bf16_f32 v223, v94, v95
    v_cvt_pk_bf16_f32 v224, v96, v97
    v_cvt_pk_bf16_f32 v225, v98, v99
    s_nop 1
    v_rcp_f32 v2, v226
    s_nop 0
    v_mfma_f32_16x16x16_bf16 v[244:247], v[220:221], v[242:243], v[244:247]
    v_mfma_f32_16x16x16_bf16 v[248:251], v[222:223], v[242:243], v[248:251]
    v_mfma_f32_16x16x16_bf16 v[252:255], v[224:225], v[242:243], v[252:255]
    buffer_load_dwordx4 a[216:219], v19, s[4:7], s29 offen offset:2048
    s_nop 4
    v_pk_mul_f32 v[244:245], v[244:245], v[2:3] op_sel_hi:[1,0]
    v_pk_mul_f32 v[246:247], v[246:247], v[2:3] op_sel_hi:[1,0]
    v_cvt_pk_bf16_f32 v230, v244, v245
    v_cvt_pk_bf16_f32 v231, v246, v247
    v_pk_mul_f32 v[248:249], v[248:249], v[2:3] op_sel_hi:[1,0]
    v_pk_mul_f32 v[250:251], v[250:251], v[2:3] op_sel_hi:[1,0]
    v_cvt_pk_bf16_f32 v232, v248, v249
    v_cvt_pk_bf16_f32 v233, v250, v251
    v_pk_mul_f32 v[252:253], v[252:253], v[2:3] op_sel_hi:[1,0]
    v_pk_mul_f32 v[254:255], v[254:255], v[2:3] op_sel_hi:[1,0]
    v_cvt_pk_bf16_f32 v234, v252, v253
    v_cvt_pk_bf16_f32 v235, v254, v255
    s_mov_b64 exec, s[30:31]
    ds_write_b64 v23, v[230:231] offset:0
    ds_write_b64 v23, v[232:233] offset:256
    ds_write_b64 v23, v[234:235] offset:512
    s_mov_b64 exec, -1
    s_cmp_lg_u32 s14, 2
    s_cbranch_scc1 CH_h273
    ds_write_b128 v127, v[112:115] offset:18432
CH_h273:
    buffer_load_dwordx4 a[220:223], v19, s[4:7], s29 offen offset:3072
    s_waitcnt lgkmcnt(0)
    s_barrier
    s_cmp_ge_u32 s14, 3
    s_cbranch_scc1 CH_w375
    ds_read_b128 v[176:179], v24
    s_waitcnt lgkmcnt(0)
    v_mfma_f32_16x16x32_bf16 v[60:63], a[240:243], v[176:179], 0
    s_nop 7
    v_cvt_pk_bf16_f32 v2, v60, v61
    v_cvt_pk_bf16_f32 v3, v62, v63
    v_min_u32 v2, s44, v2
    v_min_u32 v3, s44, v3
    s_mov_b64 exec, s[34:35]
    buffer_store_dwordx2 v[2:3], v25, s[4:7], s27 offen sc1
    buffer_store_dwordx2 v[30:31], v25, s[4:7], s28 offen sc1
    s_mov_b64 exec, -1
    v_mfma_f32_16x16x32_bf16 v[64:67], v[144:147], a[160:163], 0
    v_mfma_f32_16x16x32_bf16 v[64:67], v[148:151], a[172:175], v[64:67]
    buffer_load_dwordx4 a[224:227], v20, s[4:7], s29 offen offset:0
    v_mfma_f32_16x16x32_bf16 v[64:67], v[152:155], a[184:187], v[64:67]
    v_mfma_f32_16x16x32_bf16 v[64:67], v[156:159], a[196:199], v[64:67]
    v_mfma_f32_16x16x32_bf16 v[68:71], v[144:147], a[164:167], 0
    v_mfma_f32_16x16x32_bf16 v[68:71], v[148:151], a[176:179], v[68:71]
    buffer_load_dwordx4 a[228:231], v20, s[4:7], s29 offen offset:1024
    v_mfma_f32_16x16x32_bf16 v[68:71], v[152:155], a[188:191], v[68:71]
    v_mfma_f32_16x16x32_bf16 v[68:71], v[156:159], a[200:203], v[68:71]
    v_mfma_f32_16x16x32_bf16 v[72:75], v[144:147], a[168:171], 0
    v_mfma_f32_16x16x32_bf16 v[72:75], v[148:151], a[180:183], v[72:75]
    buffer_load_dwordx4 a[232:235], v20, s[4:7], s29 offen offset:2048
    v_mfma_f32_16x16x32_bf16 v[72:75], v[152:155], a[192:195], v[72:75]
    v_mfma_f32_16x16x32_bf16 v[72:75], v[156:159], a[204:207], v[72:75]
    v_mfma_f32_16x16x32_bf16 v[76:79], v[160:163], a[160:163], 0
    v_mfma_f32_16x16x32_bf16 v[76:79], v[164:167], a[172:175], v[76:79]
    buffer_load_dwordx4 a[236:239], v20, s[4:7], s29 offen offset:3072
    v_mfma_f32_16x16x32_bf16 v[76:79], v[168:171], a[184:187], v[76:79]
    v_mfma_f32_16x16x32_bf16 v[76:79], v[172:175], a[196:199], v[76:79]
    v_mfma_f32_16x16x32_bf16 v[80:83], v[160:163], a[164:167], 0
    v_mfma_f32_16x16x32_bf16 v[80:83], v[164:167], a[176:179], v[80:83]
    v_mfma_f32_16x16x32_bf16 v[80:83], v[168:171], a[188:191], v[80:83]
    v_mfma_f32_16x16x32_bf16 v[80:83], v[172:175], a[200:203], v[80:83]
    v_mfma_f32_16x16x32_bf16 v[84:87], v[160:163], a[168:171], 0
    v_mfma_f32_16x16x32_bf16 v[84:87], v[164:167], a[180:183], v[84:87]
    v_mfma_f32_16x16x32_bf16 v[84:87], v[168:171], a[192:195], v[84:87]
    v_mfma_f32_16x16x32_bf16 v[84:87], v[172:175], a[204:207], v[84:87]
    s_nop 7
    v_cvt_pk_bf16_f32 v208, v64, v65
    v_cvt_pk_bf16_f32 v209, v66, v67
    v_cvt_pk_bf16_f32 v210, v76, v77
    v_cvt_pk_bf16_f32 v211, v78, v79
    v_cvt_pk_bf16_f32 v212, v68, v69
    v_cvt_pk_bf16_f32 v213, v70, v71
    v_cvt_pk_bf16_f32 v214, v80, v81
    v_cvt_pk_bf16_f32 v215, v82, v83
    v_cvt_pk_bf16_f32 v216, v72, v73
    v_cvt_pk_bf16_f32 v217, v74, v75
    v_cvt_pk_bf16_f32 v218, v84, v85
    v_cvt_pk_bf16_f32 v219, v86, v87
    s_sleep 5
    buffer_load_dwordx4 v[52:55], v26, s[4:7], s27 offen sc1
    buffer_load_dwordx4 v[56:59], v27, s[4:7], s27 offen sc1
    s_mov_b32 s41, 0
    s_waitcnt vmcnt(0)
    v_max3_u32 v2, v52, v53, v54
    v_max3_u32 v2, v2, v55, v56
    v_max3_u32 v2, v2, v57, v58
    v_max_u32 v2, v2, v59
    v_cmp_eq_u32 vcc, -1, v2
    s_cbranch_vccz CH_e3ok77
CH_e3poll76:
    buffer_load_dwordx4 v[52:55], v26, s[4:7], s27 offen sc1
    buffer_load_dwordx4 v[56:59], v27, s[4:7], s27 offen sc1
    s_waitcnt vmcnt(0)
    v_max3_u32 v2, v52, v53, v54
    v_max3_u32 v2, v2, v55, v56
    v_max3_u32 v2, v2, v57, v58
    v_max_u32 v2, v2, v59
    v_cmp_eq_u32 vcc, -1, v2
    s_cbranch_vccz CH_e3ok77
    s_add_u32 s41, s41, 1
    s_cmp_lt_u32 s41, 524288
    s_cbranch_scc1 CH_e3poll76
    s_branch CH_abort
CH_e3ok77:
    v_mfma_f32_16x16x32_bf16 v[60:63], a[240:243], v[52:55], 0
    v_mfma_f32_16x16x32_bf16 v[60:63], a[240:243], v[56:59], v[60:63]
    s_nop 7
    v_cvt_pk_bf16_f32 v2, v60, v61
    v_cvt_pk_bf16_f32 v3, v62, v63
    v_min_u32 v2, s44, v2
    v_min_u32 v3, s44, v3
    s_mov_b64 exec, s[34:35]
    buffer_store_dwordx2 v[2:3], v28, s[4:7], s23 offen sc1
    buffer_store_dwordx2 v[30:31], v28, s[4:7], s24 offen sc1
    s_mov_b64 exec, -1
    s_branch CH_e78
CH_w375:
    s_cmp_eq_u32 s18, 0
    s_cbranch_scc1 CH_hp79
    s_sub_u32 s47, s18, 1
    s_lshl_b32 s47, s47, 10
    v_mov_b32 v2, 1
    v_mov_b32 v3, 1
    s_mov_b64 exec, 1
    buffer_store_dwordx2 v[2:3], v123, s[4:7], s47 offen sc1
    s_mov_b64 exec, -1
CH_hp79:
    ds_read_b128 v[100:103], v127 offset:18432
    v_mov_b32 v116, v112
    v_mov_b32 v117, v113
    v_mov_b32 v118, v112
    v_mov_b32 v119, v113
    s_nop 1
    v_permlane16_swap_b32 v116, v118
    v_permlane16_swap_b32 v117, v119
    s_mov_b64 exec, s[60:61]
    buffer_store_dwordx4 v[116:119], v15, s[4:7], s38 offen sc1
    s_mov_b64 exec, -1
    s_nop 1
    v_mov_b32 v116, v114
    v_mov_b32 v117, v115
    v_mov_b32 v118, v114
    v_mov_b32 v119, v115
    s_nop 1
    v_permlane16_swap_b32 v116, v118
    v_permlane16_swap_b32 v117, v119
    s_mov_b64 exec, s[60:61]
    buffer_store_dwordx4 v[116:119], v16, s[4:7], s39 offen sc1
    s_mov_b64 exec, -1
    s_nop 1
    s_waitcnt lgkmcnt(0)
    v_mov_b32 v116, v100
    v_mov_b32 v117, v101
    v_mov_b32 v118, v100
    v_mov_b32 v119, v101
    s_nop 1
    v_permlane16_swap_b32 v116, v118
    v_permlane16_swap_b32 v117, v119
    s_mov_b64 exec, s[60:61]
    buffer_store_dwordx4 v[116:119], v121, s[4:7], s38 offen sc1
    s_mov_b64 exec, -1
    s_nop 1
    v_mov_b32 v116, v102
    v_mov_b32 v117, v103
    v_mov_b32 v118, v102
    v_mov_b32 v119, v103
    s_nop 1
    v_permlane16_swap_b32 v116, v118
    v_permlane16_swap_b32 v117, v119
    s_mov_b64 exec, s[60:61]
    buffer_store_dwordx4 v[116:119], v122, s[4:7], s39 offen sc1
    s_mov_b64 exec, -1
    s_nop 1
    s_add_u32 s47, s18, 3
    s_cmp_gt_u32 s47, 63
    s_cbranch_scc1 CH_npf80
    s_cmp_ge_u32 s52, 4
    s_cbranch_scc1 CH_pf81
    s_lshl_b32 s48, s47, 2
    s_mov_b32 s41, 0
CH_kvw82:
    buffer_load_dword v2, v124, s[4:7], s48 offen sc1
    s_waitcnt vmcnt(0)
    s_nop 0
    v_readfirstlane_b32 s15, v2
    s_nop 3
    s_cmp_ge_u32 s15, 4
    s_cbranch_scc1 CH_kvok83
    s_sleep 2
    s_add_u32 s41, s41, 1
    s_cmp_lt_u32 s41, 524288
    s_cbranch_scc1 CH_kvw82
    s_branch CH_abort
CH_kvok83:
CH_pf81:
    s_mov_b64 exec, s[32:33]
    buffer_load_dword v9, v29, s[4:7], s45 offen
    s_mov_b64 exec, -1
CH_npf80:
    s_add_u32 s48, s18, 4
    s_min_u32 s48, s48, 63
    s_lshl_b32 s48, s48, 2
    buffer_load_dword v126, v124, s[4:7], s48 offen sc1
    v_mfma_f32_16x16x32_bf16 v[64:67], v[144:147], a[160:163], 0
    v_mfma_f32_16x16x32_bf16 v[64:67], v[148:151], a[172:175], v[64:67]
    v_mfma_f32_16x16x32_bf16 v[64:67], v[152:155], a[184:187], v[64:67]
    buffer_load_dwordx4 a[224:227], v20, s[4:7], s29 offen offset:0
    v_mfma_f32_16x16x32_bf16 v[64:67], v[156:159], a[196:199], v[64:67]
    v_mfma_f32_16x16x32_bf16 v[68:71], v[144:147], a[164:167], 0
    v_mfma_f32_16x16x32_bf16 v[68:71], v[148:151], a[176:179], v[68:71]
    v_mfma_f32_16x16x32_bf16 v[68:71], v[152:155], a[188:191], v[68:71]
    v_mfma_f32_16x16x32_bf16 v[68:71], v[156:159], a[200:203], v[68:71]
    v_mfma_f32_16x16x32_bf16 v[72:75], v[144:147], a[168:171], 0
    buffer_load_dwordx4 a[228:231], v20, s[4:7], s29 offen offset:1024
    v_mfma_f32_16x16x32_bf16 v[72:75], v[148:151], a[180:183], v[72:75]
    v_mfma_f32_16x16x32_bf16 v[72:75], v[152:155], a[192:195], v[72:75]
    v_mfma_f32_16x16x32_bf16 v[72:75], v[156:159], a[204:207], v[72:75]
    v_mfma_f32_16x16x32_bf16 v[76:79], v[160:163], a[160:163], 0
    v_mfma_f32_16x16x32_bf16 v[76:79], v[164:167], a[172:175], v[76:79]
    v_mfma_f32_16x16x32_bf16 v[76:79], v[168:171], a[184:187], v[76:79]
    buffer_load_dwordx4 a[232:235], v20, s[4:7], s29 offen offset:2048
    v_mfma_f32_16x16x32_bf16 v[76:79], v[172:175], a[196:199], v[76:79]
    v_mfma_f32_16x16x32_bf16 v[80:83], v[160:163], a[164:167], 0
    v_mfma_f32_16x16x32_bf16 v[80:83], v[164:167], a[176:179], v[80:83]
    v_mfma_f32_16x16x32_bf16 v[80:83], v[168:171], a[188:191], v[80:83]
    v_mfma_f32_16x16x32_bf16 v[80:83], v[172:175], a[200:203], v[80:83]
    v_mfma_f32_16x16x32_bf16 v[84:87], v[160:163], a[168:171], 0
    buffer_load_dwordx4 a[236:239], v20, s[4:7], s29 offen offset:3072
    v_mfma_f32_16x16x32_bf16 v[84:87], v[164:167], a[180:183], v[84:87]
    v_mfma_f32_16x16x32_bf16 v[84:87], v[168:171], a[192:195], v[84:87]
    v_mfma_f32_16x16x32_bf16 v[84:87], v[172:175], a[204:207], v[84:87]
    s_nop 7
    v_cvt_pk_bf16_f32 v208, v64, v65
    v_cvt_pk_bf16_f32 v209, v66, v67
    v_cvt_pk_bf16_f32 v210, v76, v77
    v_cvt_pk_bf16_f32 v211, v78, v79
    v_cvt_pk_bf16_f32 v212, v68, v69
    v_cvt_pk_bf16_f32 v213, v70, v71
    v_cvt_pk_bf16_f32 v214, v80, v81
    v_cvt_pk_bf16_f32 v215, v82, v83
    v_cvt_pk_bf16_f32 v216, v72, v73
    v_cvt_pk_bf16_f32 v217, v74, v75
    v_cvt_pk_bf16_f32 v218, v84, v85
    v_cvt_pk_bf16_f32 v219, v86, v87
CH_e78:
    s_add_u32 s18, s18, 1
    s_branch CH_top56
CH_bd70:
    s_barrier
    s_branch CH_done
CH_last2365:
    s_cmp_lg_u32 s14, 2
    s_cbranch_scc1 CH_l384
    ds_write_b128 v127, v[112:115] offset:18432
    s_waitcnt lgkmcnt(0)
    s_barrier
    s_branch CH_done
CH_l384:
    s_barrier
    s_cmp_eq_u32 s18, 0
    s_cbranch_scc1 CH_hp85
    s_sub_u32 s47, s18, 1
    s_lshl_b32 s47, s47, 10
    v_mov_b32 v2, 1
    v_mov_b32 v3, 1
    s_mov_b64 exec, 1
    buffer_store_dwordx2 v[2:3], v123, s[4:7], s47 offen sc1
    s_mov_b64 exec, -1
CH_hp85:
    ds_read_b128 v[100:103], v127 offset:18432
    v_mov_b32 v116, v112
    v_mov_b32 v117, v113
    v_mov_b32 v118, v112
    v_mov_b32 v119, v113
    s_nop 1
    v_permlane16_swap_b32 v116, v118
    v_permlane16_swap_b32 v117, v119
    s_mov_b64 exec, s[60:61]
    buffer_store_dwordx4 v[116:119], v15, s[4:7], s38 offen sc1
    s_mov_b64 exec, -1
    s_nop 1
    v_mov_b32 v116, v114
    v_mov_b32 v117, v115
    v_mov_b32 v118, v114
    v_mov_b32 v119, v115
    s_nop 1
    v_permlane16_swap_b32 v116, v118
    v_permlane16_swap_b32 v117, v119
    s_mov_b64 exec, s[60:61]
    buffer_store_dwordx4 v[116:119], v16, s[4:7], s39 offen sc1
    s_mov_b64 exec, -1
    s_nop 1
    s_waitcnt lgkmcnt(0)
    v_mov_b32 v116, v100
    v_mov_b32 v117, v101
    v_mov_b32 v118, v100
    v_mov_b32 v119, v101
    s_nop 1
    v_permlane16_swap_b32 v116, v118
    v_permlane16_swap_b32 v117, v119
    s_mov_b64 exec, s[60:61]
    buffer_store_dwordx4 v[116:119], v121, s[4:7], s38 offen sc1
    s_mov_b64 exec, -1
    s_nop 1
    v_mov_b32 v116, v102
    v_mov_b32 v117, v103
    v_mov_b32 v118, v102
    v_mov_b32 v119, v103
    s_nop 1
    v_permlane16_swap_b32 v116, v118
    v_permlane16_swap_b32 v117, v119
    s_mov_b64 exec, s[60:61]
    buffer_store_dwordx4 v[116:119], v122, s[4:7], s39 offen sc1
    s_mov_b64 exec, -1
    s_nop 1
    s_waitcnt vmcnt(0)
    s_lshl_b32 s47, s18, 10
    v_mov_b32 v2, 1
    v_mov_b32 v3, 1
    s_mov_b64 exec, 1
    buffer_store_dwordx2 v[2:3], v123, s[4:7], s47 offen sc1
    s_mov_b64 exec, -1
    s_branch CH_done
CH_abort:
    s_load_dwordx2 s[46:47], s[0:1], 136
    s_waitcnt lgkmcnt(0)
    s_mov_b64 exec, 1
    v_mov_b32 v2, 0
    s_or_b32 s15, s18, 0xdead0000
    v_mov_b32 v3, s15
    global_store_dword v2, v3, s[46:47]
    s_mov_b64 exec, -1
CH_done:
    s_waitcnt vmcnt(0)
    s_branch CH_end
CH_worker:
    s_mov_b32 s8, s14
    s_mov_b32 s101, s12
    s_sub_u32 s15, s15, 128
    s_lshr_b32 s24, s15, 2
    s_and_b32 s25, s15, 3
    s_mov_b32 s26, 4
    s_add_u32 s66, s15, 1600
CH_wgemm92:
    s_lshr_b32 s28, s24, 4
    s_cmp_eq_u32 s28, 0
    s_cbranch_scc1 CH_mk93
    s_cmp_eq_u32 s28, 1
    s_cbranch_scc1 CH_mv94
    s_load_dwordx2 s[36:37], s[0:1], 88
    s_mov_b32 s27, 33554432
    s_mov_b32 s33, 85993472
    s_branch CH_mj95
CH_mk93:
    s_load_dwordx2 s[36:37], s[0:1], 96
    s_mov_b32 s27, 0
    s_mov_b32 s33, 85991424
    s_branch CH_mj95
CH_mv94:
    s_load_dwordx2 s[36:37], s[0:1], 104
    s_mov_b32 s27, 16777216
    s_mov_b32 s33, 85991424
CH_mj95:
    s_load_dwordx2 s[38:39], s[0:1], 72
    s_and_b32 s28, s24, 15
    s_lshl_b32 s28, s28, 1
    s_lshr_b32 s29, s28, 2
    s_lshl_b32 s29, s29, 8
    s_add_u32 s33, s33, s29
    s_waitcnt lgkmcnt(0)
    s_mov_b32 s16, s36
    s_and_b32 s17, s37, 0xffff
    s_mov_b32 s18, 5242880
    s_mov_b32 s19, 0x20000
    s_mov_b32 s20, s38
    s_and_b32 s21, s39, 0xffff
    s_mov_b32 s22, 2621440
    s_mov_b32 s23, 0x20000
    s_lshl_b32 s29, s28, 19
    s_add_u32 s27, s27, s29
    s_lshl_b32 s29, s8, 10
    s_add_u32 s27, s27, s29
    v_and_b32 v2, 31, v1
    v_lshrrev_b32 v3, 4, v2
    v_lshlrev_b32 v3, 12, v3
    v_and_b32 v4, 15, v1
    v_lshlrev_b32 v4, 4, v4
    v_lshrrev_b32 v5, 5, v1
    v_lshlrev_b32 v6, 8, v5
    v_add3_u32 v20, v3, v4, v6
    v_mul_u32_u24 v3, 1296, v2
    v_lshlrev_b32 v5, 4, v5
    v_add_u32 v19, v3, v5
    s_mov_b32 s29, 51782
    v_add_u32 v2, 0, v0
    v_mul_lo_u32 v3, v2, s29
    v_lshrrev_b32 v3, 22, v3
    v_mul_u32_u24 v4, 81, v3
    v_sub_u32 v4, v2, v4
    v_min_u32 v4, 79, v4
    v_min_u32 v3, 31, v3
    v_mul_u32_u24 v3, 1280, v3
    v_lshlrev_b32 v4, 4, v4
    v_add_u32 v8, v3, v4
    v_add_u32 v2, 256, v0
    v_mul_lo_u32 v3, v2, s29
    v_lshrrev_b32 v3, 22, v3
    v_mul_u32_u24 v4, 81, v3
    v_sub_u32 v4, v2, v4
    v_min_u32 v4, 79, v4
    v_min_u32 v3, 31, v3
    v_mul_u32_u24 v3, 1280, v3
    v_lshlrev_b32 v4, 4, v4
    v_add_u32 v9, v3, v4
    v_add_u32 v2, 512, v0
    v_mul_lo_u32 v3, v2, s29
    v_lshrrev_b32 v3, 22, v3
    v_mul_u32_u24 v4, 81, v3
    v_sub_u32 v4, v2, v4
    v_min_u32 v4, 79, v4
    v_min_u32 v3, 31, v3
    v_mul_u32_u24 v3, 1280, v3
    v_lshlrev_b32 v4, 4, v4
    v_add_u32 v10, v3, v4
    v_add_u32 v2, 768, v0
    v_mul_lo_u32 v3, v2, s29
    v_lshrrev_b32 v3, 22, v3
    v_mul_u32_u24 v4, 81, v3
    v_sub_u32 v4, v2, v4
    v_min_u32 v4, 79, v4
    v_min_u32 v3, 31, v3
    v_mul_u32_u24 v3, 1280, v3
    v_lshlrev_b32 v4, 4, v4
    v_add_u32 v11, v3, v4
    v_add_u32 v2, 1024, v0
    v_mul_lo_u32 v3, v2, s29
    v_lshrrev_b32 v3, 22, v3
    v_mul_u32_u24 v4, 81, v3
    v_sub_u32 v4, v2, v4
    v_min_u32 v4, 79, v4
    v_min_u32 v3, 31, v3
    v_mul_u32_u24 v3, 1280, v3
    v_lshlrev_b32 v4, 4, v4
    v_add_u32 v12, v3, v4
    v_add_u32 v2, 1280, v0
    v_mul_lo_u32 v3, v2, s29
    v_lshrrev_b32 v3, 22, v3
    v_mul_u32_u24 v4, 81, v3
    v_sub_u32 v4, v2, v4
    v_min_u32 v4, 79, v4
    v_min_u32 v3, 31, v3
    v_mul_u32_u24 v3, 1280, v3
    v_lshlrev_b32 v4, 4, v4
    v_add_u32 v13, v3, v4
    v_add_u32 v2, 1536, v0
    v_mul_lo_u32 v3, v2, s29
    v_lshrrev_b32 v3, 22, v3
    v_mul_u32_u24 v4, 81, v3
    v_sub_u32 v4, v2, v4
    v_min_u32 v4, 79, v4
    v_min_u32 v3, 31, v3
    v_mul_u32_u24 v3, 1280, v3
    v_lshlrev_b32 v4, 4, v4
    v_add_u32 v14, v3, v4
    v_add_u32 v2, 1792, v0
    v_mul_lo_u32 v3, v2, s29
    v_lshrrev_b32 v3, 22, v3
    v_mul_u32_u24 v4, 81, v3
    v_sub_u32 v4, v2, v4
    v_min_u32 v4, 79, v4
    v_min_u32 v3, 31, v3
    v_mul_u32_u24 v3, 1280, v3
    v_lshlrev_b32 v4, 4, v4
    v_add_u32 v15, v3, v4
    v_add_u32 v2, 2048, v0
    v_mul_lo_u32 v3, v2, s29
    v_lshrrev_b32 v3, 22, v3
    v_mul_u32_u24 v4, 81, v3
    v_sub_u32 v4, v2, v4
    v_min_u32 v4, 79, v4
    v_min_u32 v3, 31, v3
    v_mul_u32_u24 v3, 1280, v3
    v_lshlrev_b32 v4, 4, v4
    v_add_u32 v16, v3, v4
    v_add_u32 v2, 2304, v0
    v_mul_lo_u32 v3, v2, s29
    v_lshrrev_b32 v3, 22, v3
    v_mul_u32_u24 v4, 81, v3
    v_sub_u32 v4, v2, v4
    v_min_u32 v4, 79, v4
    v_min_u32 v3, 31, v3
    v_mul_u32_u24 v3, 1280, v3
    v_lshlrev_b32 v4, 4, v4
    v_add_u32 v17, v3, v4
    v_add_u32 v2, 2560, v0
    v_mul_lo_u32 v3, v2, s29
    v_lshrrev_b32 v3, 22, v3
    v_mul_u32_u24 v4, 81, v3
    v_sub_u32 v4, v2, v4
    v_min_u32 v4, 79, v4
    v_min_u32 v3, 31, v3
    v_mul_u32_u24 v3, 1280, v3
    v_lshlrev_b32 v4, 4, v4
    v_add_u32 v18, v3, v4
    v_lshrrev_b32 v2, 5, v0
    v_lshlrev_b32 v2, 13, v2
    v_and_b32 v3, 31, v0
    v_lshlrev_b32 v3, 4, v3
    s_lshl_b32 s29, s28, 8
    v_add3_u32 v2, v2, v3, s29
    s_lshl_b32 s32, s8, 10
    v_lshrrev_b32 v3, 4, v1
    v_lshrrev_b32 v4, 1, v3
    v_lshlrev_b32 v4, 3, v4
    v_and_b32 v5, 15, v1
    v_lshrrev_b32 v5, 2, v5
    v_add_u32 v4, v4, v5
    v_lshlrev_b32 v4, 9, v4
    v_and_b32 v3, 1, v3
    v_lshlrev_b32 v3, 5, v3
    v_and_b32 v5, 3, v1
    v_lshlrev_b32 v5, 3, v5
    v_add3_u32 v4, v4, v3, v5
    s_lshl_b32 s29, s8, 6
    v_add_u32 v4, s29, v4
    v_add_u32 v5, 40960, v4
    v_add_u32 v6, 81920, v4
    s_mov_b32 s29, 0
    s_add_u32 m0, s32, 0
    s_nop 0
    buffer_load_dwordx4 v2, s[16:19], s29 offen lds
    s_mov_b32 s29, 65536
    s_add_u32 m0, s32, 4096
    s_nop 0
    buffer_load_dwordx4 v2, s[16:19], s29 offen lds
    s_mov_b32 s29, 131072
    s_add_u32 m0, s32, 8192
    s_nop 0
    buffer_load_dwordx4 v2, s[16:19], s29 offen lds
    s_mov_b32 s29, 196608
    s_add_u32 m0, s32, 12288
    s_nop 0
    buffer_load_dwordx4 v2, s[16:19], s29 offen lds
    s_mov_b32 s29, 262144
    s_add_u32 m0, s32, 16384
    s_nop 0
    buffer_load_dwordx4 v2, s[16:19], s29 offen lds
    s_mov_b32 s29, 327680
    s_add_u32 m0, s32, 20480
    s_nop 0
    buffer_load_dwordx4 v2, s[16:19], s29 offen lds
    s_mov_b32 s29, 393216
    s_add_u32 m0, s32, 24576
    s_nop 0
    buffer_load_dwordx4 v2, s[16:19], s29 offen lds
    s_mov_b32 s29, 458752
    s_add_u32 m0, s32, 28672
    s_nop 0
    buffer_load_dwordx4 v2, s[16:19], s29 offen lds
    s_mov_b32 s29, 524288
    s_add_u32 m0, s32, 32768
    s_nop 0
    buffer_load_dwordx4 v2, s[16:19], s29 offen lds
    s_mov_b32 s29, 589824
    s_add_u32 m0, s32, 36864
    s_nop 0
    buffer_load_dwordx4 v2, s[16:19], s29 offen lds
    s_mov_b32 s29, 655360
    s_add_u32 m0, s32, 40960
    s_nop 0
    buffer_load_dwordx4 v2, s[16:19], s29 offen lds
    s_mov_b32 s29, 720896
    s_add_u32 m0, s32, 45056
    s_nop 0
    buffer_load_dwordx4 v2, s[16:19], s29 offen lds
    s_mov_b32 s29, 786432
    s_add_u32 m0, s32, 49152
    s_nop 0
    buffer_load_dwordx4 v2, s[16:19], s29 offen lds
    s_mov_b32 s29, 851968
    s_add_u32 m0, s32, 53248
    s_nop 0
    buffer_load_dwordx4 v2, s[16:19], s29 offen lds
    s_mov_b32 s29, 917504
    s_add_u32 m0, s32, 57344
    s_nop 0
    buffer_load_dwordx4 v2, s[16:19], s29 offen lds
    s_mov_b32 s29, 983040
    s_add_u32 m0, s32, 61440
    s_nop 0
    buffer_load_dwordx4 v2, s[16:19], s29 offen lds
    s_mov_b32 s29, 1048576
    s_add_u32 m0, s32, 65536
    s_nop 0
    buffer_load_dwordx4 v2, s[16:19], s29 offen lds
    s_mov_b32 s29, 1114112
    s_add_u32 m0, s32, 69632
    s_nop 0
    buffer_load_dwordx4 v2, s[16:19], s29 offen lds
    s_mov_b32 s29, 1179648
    s_add_u32 m0, s32, 73728
    s_nop 0
    buffer_load_dwordx4 v2, s[16:19], s29 offen lds
    s_mov_b32 s29, 1245184
    s_add_u32 m0, s32, 77824
    s_nop 0
    buffer_load_dwordx4 v2, s[16:19], s29 offen lds
    s_mov_b32 s29, 1310720
    s_add_u32 m0, s32, 81920
    s_nop 0
    buffer_load_dwordx4 v2, s[16:19], s29 offen lds
    s_mov_b32 s29, 1376256
    s_add_u32 m0, s32, 86016
    s_nop 0
    buffer_load_dwordx4 v2, s[16:19], s29 offen lds
    s_mov_b32 s29, 1441792
    s_add_u32 m0, s32, 90112
    s_nop 0
    buffer_load_dwordx4 v2, s[16:19], s29 offen lds
    s_mov_b32 s29, 1507328
    s_add_u32 m0, s32, 94208
    s_nop 0
    buffer_load_dwordx4 v2, s[16:19], s29 offen lds
    s_mov_b32 s29, 1572864
    s_add_u32 m0, s32, 98304
    s_nop 0
    buffer_load_dwordx4 v2, s[16:19], s29 offen lds
    s_mov_b32 s29, 1638400
    s_add_u32 m0, s32, 102400
    s_nop 0
    buffer_load_dwordx4 v2, s[16:19], s29 offen lds
    s_mov_b32 s29, 1703936
    s_add_u32 m0, s32, 106496
    s_nop 0
    buffer_load_dwordx4 v2, s[16:19], s29 offen lds
    s_mov_b32 s29, 1769472
    s_add_u32 m0, s32, 110592
    s_nop 0
    buffer_load_dwordx4 v2, s[16:19], s29 offen lds
    s_mov_b32 s29, 1835008
    s_add_u32 m0, s32, 114688
    s_nop 0
    buffer_load_dwordx4 v2, s[16:19], s29 offen lds
    s_mov_b32 s29, 1900544
    s_add_u32 m0, s32, 118784
    s_nop 0
    buffer_load_dwordx4 v2, s[16:19], s29 offen lds
    s_waitcnt vmcnt(20)
    s_barrier
    ds_read_b64_tr_b16 a[0:1], v4 offset:0
    ds_read_b64_tr_b16 a[2:3], v4 offset:2048
    ds_read_b64_tr_b16 a[160:161], v4 offset:256
    ds_read_b64_tr_b16 a[162:163], v4 offset:2304
    ds_read_b64_tr_b16 a[4:5], v4 offset:8192
    ds_read_b64_tr_b16 a[6:7], v4 offset:10240
    ds_read_b64_tr_b16 a[164:165], v4 offset:8448
    ds_read_b64_tr_b16 a[166:167], v4 offset:10496
    ds_read_b64_tr_b16 a[8:9], v4 offset:16384
    ds_read_b64_tr_b16 a[10:11], v4 offset:18432
    ds_read_b64_tr_b16 a[168:169], v4 offset:16640
    ds_read_b64_tr_b16 a[170:171], v4 offset:18688
    s_waitcnt lgkmcnt(0)
    ds_read_b64_tr_b16 a[12:13], v4 offset:24576
    ds_read_b64_tr_b16 a[14:15], v4 offset:26624
    ds_read_b64_tr_b16 a[172:173], v4 offset:24832
    ds_read_b64_tr_b16 a[174:175], v4 offset:26880
    ds_read_b64_tr_b16 a[16:17], v4 offset:32768
    ds_read_b64_tr_b16 a[18:19], v4 offset:34816
    ds_read_b64_tr_b16 a[176:177], v4 offset:33024
    ds_read_b64_tr_b16 a[178:179], v4 offset:35072
    s_waitcnt lgkmcnt(0)
    s_barrier
    s_mov_b32 s29, 1966080
    s_add_u32 m0, s32, 0
    s_nop 0
    buffer_load_dwordx4 v2, s[16:19], s29 offen lds
    s_mov_b32 s29, 2031616
    s_add_u32 m0, s32, 4096
    s_nop 0
    buffer_load_dwordx4 v2, s[16:19], s29 offen lds
    s_mov_b32 s29, 2097152
    s_add_u32 m0, s32, 8192
    s_nop 0
    buffer_load_dwordx4 v2, s[16:19], s29 offen lds
    s_mov_b32 s29, 2162688
    s_add_u32 m0, s32, 12288
    s_nop 0
    buffer_load_dwordx4 v2, s[16:19], s29 offen lds
    s_mov_b32 s29, 2228224
    s_add_u32 m0, s32, 16384
    s_nop 0
    buffer_load_dwordx4 v2, s[16:19], s29 offen lds
    s_mov_b32 s29, 2293760
    s_add_u32 m0, s32, 20480
    s_nop 0
    buffer_load_dwordx4 v2, s[16:19], s29 offen lds
    s_mov_b32 s29, 2359296
    s_add_u32 m0, s32, 24576
    s_nop 0
    buffer_load_dwordx4 v2, s[16:19], s29 offen lds
    s_mov_b32 s29, 2424832
    s_add_u32 m0, s32, 28672
    s_nop 0
    buffer_load_dwordx4 v2, s[16:19], s29 offen lds
    s_mov_b32 s29, 2490368
    s_add_u32 m0, s32, 32768
    s_nop 0
    buffer_load_dwordx4 v2, s[16:19], s29 offen lds
    s_mov_b32 s29, 2555904
    s_add_u32 m0, s32, 36864
    s_nop 0
    buffer_load_dwordx4 v2, s[16:19], s29 offen lds
    s_waitcnt vmcnt(20)
    s_barrier
    ds_read_b64_tr_b16 a[20:21], v5 offset:0
    ds_read_b64_tr_b16 a[22:23], v5 offset:2048
    ds_read_b64_tr_b16 a[180:181], v5 offset:256
    ds_read_b64_tr_b16 a[182:183], v5 offset:2304
    ds_read_b64_tr_b16 a[24:25], v5 offset:8192
    ds_read_b64_tr_b16 a[26:27], v5 offset:10240
    ds_read_b64_tr_b16 a[184:185], v5 offset:8448
    ds_read_b64_tr_b16 a[186:187], v5 offset:10496
    ds_read_b64_tr_b16 a[28:29], v5 offset:16384
    ds_read_b64_tr_b16 a[30:31], v5 offset:18432
    ds_read_b64_tr_b16 a[188:189], v5 offset:16640
    ds_read_b64_tr_b16 a[190:191], v5 offset:18688
    s_waitcnt lgkmcnt(0)
    ds_read_b64_tr_b16 a[32:33], v5 offset:24576
    ds_read_b64_tr_b16 a[34:35], v5 offset:26624
    ds_read_b64_tr_b16 a[192:193], v5 offset:24832
    ds_read_b64_tr_b16 a[194:195], v5 offset:26880
    ds_read_b64_tr_b16 a[36:37], v5 offset:32768
    ds_read_b64_tr_b16 a[38:39], v5 offset:34816
    ds_read_b64_tr_b16 a[196:197], v5 offset:33024
    ds_read_b64_tr_b16 a[198:199], v5 offset:35072
    s_waitcnt lgkmcnt(0)
    s_barrier
    s_mov_b32 s29, 2621440
    s_add_u32 m0, s32, 40960
    s_nop 0
    buffer_load_dwordx4 v2, s[16:19], s29 offen lds
    s_mov_b32 s29, 2686976
    s_add_u32 m0, s32, 45056
    s_nop 0
    buffer_load_dwordx4 v2, s[16:19], s29 offen lds
    s_mov_b32 s29, 2752512
    s_add_u32 m0, s32, 49152
    s_nop 0
    buffer_load_dwordx4 v2, s[16:19], s29 offen lds
    s_mov_b32 s29, 2818048
    s_add_u32 m0, s32, 53248
    s_nop 0
    buffer_load_dwordx4 v2, s[16:19], s29 offen lds
    s_mov_b32 s29, 2883584
    s_add_u32 m0, s32, 57344
    s_nop 0
    buffer_load_dwordx4 v2, s[16:19], s29 offen lds
    s_mov_b32 s29, 2949120
    s_add_u32 m0, s32, 61440
    s_nop 0
    buffer_load_dwordx4 v2, s[16:19], s29 offen lds
    s_mov_b32 s29, 3014656
    s_add_u32 m0, s32, 65536
    s_nop 0
    buffer_load_dwordx4 v2, s[16:19], s29 offen lds
    s_mov_b32 s29, 3080192
    s_add_u32 m0, s32, 69632
    s_nop 0
    buffer_load_dwordx4 v2, s[16:19], s29 offen lds
    s_mov_b32 s29, 3145728
    s_add_u32 m0, s32, 73728
    s_nop 0
    buffer_load_dwordx4 v2, s[16:19], s29 offen lds
    s_mov_b32 s29, 3211264
    s_add_u32 m0, s32, 77824
    s_nop 0
    buffer_load_dwordx4 v2, s[16:19], s29 offen lds
    s_waitcnt vmcnt(20)
    s_barrier
    ds_read_b64_tr_b16 a[40:41], v6 offset:0
    ds_read_b64_tr_b16 a[42:43], v6 offset:2048
    ds_read_b64_tr_b16 a[200:201], v6 offset:256
    ds_read_b64_tr_b16 a[202:203], v6 offset:2304
    ds_read_b64_tr_b16 a[44:45], v6 offset:8192
    ds_read_b64_tr_b16 a[46:47], v6 offset:10240
    ds_read_b64_tr_b16 a[204:205], v6 offset:8448
    ds_read_b64_tr_b16 a[206:207], v6 offset:10496
    ds_read_b64_tr_b16 a[48:49], v6 offset:16384
    ds_read_b64_tr_b16 a[50:51], v6 offset:18432
    ds_read_b64_tr_b16 a[208:209], v6 offset:16640
    ds_read_b64_tr_b16 a[210:211], v6 offset:18688
    s_waitcnt lgkmcnt(0)
    ds_read_b64_tr_b16 a[52:53], v6 offset:24576
    ds_read_b64_tr_b16 a[54:55], v6 offset:26624
    ds_read_b64_tr_b16 a[212:213], v6 offset:24832
    ds_read_b64_tr_b16 a[214:215], v6 offset:26880
    ds_read_b64_tr_b16 a[56:57], v6 offset:32768
    ds_read_b64_tr_b16 a[58:59], v6 offset:34816
    ds_read_b64_tr_b16 a[216:217], v6 offset:33024
    ds_read_b64_tr_b16 a[218:219], v6 offset:35072
    s_waitcnt lgkmcnt(0)
    s_barrier
    s_mov_b32 s29, 3276800
    s_add_u32 m0, s32, 81920
    s_nop 0
    buffer_load_dwordx4 v2, s[16:19], s29 offen lds
    s_mov_b32 s29, 3342336
    s_add_u32 m0, s32, 86016
    s_nop 0
    buffer_load_dwordx4 v2, s[16:19], s29 offen lds
    s_mov_b32 s29, 3407872
    s_add_u32 m0, s32, 90112
    s_nop 0
    buffer_load_dwordx4 v2, s[16:19], s29 offen lds
    s_mov_b32 s29, 3473408
    s_add_u32 m0, s32, 94208
    s_nop 0
    buffer_load_dwordx4 v2, s[16:19], s29 offen lds
    s_mov_b32 s29, 3538944
    s_add_u32 m0, s32, 98304
    s_nop 0
    buffer_load_dwordx4 v2, s[16:19], s29 offen lds
    s_mov_b32 s29, 3604480
    s_add_u32 m0, s32, 102400
    s_nop 0
    buffer_load_dwordx4 v2, s[16:19], s29 offen lds
    s_mov_b32 s29, 3670016
    s_add_u32 m0, s32, 106496
    s_nop 0
    buffer_load_dwordx4 v2, s[16:19], s29 offen lds
    s_mov_b32 s29, 3735552
    s_add_u32 m0, s32, 110592
    s_nop 0
    buffer_load_dwordx4 v2, s[16:19], s29 offen lds
    s_mov_b32 s29, 3801088
    s_add_u32 m0, s32, 114688
    s_nop 0
    buffer_load_dwordx4 v2, s[16:19], s29 offen lds
    s_mov_b32 s29, 3866624
    s_add_u32 m0, s32, 118784
    s_nop 0
    buffer_load_dwordx4 v2, s[16:19], s29 offen lds
    s_waitcnt vmcnt(20)
    s_barrier
    ds_read_b64_tr_b16 a[60:61], v4 offset:0
    ds_read_b64_tr_b16 a[62:63], v4 offset:2048
    ds_read_b64_tr_b16 a[220:221], v4 offset:256
    ds_read_b64_tr_b16 a[222:223], v4 offset:2304
    ds_read_b64_tr_b16 a[64:65], v4 offset:8192
    ds_read_b64_tr_b16 a[66:67], v4 offset:10240
    ds_read_b64_tr_b16 a[224:225], v4 offset:8448
    ds_read_b64_tr_b16 a[226:227], v4 offset:10496
    ds_read_b64_tr_b16 a[68:69], v4 offset:16384
    ds_read_b64_tr_b16 a[70:71], v4 offset:18432
    ds_read_b64_tr_b16 a[228:229], v4 offset:16640
    ds_read_b64_tr_b16 a[230:231], v4 offset:18688
    s_waitcnt lgkmcnt(0)
    ds_read_b64_tr_b16 a[72:73], v4 offset:24576
    ds_read_b64_tr_b16 a[74:75], v4 offset:26624
    ds_read_b64_tr_b16 a[232:233], v4 offset:24832
    ds_read_b64_tr_b16 a[234:235], v4 offset:26880
    ds_read_b64_tr_b16 a[76:77], v4 offset:32768
    ds_read_b64_tr_b16 a[78:79], v4 offset:34816
    ds_read_b64_tr_b16 a[236:237], v4 offset:33024
    ds_read_b64_tr_b16 a[238:239], v4 offset:35072
    s_waitcnt lgkmcnt(0)
    s_barrier
    s_mov_b32 s29, 3932160
    s_add_u32 m0, s32, 0
    s_nop 0
    buffer_load_dwordx4 v2, s[16:19], s29 offen lds
    s_mov_b32 s29, 3997696
    s_add_u32 m0, s32, 4096
    s_nop 0
    buffer_load_dwordx4 v2, s[16:19], s29 offen lds
    s_mov_b32 s29, 4063232
    s_add_u32 m0, s32, 8192
    s_nop 0
    buffer_load_dwordx4 v2, s[16:19], s29 offen lds
    s_mov_b32 s29, 4128768
    s_add_u32 m0, s32, 12288
    s_nop 0
    buffer_load_dwordx4 v2, s[16:19], s29 offen lds
    s_mov_b32 s29, 4194304
    s_add_u32 m0, s32, 16384
    s_nop 0
    buffer_load_dwordx4 v2, s[16:19], s29 offen lds
    s_mov_b32 s29, 4259840
    s_add_u32 m0, s32, 20480
    s_nop 0
    buffer_load_dwordx4 v2, s[16:19], s29 offen lds
    s_mov_b32 s29, 4325376
    s_add_u32 m0, s32, 24576
    s_nop 0
    buffer_load_dwordx4 v2, s[16:19], s29 offen lds
    s_mov_b32 s29, 4390912
    s_add_u32 m0, s32, 28672
    s_nop 0
    buffer_load_dwordx4 v2, s[16:19], s29 offen lds
    s_mov_b32 s29, 4456448
    s_add_u32 m0, s32, 32768
    s_nop 0
    buffer_load_dwordx4 v2, s[16:19], s29 offen lds
    s_mov_b32 s29, 4521984
    s_add_u32 m0, s32, 36864
    s_nop 0
    buffer_load_dwordx4 v2, s[16:19], s29 offen lds
    s_waitcnt vmcnt(20)
    s_barrier
    ds_read_b64_tr_b16 a[80:81], v5 offset:0
    ds_read_b64_tr_b16 a[82:83], v5 offset:2048
    ds_read_b64_tr_b16 a[240:241], v5 offset:256
    ds_read_b64_tr_b16 a[242:243], v5 offset:2304
    ds_read_b64_tr_b16 a[84:85], v5 offset:8192
    ds_read_b64_tr_b16 a[86:87], v5 offset:10240
    ds_read_b64_tr_b16 a[244:245], v5 offset:8448
    ds_read_b64_tr_b16 a[246:247], v5 offset:10496
    ds_read_b64_tr_b16 a[88:89], v5 offset:16384
    ds_read_b64_tr_b16 a[90:91], v5 offset:18432
    ds_read_b64_tr_b16 a[248:249], v5 offset:16640
    ds_read_b64_tr_b16 a[250:251], v5 offset:18688
    s_waitcnt lgkmcnt(0)
    ds_read_b64_tr_b16 a[92:93], v5 offset:24576
    ds_read_b64_tr_b16 a[94:95], v5 offset:26624
    ds_read_b64_tr_b16 a[252:253], v5 offset:24832
    ds_read_b64_tr_b16 a[254:255], v5 offset:26880
    ds_read_b64_tr_b16 a[96:97], v5 offset:32768
    ds_read_b64_tr_b16 a[98:99], v5 offset:34816
    ds_read_b64_tr_b16 v[96:97], v5 offset:33024
    ds_read_b64_tr_b16 v[98:99], v5 offset:35072
    s_waitcnt lgkmcnt(0)
    s_barrier
    s_mov_b32 s29, 4587520
    s_add_u32 m0, s32, 40960
    s_nop 0
    buffer_load_dwordx4 v2, s[16:19], s29 offen lds
    s_mov_b32 s29, 4653056
    s_add_u32 m0, s32, 45056
    s_nop 0
    buffer_load_dwordx4 v2, s[16:19], s29 offen lds
    s_mov_b32 s29, 4718592
    s_add_u32 m0, s32, 49152
    s_nop 0
    buffer_load_dwordx4 v2, s[16:19], s29 offen lds
    s_mov_b32 s29, 4784128
    s_add_u32 m0, s32, 53248
    s_nop 0
    buffer_load_dwordx4 v2, s[16:19], s29 offen lds
    s_mov_b32 s29, 4849664
    s_add_u32 m0, s32, 57344
    s_nop 0
    buffer_load_dwordx4 v2, s[16:19], s29 offen lds
    s_mov_b32 s29, 4915200
    s_add_u32 m0, s32, 61440
    s_nop 0
    buffer_load_dwordx4 v2, s[16:19], s29 offen lds
    s_mov_b32 s29, 4980736
    s_add_u32 m0, s32, 65536
    s_nop 0
    buffer_load_dwordx4 v2, s[16:19], s29 offen lds
    s_mov_b32 s29, 5046272
    s_add_u32 m0, s32, 69632
    s_nop 0
    buffer_load_dwordx4 v2, s[16:19], s29 offen lds
    s_mov_b32 s29, 5111808
    s_add_u32 m0, s32, 73728
    s_nop 0
    buffer_load_dwordx4 v2, s[16:19], s29 offen lds
    s_mov_b32 s29, 5177344
    s_add_u32 m0, s32, 77824
    s_nop 0
    buffer_load_dwordx4 v2, s[16:19], s29 offen lds
    s_waitcnt vmcnt(20)
    s_barrier
    ds_read_b64_tr_b16 a[100:101], v6 offset:0
    ds_read_b64_tr_b16 a[102:103], v6 offset:2048
    ds_read_b64_tr_b16 v[100:101], v6 offset:256
    ds_read_b64_tr_b16 v[102:103], v6 offset:2304
    ds_read_b64_tr_b16 a[104:105], v6 offset:8192
    ds_read_b64_tr_b16 a[106:107], v6 offset:10240
    ds_read_b64_tr_b16 v[104:105], v6 offset:8448
    ds_read_b64_tr_b16 v[106:107], v6 offset:10496
    ds_read_b64_tr_b16 a[108:109], v6 offset:16384
    ds_read_b64_tr_b16 a[110:111], v6 offset:18432
    ds_read_b64_tr_b16 v[108:109], v6 offset:16640
    ds_read_b64_tr_b16 v[110:111], v6 offset:18688
    s_waitcnt lgkmcnt(0)
    ds_read_b64_tr_b16 a[112:113], v6 offset:24576
    ds_read_b64_tr_b16 a[114:115], v6 offset:26624
    ds_read_b64_tr_b16 v[112:113], v6 offset:24832
    ds_read_b64_tr_b16 v[114:115], v6 offset:26880
    ds_read_b64_tr_b16 a[116:117], v6 offset:32768
    ds_read_b64_tr_b16 a[118:119], v6 offset:34816
    ds_read_b64_tr_b16 v[116:117], v6 offset:33024
    ds_read_b64_tr_b16 v[118:119], v6 offset:35072
    s_waitcnt lgkmcnt(0)
    s_barrier
    s_waitcnt vmcnt(10)
    s_barrier
    ds_read_b64_tr_b16 a[120:121], v4 offset:0
    ds_read_b64_tr_b16 a[122:123], v4 offset:2048
    ds_read_b64_tr_b16 v[120:121], v4 offset:256
    ds_read_b64_tr_b16 v[122:123], v4 offset:2304
    ds_read_b64_tr_b16 a[124:125], v4 offset:8192
    ds_read_b64_tr_b16 a[126:127], v4 offset:10240
    ds_read_b64_tr_b16 v[124:125], v4 offset:8448
    ds_read_b64_tr_b16 v[126:127], v4 offset:10496
    ds_read_b64_tr_b16 a[128:129], v4 offset:16384
    ds_read_b64_tr_b16 a[130:131], v4 offset:18432
    ds_read_b64_tr_b16 v[128:129], v4 offset:16640
    ds_read_b64_tr_b16 v[130:131], v4 offset:18688
    s_waitcnt lgkmcnt(0)
    ds_read_b64_tr_b16 a[132:133], v4 offset:24576
    ds_read_b64_tr_b16 a[134:135], v4 offset:26624
    ds_read_b64_tr_b16 v[132:133], v4 offset:24832
    ds_read_b64_tr_b16 v[134:135], v4 offset:26880
    ds_read_b64_tr_b16 a[136:137], v4 offset:32768
    ds_read_b64_tr_b16 a[138:139], v4 offset:34816
    ds_read_b64_tr_b16 v[136:137], v4 offset:33024
    ds_read_b64_tr_b16 v[138:139], v4 offset:35072
    s_waitcnt lgkmcnt(0)
    s_barrier
    s_waitcnt vmcnt(0)
    s_barrier
    ds_read_b64_tr_b16 a[140:141], v5 offset:0
    ds_read_b64_tr_b16 a[142:143], v5 offset:2048
    ds_read_b64_tr_b16 v[140:141], v5 offset:256
    ds_read_b64_tr_b16 v[142:143], v5 offset:2304
    ds_read_b64_tr_b16 a[144:145], v5 offset:8192
    ds_read_b64_tr_b16 a[146:147], v5 offset:10240
    ds_read_b64_tr_b16 v[144:145], v5 offset:8448
    ds_read_b64_tr_b16 v[146:147], v5 offset:10496
    ds_read_b64_tr_b16 a[148:149], v5 offset:16384
    ds_read_b64_tr_b16 a[150:151], v5 offset:18432
    ds_read_b64_tr_b16 v[148:149], v5 offset:16640
    ds_read_b64_tr_b16 v[150:151], v5 offset:18688
    s_waitcnt lgkmcnt(0)
    ds_read_b64_tr_b16 a[152:153], v5 offset:24576
    ds_read_b64_tr_b16 a[154:155], v5 offset:26624
    ds_read_b64_tr_b16 v[152:153], v5 offset:24832
    ds_read_b64_tr_b16 v[154:155], v5 offset:26880
    ds_read_b64_tr_b16 a[156:157], v5 offset:32768
    ds_read_b64_tr_b16 a[158:159], v5 offset:34816
    ds_read_b64_tr_b16 v[156:157], v5 offset:33024
    ds_read_b64_tr_b16 v[158:159], v5 offset:35072
    s_waitcnt lgkmcnt(0)
    s_barrier
    s_cmp_lg_u32 s65, 0
    s_cbranch_scc1 CH_vf96
    s_barrier
    s_cmp_lg_u32 s8, 0
    s_cbranch_scc1 CH_dw97
    v_and_b32 v2, 63, v0
    v_lshlrev_b32 v3, 5, v2
    v_and_b32 v3, 0xff, v3
    v_cmp_eq_u32 vcc, 8, v2
    v_mov_b32 v4, 4
    s_nop 0
    v_cndmask_b32 v3, v3, v4, vcc
    v_cmp_eq_u32 vcc, 9, v2
    v_mov_b32 v4, 8
    s_nop 0
    v_cndmask_b32 v2, v3, v4, vcc
    s_mov_b32 s41, 0
CH_dpoll98:
    global_load_dword v3, v2, s[96:97] sc1
    s_waitcnt vmcnt(0)
    s_nop 0
    v_readlane_b32 s48, v3, 0
    v_readlane_b32 s49, v3, 1
    v_readlane_b32 s50, v3, 2
    v_readlane_b32 s51, v3, 3
    v_readlane_b32 s52, v3, 4
    v_readlane_b32 s53, v3, 5
    v_readlane_b32 s54, v3, 6
    v_readlane_b32 s55, v3, 7
    v_readlane_b32 s56, v3, 8
    v_readlane_b32 s42, v3, 9
    s_nop 3
    s_cmp_lt_u32 s56, 256
    s_cbranch_scc1 CH_dpoll98_r
    s_cmp_eq_u32 s42, 99
    s_cbranch_scc1 CH_dpoll98_r
    s_min_u32 s15, s48, s49
    s_min_u32 s15, s15, s50
    s_min_u32 s15, s15, s51
    s_min_u32 s15, s15, s52
    s_min_u32 s15, s15, s53
    s_min_u32 s15, s15, s54
    s_min_u32 s15, s15, s55
    s_cmp_ge_u32 s15, 32
    s_cbranch_scc1 CH_dfast99
    s_add_u32 s15, s48, s49
    s_add_u32 s15, s15, s50
    s_add_u32 s15, s15, s51
    s_add_u32 s15, s15, s52
    s_add_u32 s15, s15, s53
    s_add_u32 s15, s15, s54
    s_add_u32 s15, s15, s55
    s_cmp_ge_u32 s15, 256
    s_cbranch_scc1 CH_dslow100
CH_dpoll98_r:
    s_sleep 1
    s_add_u32 s41, s41, 1
    s_cmp_lt_u32 s41, 524288
    s_cbranch_scc1 CH_dpoll98
    s_mov_b32 s15, 999
    s_mov_b32 s56, 0
    s_branch CH_dwr101
CH_dfast99:
    s_mov_b32 s56, 1
    s_lshl_b32 s15, s12, 5
    s_add_u32 s15, s15, s13
    s_branch CH_dwr101
CH_dslow100:
    s_mov_b32 s15, s13
    s_cmp_gt_u32 s12, 0
    s_cselect_b32 s56, s48, 0
    s_add_u32 s15, s15, s56
    s_cmp_gt_u32 s12, 1
    s_cselect_b32 s56, s49, 0
    s_add_u32 s15, s15, s56
    s_cmp_gt_u32 s12, 2
    s_cselect_b32 s56, s50, 0
    s_add_u32 s15, s15, s56
    s_cmp_gt_u32 s12, 3
    s_cselect_b32 s56, s51, 0
    s_add_u32 s15, s15, s56
    s_cmp_gt_u32 s12, 4
    s_cselect_b32 s56, s52, 0
    s_add_u32 s15, s15, s56
    s_cmp_gt_u32 s12, 5
    s_cselect_b32 s56, s53, 0
    s_add_u32 s15, s15, s56
    s_cmp_gt_u32 s12, 6
    s_cselect_b32 s56, s54, 0
    s_add_u32 s15, s15, s56
    s_mov_b32 s56, 0
CH_dwr101:
    v_mov_b32 v2, 143328
    v_mov_b32 v3, s15
    v_mov_b32 v4, s56
    v_mov_b32 v5, s42
    ds_write_b32 v2, v3
    ds_write_b32 v2, v4 offset:4
    ds_write_b32 v2, v5 offset:8
    s_waitcnt lgkmcnt(0)
CH_dw97:
    s_barrier
    v_mov_b32 v2, 143328
    ds_read_b32 v3, v2
    ds_read_b32 v4, v2 offset:4
    ds_read_b32 v5, v2 offset:8
    s_waitcnt lgkmcnt(0)
    s_nop 0
    v_readfirstlane_b32 s15, v3
    v_readfirstlane_b32 s43, v4
    v_readfirstlane_b32 s42, v5
    s_nop 3
    s_mov_b32 s65, 1
    s_cmp_eq_u32 s43, 0
    s_cbranch_scc1 CH_dispatch
CH_vf96:
    s_mul_i32 s30, s25, 40960
    s_mov_b32 s31, s32
    s_mov_b32 s34, -1
    s_mov_b32 s35, -1
    s_add_u32 m0, s31, 0
    s_nop 0
    buffer_load_dwordx4 v8, s[20:23], s30 offen lds
    s_add_u32 m0, s31, 4096
    s_nop 0
    buffer_load_dwordx4 v9, s[20:23], s30 offen lds
    s_add_u32 m0, s31, 8192
    s_nop 0
    buffer_load_dwordx4 v10, s[20:23], s30 offen lds
    s_add_u32 m0, s31, 12288
    s_nop 0
    buffer_load_dwordx4 v11, s[20:23], s30 offen lds
    s_add_u32 m0, s31, 16384
    s_nop 0
    buffer_load_dwordx4 v12, s[20:23], s30 offen lds
    s_add_u32 m0, s31, 20480
    s_nop 0
    buffer_load_dwordx4 v13, s[20:23], s30 offen lds
    s_add_u32 m0, s31, 24576
    s_nop 0
    buffer_load_dwordx4 v14, s[20:23], s30 offen lds
    s_add_u32 m0, s31, 28672
    s_nop 0
    buffer_load_dwordx4 v15, s[20:23], s30 offen lds
    s_add_u32 m0, s31, 32768
    s_nop 0
    buffer_load_dwordx4 v16, s[20:23], s30 offen lds
    s_add_u32 m0, s31, 36864
    s_nop 0
    buffer_load_dwordx4 v17, s[20:23], s30 offen lds
    s_add_u32 m0, s31, 40960
    s_nop 0
    buffer_load_dwordx4 v18, s[20:23], s30 offen lds
    s_waitcnt vmcnt(0)
CH_top103:
    s_waitcnt vmcnt(4)
    s_barrier
    s_cmp_eq_u32 s35, -1
    s_cbranch_scc1 CH_nosig105
    s_cmp_lg_u32 s8, 0
    s_cbranch_scc1 CH_sg108
    s_lshl_b32 s29, s35, 2
    s_add_u32 s29, s29, s33
    v_mov_b32 v2, s29
    v_mov_b32 v3, 1
    s_mov_b64 exec, 1
    buffer_atomic_add v3, v2, s[4:7], 0 offen sc1
    s_mov_b64 exec, -1
CH_sg108:
CH_nosig105:
    s_sub_u32 s28, s31, s32
    v_add_u32 v7, s28, v19
    s_xor_b32 s28, s28, 45056
    s_add_u32 s31, s28, s32
    s_add_u32 s28, s25, s26
    s_min_u32 s28, s28, 63
    s_mul_i32 s30, s28, 40960
    ds_read_b128 v[56:59], v7 offset:0
    ds_read_b128 v[60:63], v7 offset:32
    ds_read_b128 v[64:67], v7 offset:64
    ds_read_b128 v[68:71], v7 offset:96
    ds_read_b128 v[72:75], v7 offset:128
    ds_read_b128 v[76:79], v7 offset:160
    s_waitcnt lgkmcnt(5)
    v_mfma_f32_32x32x16_bf16 v[24:39], a[0:3], v[56:59], 0
    v_mfma_f32_32x32x16_bf16 v[40:55], a[160:163], v[56:59], 0
    ds_read_b128 v[56:59], v7 offset:192
    s_waitcnt lgkmcnt(5)
    v_mfma_f32_32x32x16_bf16 v[24:39], a[4:7], v[60:63], v[24:39]
    v_mfma_f32_32x32x16_bf16 v[40:55], a[164:167], v[60:63], v[40:55]
    s_add_u32 m0, s31, 0
    s_nop 0
    buffer_load_dwordx4 v8, s[20:23], s30 offen lds
    ds_read_b128 v[60:63], v7 offset:224
    s_waitcnt lgkmcnt(5)
    v_mfma_f32_32x32x16_bf16 v[24:39], a[8:11], v[64:67], v[24:39]
    v_mfma_f32_32x32x16_bf16 v[40:55], a[168:171], v[64:67], v[40:55]
    ds_read_b128 v[64:67], v7 offset:256
    s_waitcnt lgkmcnt(5)
    v_mfma_f32_32x32x16_bf16 v[24:39], a[12:15], v[68:71], v[24:39]
    v_mfma_f32_32x32x16_bf16 v[40:55], a[172:175], v[68:71], v[40:55]
    ds_read_b128 v[68:71], v7 offset:288
    s_waitcnt lgkmcnt(5)
    v_mfma_f32_32x32x16_bf16 v[24:39], a[16:19], v[72:75], v[24:39]
    v_mfma_f32_32x32x16_bf16 v[40:55], a[176:179], v[72:75], v[40:55]
    s_add_u32 m0, s31, 4096
    s_nop 0
    buffer_load_dwordx4 v9, s[20:23], s30 offen lds
    ds_read_b128 v[72:75], v7 offset:320
    s_waitcnt lgkmcnt(5)
    v_mfma_f32_32x32x16_bf16 v[24:39], a[20:23], v[76:79], v[24:39]
    v_mfma_f32_32x32x16_bf16 v[40:55], a[180:183], v[76:79], v[40:55]
    ds_read_b128 v[76:79], v7 offset:352
    s_waitcnt lgkmcnt(5)
    v_mfma_f32_32x32x16_bf16 v[24:39], a[24:27], v[56:59], v[24:39]
    v_mfma_f32_32x32x16_bf16 v[40:55], a[184:187], v[56:59], v[40:55]
    ds_read_b128 v[56:59], v7 offset:384
    s_waitcnt lgkmcnt(5)
    v_mfma_f32_32x32x16_bf16 v[24:39], a[28:31], v[60:63], v[24:39]
    v_mfma_f32_32x32x16_bf16 v[40:55], a[188:191], v[60:63], v[40:55]
    s_add_u32 m0, s31, 8192
    s_nop 0
    buffer_load_dwordx4 v10, s[20:23], s30 offen lds
    ds_read_b128 v[60:63], v7 offset:416
    s_waitcnt lgkmcnt(5)
    v_mfma_f32_32x32x16_bf16 v[24:39], a[32:35], v[64:67], v[24:39]
    v_mfma_f32_32x32x16_bf16 v[40:55], a[192:195], v[64:67], v[40:55]
    ds_read_b128 v[64:67], v7 offset:448
    s_waitcnt lgkmcnt(5)
    v_mfma_f32_32x32x16_bf16 v[24:39], a[36:39], v[68:71], v[24:39]
    v_mfma_f32_32x32x16_bf16 v[40:55], a[196:199], v[68:71], v[40:55]
    ds_read_b128 v[68:71], v7 offset:480
    s_waitcnt lgkmcnt(5)
    v_mfma_f32_32x32x16_bf16 v[24:39], a[40:43], v[72:75], v[24:39]
    v_mfma_f32_32x32x16_bf16 v[40:55], a[200:203], v[72:75], v[40:55]
    s_add_u32 m0, s31, 12288
    s_nop 0
    buffer_load_dwordx4 v11, s[20:23], s30 offen lds
    ds_read_b128 v[72:75], v7 offset:512
    s_waitcnt lgkmcnt(5)
    v_mfma_f32_32x32x16_bf16 v[24:39], a[44:47], v[76:79], v[24:39]
    v_mfma_f32_32x32x16_bf16 v[40:55], a[204:207], v[76:79], v[40:55]
    ds_read_b128 v[76:79], v7 offset:544
    s_waitcnt lgkmcnt(5)
    v_mfma_f32_32x32x16_bf16 v[24:39], a[48:51], v[56:59], v[24:39]
    v_mfma_f32_32x32x16_bf16 v[40:55], a[208:211], v[56:59], v[40:55]
    ds_read_b128 v[56:59], v7 offset:576
    s_waitcnt lgkmcnt(5)
    v_mfma_f32_32x32x16_bf16 v[24:39], a[52:55], v[60:63], v[24:39]
    v_mfma_f32_32x32x16_bf16 v[40:55], a[212:215], v[60:63], v[40:55]
    s_add_u32 m0, s31, 16384
    s_nop 0
    buffer_load_dwordx4 v12, s[20:23], s30 offen lds
    ds_read_b128 v[60:63], v7 offset:608
    s_waitcnt lgkmcnt(5)
    v_mfma_f32_32x32x16_bf16 v[24:39], a[56:59], v[64:67], v[24:39]
    v_mfma_f32_32x32x16_bf16 v[40:55], a[216:219], v[64:67], v[40:55]
    ds_read_b128 v[64:67], v7 offset:640
    s_waitcnt lgkmcnt(5)
    v_mfma_f32_32x32x16_bf16 v[24:39], a[60:63], v[68:71], v[24:39]
    v_mfma_f32_32x32x16_bf16 v[40:55], a[220:223], v[68:71], v[40:55]
    ds_read_b128 v[68:71], v7 offset:672
    s_waitcnt lgkmcnt(5)
    v_mfma_f32_32x32x16_bf16 v[24:39], a[64:67], v[72:75], v[24:39]
    v_mfma_f32_32x32x16_bf16 v[40:55], a[224:227], v[72:75], v[40:55]
    s_add_u32 m0, s31, 20480
    s_nop 0
    buffer_load_dwordx4 v13, s[20:23], s30 offen lds
    ds_read_b128 v[72:75], v7 offset:704
    s_waitcnt lgkmcnt(5)
    v_mfma_f32_32x32x16_bf16 v[24:39], a[68:71], v[76:79], v[24:39]
    v_mfma_f32_32x32x16_bf16 v[40:55], a[228:231], v[76:79], v[40:55]
    ds_read_b128 v[76:79], v7 offset:736
    s_waitcnt lgkmcnt(5)
    v_mfma_f32_32x32x16_bf16 v[24:39], a[72:75], v[56:59], v[24:39]
    v_mfma_f32_32x32x16_bf16 v[40:55], a[232:235], v[56:59], v[40:55]
    ds_read_b128 v[56:59], v7 offset:768
    s_waitcnt lgkmcnt(5)
    v_mfma_f32_32x32x16_bf16 v[24:39], a[76:79], v[60:63], v[24:39]
    v_mfma_f32_32x32x16_bf16 v[40:55], a[236:239], v[60:63], v[40:55]
    s_add_u32 m0, s31, 24576
    s_nop 0
    buffer_load_dwordx4 v14, s[20:23], s30 offen lds
    ds_read_b128 v[60:63], v7 offset:800
    s_waitcnt lgkmcnt(5)
    v_mfma_f32_32x32x16_bf16 v[24:39], a[80:83], v[64:67], v[24:39]
    v_mfma_f32_32x32x16_bf16 v[40:55], a[240:243], v[64:67], v[40:55]
    ds_read_b128 v[64:67], v7 offset:832
    s_waitcnt lgkmcnt(5)
    v_mfma_f32_32x32x16_bf16 v[24:39], a[84:87], v[68:71], v[24:39]
    v_mfma_f32_32x32x16_bf16 v[40:55], a[244:247], v[68:71], v[40:55]
    ds_read_b128 v[68:71], v7 offset:864
    s_waitcnt lgkmcnt(5)
    v_mfma_f32_32x32x16_bf16 v[24:39], a[88:91], v[72:75], v[24:39]
    v_mfma_f32_32x32x16_bf16 v[40:55], a[248:251], v[72:75], v[40:55]
    s_add_u32 m0, s31, 28672
    s_nop 0
    buffer_load_dwordx4 v15, s[20:23], s30 offen lds
    ds_read_b128 v[72:75], v7 offset:896
    s_waitcnt lgkmcnt(5)
    v_mfma_f32_32x32x16_bf16 v[24:39], a[92:95], v[76:79], v[24:39]
    v_mfma_f32_32x32x16_bf16 v[40:55], a[252:255], v[76:79], v[40:55]
    ds_read_b128 v[76:79], v7 offset:928
    s_waitcnt lgkmcnt(5)
    v_mfma_f32_32x32x16_bf16 v[24:39], a[96:99], v[56:59], v[24:39]
    v_mfma_f32_32x32x16_bf16 v[40:55], v[96:99], v[56:59], v[40:55]
    ds_read_b128 v[56:59], v7 offset:960
    s_waitcnt lgkmcnt(5)
    v_mfma_f32_32x32x16_bf16 v[24:39], a[100:103], v[60:63], v[24:39]
    v_mfma_f32_32x32x16_bf16 v[40:55], v[100:103], v[60:63], v[40:55]
    s_add_u32 m0, s31, 32768
    s_nop 0
    buffer_load_dwordx4 v16, s[20:23], s30 offen lds
    ds_read_b128 v[60:63], v7 offset:992
    s_waitcnt lgkmcnt(5)
    v_mfma_f32_32x32x16_bf16 v[24:39], a[104:107], v[64:67], v[24:39]
    v_mfma_f32_32x32x16_bf16 v[40:55], v[104:107], v[64:67], v[40:55]
    ds_read_b128 v[64:67], v7 offset:1024
    s_waitcnt lgkmcnt(5)
    v_mfma_f32_32x32x16_bf16 v[24:39], a[108:111], v[68:71], v[24:39]
    v_mfma_f32_32x32x16_bf16 v[40:55], v[108:111], v[68:71], v[40:55]
    ds_read_b128 v[68:71], v7 offset:1056
    s_waitcnt lgkmcnt(5)
    v_mfma_f32_32x32x16_bf16 v[24:39], a[112:115], v[72:75], v[24:39]
    v_mfma_f32_32x32x16_bf16 v[40:55], v[112:115], v[72:75], v[40:55]
    s_add_u32 m0, s31, 36864
    s_nop 0
    buffer_load_dwordx4 v17, s[20:23], s30 offen lds
    ds_read_b128 v[72:75], v7 offset:1088
    s_waitcnt lgkmcnt(5)
    v_mfma_f32_32x32x16_bf16 v[24:39], a[116:119], v[76:79], v[24:39]
    v_mfma_f32_32x32x16_bf16 v[40:55], v[116:119], v[76:79], v[40:55]
    ds_read_b128 v[76:79], v7 offset:1120
    s_waitcnt lgkmcnt(5)
    v_mfma_f32_32x32x16_bf16 v[24:39], a[120:123], v[56:59], v[24:39]
    v_mfma_f32_32x32x16_bf16 v[40:55], v[120:123], v[56:59], v[40:55]
    ds_read_b128 v[56:59], v7 offset:1152
    s_waitcnt lgkmcnt(5)
    v_mfma_f32_32x32x16_bf16 v[24:39], a[124:127], v[60:63], v[24:39]
    v_mfma_f32_32x32x16_bf16 v[40:55], v[124:127], v[60:63], v[40:55]
    s_add_u32 m0, s31, 40960
    s_nop 0
    buffer_load_dwordx4 v18, s[20:23], s30 offen lds
    ds_read_b128 v[60:63], v7 offset:1184
    s_waitcnt lgkmcnt(5)
    v_mfma_f32_32x32x16_bf16 v[24:39], a[128:131], v[64:67], v[24:39]
    v_mfma_f32_32x32x16_bf16 v[40:55], v[128:131], v[64:67], v[40:55]
    ds_read_b128 v[64:67], v7 offset:1216
    s_waitcnt lgkmcnt(5)
    v_mfma_f32_32x32x16_bf16 v[24:39], a[132:135], v[68:71], v[24:39]
    v_mfma_f32_32x32x16_bf16 v[40:55], v[132:135], v[68:71], v[40:55]
    ds_read_b128 v[68:71], v7 offset:1248
    s_waitcnt lgkmcnt(5)
    v_mfma_f32_32x32x16_bf16 v[24:39], a[136:139], v[72:75], v[24:39]
    v_mfma_f32_32x32x16_bf16 v[40:55], v[136:139], v[72:75], v[40:55]
    s_waitcnt lgkmcnt(4)
    v_mfma_f32_32x32x16_bf16 v[24:39], a[140:143], v[76:79], v[24:39]
    v_mfma_f32_32x32x16_bf16 v[40:55], v[140:143], v[76:79], v[40:55]
    s_waitcnt lgkmcnt(3)
    v_mfma_f32_32x32x16_bf16 v[24:39], a[144:147], v[56:59], v[24:39]
    v_mfma_f32_32x32x16_bf16 v[40:55], v[144:147], v[56:59], v[40:55]
    s_waitcnt lgkmcnt(2)
    v_mfma_f32_32x32x16_bf16 v[24:39], a[148:151], v[60:63], v[24:39]
    v_mfma_f32_32x32x16_bf16 v[40:55], v[148:151], v[60:63], v[40:55]
    s_waitcnt lgkmcnt(1)
    v_mfma_f32_32x32x16_bf16 v[24:39], a[152:155], v[64:67], v[24:39]
    v_mfma_f32_32x32x16_bf16 v[40:55], v[152:155], v[64:67], v[40:55]
    s_waitcnt lgkmcnt(0)
    v_mfma_f32_32x32x16_bf16 v[24:39], a[156:159], v[68:71], v[24:39]
    v_mfma_f32_32x32x16_bf16 v[40:55], v[156:159], v[68:71], v[40:55]
    s_nop 11
    s_lshl_b32 s28, s25, 13
    s_add_u32 s28, s28, s27
    s_add_u32 s29, s28, 524288
    v_cvt_pk_bf16_f32 v80, v24, v25
    v_cvt_pk_bf16_f32 v81, v26, v27
    v_cvt_pk_bf16_f32 v82, v28, v29
    v_cvt_pk_bf16_f32 v83, v30, v31
    v_cvt_pk_bf16_f32 v84, v32, v33
    v_cvt_pk_bf16_f32 v85, v34, v35
    v_cvt_pk_bf16_f32 v86, v36, v37
    v_cvt_pk_bf16_f32 v87, v38, v39
    s_nop 1
    v_permlane32_swap_b32 v80, v82
    v_permlane32_swap_b32 v81, v83
    v_permlane32_swap_b32 v84, v86
    v_permlane32_swap_b32 v85, v87
    s_nop 0
    buffer_store_dwordx4 v[80:83], v20, s[4:7], s28 offen sc1
    buffer_store_dwordx4 v[84:87], v20, s[4:7], s28 offen offset:512 sc1
    v_cvt_pk_bf16_f32 v88, v40, v41
    v_cvt_pk_bf16_f32 v89, v42, v43
    v_cvt_pk_bf16_f32 v90, v44, v45
    v_cvt_pk_bf16_f32 v91, v46, v47
    v_cvt_pk_bf16_f32 v92, v48, v49
    v_cvt_pk_bf16_f32 v93, v50, v51
    v_cvt_pk_bf16_f32 v94, v52, v53
    v_cvt_pk_bf16_f32 v95, v54, v55
    s_nop 1
    v_permlane32_swap_b32 v88, v90
    v_permlane32_swap_b32 v89, v91
    v_permlane32_swap_b32 v92, v94
    v_permlane32_swap_b32 v93, v95
    s_nop 0
    buffer_store_dwordx4 v[88:91], v20, s[4:7], s29 offen sc1
    buffer_store_dwordx4 v[92:95], v20, s[4:7], s29 offen offset:512 sc1
    s_cmp_eq_u32 s34, -1
    s_cbranch_scc0 CH_cont107
    s_waitcnt vmcnt(0)
    s_barrier
    s_cmp_lg_u32 s8, 0
    s_cbranch_scc1 CH_sg109
    s_lshl_b32 s29, s25, 2
    s_add_u32 s29, s29, s33
    v_mov_b32 v2, s29
    v_mov_b32 v3, 1
    s_mov_b64 exec, 1
    buffer_atomic_add v3, v2, s[4:7], 0 offen sc1
    s_mov_b64 exec, -1
CH_sg109:
    s_mov_b32 s34, -2
    s_branch CH_cont107_2
CH_cont107:
    s_mov_b32 s35, s34
    s_mov_b32 s34, s25
    s_cmp_eq_u32 s35, -2
    s_cselect_b32 s35, -1, s35
CH_cont107_2:
    s_add_u32 s25, s25, s26
    s_cmp_lt_u32 s25, 64
    s_cbranch_scc1 CH_top103
    s_waitcnt vmcnt(0)
    s_barrier
    s_cmp_gt_u32 s35, 63
    s_cbranch_scc1 CH_fin110
    s_cmp_lg_u32 s8, 0
    s_cbranch_scc1 CH_sg111
    s_lshl_b32 s29, s35, 2
    s_add_u32 s29, s29, s33
    v_mov_b32 v2, s29
    v_mov_b32 v3, 1
    s_mov_b64 exec, 1
    buffer_atomic_add v3, v2, s[4:7], 0 offen sc1
    s_mov_b64 exec, -1
CH_sg111:
CH_fin110:
    s_cmp_gt_u32 s34, 63
    s_cbranch_scc1 CH_fin112
    s_cmp_lg_u32 s8, 0
    s_cbranch_scc1 CH_sg113
    s_lshl_b32 s29, s34, 2
    s_add_u32 s29, s29, s33
    v_mov_b32 v2, s29
    v_mov_b32 v3, 1
    s_mov_b64 exec, 1
    buffer_atomic_add v3, v2, s[4:7], 0 offen sc1
    s_mov_b64 exec, -1
CH_sg113:
CH_fin112:
CH_wtop86:
    s_cmp_lg_u32 s8, 0
    s_cbranch_scc1 CH_wnw87
    s_mov_b64 exec, 1
    v_mov_b32 v2, 85997696
    v_mov_b32 v3, 1
    buffer_atomic_add v3, v2, s[4:7], 0 offen sc0
    s_waitcnt vmcnt(0)
    v_mov_b32 v2, 143296
    ds_write_b32 v2, v3
    s_waitcnt lgkmcnt(0)
    s_mov_b64 exec, -1
CH_wnw87:
    s_barrier
    v_mov_b32 v2, 143296
    ds_read_b32 v3, v2
    s_waitcnt lgkmcnt(0)
    s_nop 0
    v_readfirstlane_b32 s13, v3
    s_nop 3
    s_barrier
    s_cmp_ge_u32 s13, 1224
    s_cbranch_scc1 CH_end
    s_mov_b32 s66, s13
    s_cmp_ge_u32 s13, 320
    s_cbranch_scc1 CH_wao91
    s_cmp_ge_u32 s13, 160
    s_cbranch_scc1 CH_wssm90
    s_cmp_ge_u32 s13, 128
    s_cbranch_scc1 CH_wwof89
    s_lshr_b32 s24, s13, 3
    s_add_u32 s24, s24, 32
    s_and_b32 s25, s13, 7
    s_mov_b32 s26, 8
    s_branch CH_wgemm92
CH_wwof89:
    s_sub_u32 s10, s13, 128
    s_lshl_b32 s10, s10, 2
    s_add_u32 s9, s10, 0
    s_load_dwordx2 s[26:27], s[0:1], 112
    s_waitcnt lgkmcnt(0)
    s_mov_b32 s16, s26
    s_and_b32 s17, s27, 0xffff
    s_mov_b32 s18, 5242880
    s_mov_b32 s19, 0x20000
    s_mul_i32 s20, s9, 40960
    v_lshlrev_b32 v2, 4, v0
    s_lshl_b32 s21, s8, 10
    s_add_u32 m0, s21, 0
    s_add_u32 s22, s20, 0
    s_nop 0
    buffer_load_dwordx4 v2, s[16:19], s22 offen lds
    s_add_u32 m0, s21, 4096
    s_add_u32 s22, s20, 4096
    s_nop 0
    buffer_load_dwordx4 v2, s[16:19], s22 offen lds
    s_add_u32 m0, s21, 8192
    s_add_u32 s22, s20, 8192
    s_nop 0
    buffer_load_dwordx4 v2, s[16:19], s22 offen lds
    s_add_u32 m0, s21, 12288
    s_add_u32 s22, s20, 12288
    s_nop 0
    buffer_load_dwordx4 v2, s[16:19], s22 offen lds
    s_add_u32 m0, s21, 16384
    s_add_u32 s22, s20, 16384
    s_nop 0
    buffer_load_dwordx4 v2, s[16:19], s22 offen lds
    s_add_u32 m0, s21, 20480
    s_add_u32 s22, s20, 20480
    s_nop 0
    buffer_load_dwordx4 v2, s[16:19], s22 offen lds
    s_add_u32 m0, s21, 24576
    s_add_u32 s22, s20, 24576
    s_nop 0
    buffer_load_dwordx4 v2, s[16:19], s22 offen lds
    s_add_u32 m0, s21, 28672
    s_add_u32 s22, s20, 28672
    s_nop 0
    buffer_load_dwordx4 v2, s[16:19], s22 offen lds
    s_add_u32 m0, s21, 32768
    s_add_u32 s22, s20, 32768
    s_nop 0
    buffer_load_dwordx4 v2, s[16:19], s22 offen lds
    s_add_u32 m0, s21, 36864
    s_add_u32 s22, s20, 36864
    s_nop 0
    buffer_load_dwordx4 v2, s[16:19], s22 offen lds
    s_waitcnt vmcnt(0)
    s_barrier
    v_and_b32 v3, 15, v1
    v_lshrrev_b32 v3, 2, v3
    v_lshrrev_b32 v4, 4, v1
    v_lshlrev_b32 v4, 3, v4
    v_add_u32 v3, v3, v4
    v_mul_u32_u24 v3, 1280, v3
    v_and_b32 v4, 3, v1
    v_lshlrev_b32 v4, 3, v4
    s_mul_i32 s21, s8, 320
    v_add3_u32 v3, v3, v4, s21
    v_lshlrev_b32 v5, 4, v1
    s_mul_i32 s22, s8, 1310720
    s_lshl_b32 s23, s9, 10
    s_add_u32 s22, s22, s23
    s_add_u32 s22, s22, 88080384
    ds_read_b64_tr_b16 v[8:9], v3 offset:0
    ds_read_b64_tr_b16 v[10:11], v3 offset:5120
    ds_read_b64_tr_b16 v[12:13], v3 offset:32
    ds_read_b64_tr_b16 v[14:15], v3 offset:5152
    ds_read_b64_tr_b16 v[16:17], v3 offset:64
    ds_read_b64_tr_b16 v[18:19], v3 offset:5184
    ds_read_b64_tr_b16 v[20:21], v3 offset:96
    ds_read_b64_tr_b16 v[22:23], v3 offset:5216
    ds_read_b64_tr_b16 v[24:25], v3 offset:128
    ds_read_b64_tr_b16 v[26:27], v3 offset:5248
    ds_read_b64_tr_b16 v[28:29], v3 offset:160
    ds_read_b64_tr_b16 v[30:31], v3 offset:5280
    ds_read_b64_tr_b16 v[32:33], v3 offset:192
    ds_read_b64_tr_b16 v[34:35], v3 offset:5312
    ds_read_b64_tr_b16 v[36:37], v3 offset:224
    ds_read_b64_tr_b16 v[38:39], v3 offset:5344
    ds_read_b64_tr_b16 v[40:41], v3 offset:256
    ds_read_b64_tr_b16 v[42:43], v3 offset:5376
    ds_read_b64_tr_b16 v[44:45], v3 offset:288
    ds_read_b64_tr_b16 v[46:47], v3 offset:5408
    s_waitcnt lgkmcnt(0)
    buffer_store_dwordx4 v[8:11], v5, s[4:7], s22 offen sc1
    s_add_u32 s22, s22, 131072
    buffer_store_dwordx4 v[12:15], v5, s[4:7], s22 offen sc1
    s_add_u32 s22, s22, 131072
    buffer_store_dwordx4 v[16:19], v5, s[4:7], s22 offen sc1
    s_add_u32 s22, s22, 131072
    buffer_store_dwordx4 v[20:23], v5, s[4:7], s22 offen sc1
    s_add_u32 s22, s22, 131072
    buffer_store_dwordx4 v[24:27], v5, s[4:7], s22 offen sc1
    s_add_u32 s22, s22, 131072
    buffer_store_dwordx4 v[28:31], v5, s[4:7], s22 offen sc1
    s_add_u32 s22, s22, 131072
    buffer_store_dwordx4 v[32:35], v5, s[4:7], s22 offen sc1
    s_add_u32 s22, s22, 131072
    buffer_store_dwordx4 v[36:39], v5, s[4:7], s22 offen sc1
    s_add_u32 s22, s22, 131072
    buffer_store_dwordx4 v[40:43], v5, s[4:7], s22 offen sc1
    s_add_u32 s22, s22, 131072
    buffer_store_dwordx4 v[44:47], v5, s[4:7], s22 offen sc1
    s_add_u32 s22, s22, 131072
    s_waitcnt vmcnt(0)
    s_barrier
    s_add_u32 s9, s10, 1
    s_load_dwordx2 s[26:27], s[0:1], 112
    s_waitcnt lgkmcnt(0)
    s_mov_b32 s16, s26
    s_and_b32 s17, s27, 0xffff
    s_mov_b32 s18, 5242880
    s_mov_b32 s19, 0x20000
    s_mul_i32 s20, s9, 40960
    v_lshlrev_b32 v2, 4, v0
    s_lshl_b32 s21, s8, 10
    s_add_u32 m0, s21, 0
    s_add_u32 s22, s20, 0
    s_nop 0
    buffer_load_dwordx4 v2, s[16:19], s22 offen lds
    s_add_u32 m0, s21, 4096
    s_add_u32 s22, s20, 4096
    s_nop 0
    buffer_load_dwordx4 v2, s[16:19], s22 offen lds
    s_add_u32 m0, s21, 8192
    s_add_u32 s22, s20, 8192
    s_nop 0
    buffer_load_dwordx4 v2, s[16:19], s22 offen lds
    s_add_u32 m0, s21, 12288
    s_add_u32 s22, s20, 12288
    s_nop 0
    buffer_load_dwordx4 v2, s[16:19], s22 offen lds
    s_add_u32 m0, s21, 16384
    s_add_u32 s22, s20, 16384
    s_nop 0
    buffer_load_dwordx4 v2, s[16:19], s22 offen lds
    s_add_u32 m0, s21, 20480
    s_add_u32 s22, s20, 20480
    s_nop 0
    buffer_load_dwordx4 v2, s[16:19], s22 offen lds
    s_add_u32 m0, s21, 24576
    s_add_u32 s22, s20, 24576
    s_nop 0
    buffer_load_dwordx4 v2, s[16:19], s22 offen lds
    s_add_u32 m0, s21, 28672
    s_add_u32 s22, s20, 28672
    s_nop 0
    buffer_load_dwordx4 v2, s[16:19], s22 offen lds
    s_add_u32 m0, s21, 32768
    s_add_u32 s22, s20, 32768
    s_nop 0
    buffer_load_dwordx4 v2, s[16:19], s22 offen lds
    s_add_u32 m0, s21, 36864
    s_add_u32 s22, s20, 36864
    s_nop 0
    buffer_load_dwordx4 v2, s[16:19], s22 offen lds
    s_waitcnt vmcnt(0)
    s_barrier
    v_and_b32 v3, 15, v1
    v_lshrrev_b32 v3, 2, v3
    v_lshrrev_b32 v4, 4, v1
    v_lshlrev_b32 v4, 3, v4
    v_add_u32 v3, v3, v4
    v_mul_u32_u24 v3, 1280, v3
    v_and_b32 v4, 3, v1
    v_lshlrev_b32 v4, 3, v4
    s_mul_i32 s21, s8, 320
    v_add3_u32 v3, v3, v4, s21
    v_lshlrev_b32 v5, 4, v1
    s_mul_i32 s22, s8, 1310720
    s_lshl_b32 s23, s9, 10
    s_add_u32 s22, s22, s23
    s_add_u32 s22, s22, 88080384
    ds_read_b64_tr_b16 v[8:9], v3 offset:0
    ds_read_b64_tr_b16 v[10:11], v3 offset:5120
    ds_read_b64_tr_b16 v[12:13], v3 offset:32
    ds_read_b64_tr_b16 v[14:15], v3 offset:5152
    ds_read_b64_tr_b16 v[16:17], v3 offset:64
    ds_read_b64_tr_b16 v[18:19], v3 offset:5184
    ds_read_b64_tr_b16 v[20:21], v3 offset:96
    ds_read_b64_tr_b16 v[22:23], v3 offset:5216
    ds_read_b64_tr_b16 v[24:25], v3 offset:128
    ds_read_b64_tr_b16 v[26:27], v3 offset:5248
    ds_read_b64_tr_b16 v[28:29], v3 offset:160
    ds_read_b64_tr_b16 v[30:31], v3 offset:5280
    ds_read_b64_tr_b16 v[32:33], v3 offset:192
    ds_read_b64_tr_b16 v[34:35], v3 offset:5312
    ds_read_b64_tr_b16 v[36:37], v3 offset:224
    ds_read_b64_tr_b16 v[38:39], v3 offset:5344
    ds_read_b64_tr_b16 v[40:41], v3 offset:256
    ds_read_b64_tr_b16 v[42:43], v3 offset:5376
    ds_read_b64_tr_b16 v[44:45], v3 offset:288
    ds_read_b64_tr_b16 v[46:47], v3 offset:5408
    s_waitcnt lgkmcnt(0)
    buffer_store_dwordx4 v[8:11], v5, s[4:7], s22 offen sc1
    s_add_u32 s22, s22, 131072
    buffer_store_dwordx4 v[12:15], v5, s[4:7], s22 offen sc1
    s_add_u32 s22, s22, 131072
    buffer_store_dwordx4 v[16:19], v5, s[4:7], s22 offen sc1
    s_add_u32 s22, s22, 131072
    buffer_store_dwordx4 v[20:23], v5, s[4:7], s22 offen sc1
    s_add_u32 s22, s22, 131072
    buffer_store_dwordx4 v[24:27], v5, s[4:7], s22 offen sc1
    s_add_u32 s22, s22, 131072
    buffer_store_dwordx4 v[28:31], v5, s[4:7], s22 offen sc1
    s_add_u32 s22, s22, 131072
    buffer_store_dwordx4 v[32:35], v5, s[4:7], s22 offen sc1
    s_add_u32 s22, s22, 131072
    buffer_store_dwordx4 v[36:39], v5, s[4:7], s22 offen sc1
    s_add_u32 s22, s22, 131072
    buffer_store_dwordx4 v[40:43], v5, s[4:7], s22 offen sc1
    s_add_u32 s22, s22, 131072
    buffer_store_dwordx4 v[44:47], v5, s[4:7], s22 offen sc1
    s_add_u32 s22, s22, 131072
    s_waitcnt vmcnt(0)
    s_barrier
    s_add_u32 s9, s10, 2
    s_load_dwordx2 s[26:27], s[0:1], 112
    s_waitcnt lgkmcnt(0)
    s_mov_b32 s16, s26
    s_and_b32 s17, s27, 0xffff
    s_mov_b32 s18, 5242880
    s_mov_b32 s19, 0x20000
    s_mul_i32 s20, s9, 40960
    v_lshlrev_b32 v2, 4, v0
    s_lshl_b32 s21, s8, 10
    s_add_u32 m0, s21, 0
    s_add_u32 s22, s20, 0
    s_nop 0
    buffer_load_dwordx4 v2, s[16:19], s22 offen lds
    s_add_u32 m0, s21, 4096
    s_add_u32 s22, s20, 4096
    s_nop 0
    buffer_load_dwordx4 v2, s[16:19], s22 offen lds
    s_add_u32 m0, s21, 8192
    s_add_u32 s22, s20, 8192
    s_nop 0
    buffer_load_dwordx4 v2, s[16:19], s22 offen lds
    s_add_u32 m0, s21, 12288
    s_add_u32 s22, s20, 12288
    s_nop 0
    buffer_load_dwordx4 v2, s[16:19], s22 offen lds
    s_add_u32 m0, s21, 16384
    s_add_u32 s22, s20, 16384
    s_nop 0
    buffer_load_dwordx4 v2, s[16:19], s22 offen lds
    s_add_u32 m0, s21, 20480
    s_add_u32 s22, s20, 20480
    s_nop 0
    buffer_load_dwordx4 v2, s[16:19], s22 offen lds
    s_add_u32 m0, s21, 24576
    s_add_u32 s22, s20, 24576
    s_nop 0
    buffer_load_dwordx4 v2, s[16:19], s22 offen lds
    s_add_u32 m0, s21, 28672
    s_add_u32 s22, s20, 28672
    s_nop 0
    buffer_load_dwordx4 v2, s[16:19], s22 offen lds
    s_add_u32 m0, s21, 32768
    s_add_u32 s22, s20, 32768
    s_nop 0
    buffer_load_dwordx4 v2, s[16:19], s22 offen lds
    s_add_u32 m0, s21, 36864
    s_add_u32 s22, s20, 36864
    s_nop 0
    buffer_load_dwordx4 v2, s[16:19], s22 offen lds
    s_waitcnt vmcnt(0)
    s_barrier
    v_and_b32 v3, 15, v1
    v_lshrrev_b32 v3, 2, v3
    v_lshrrev_b32 v4, 4, v1
    v_lshlrev_b32 v4, 3, v4
    v_add_u32 v3, v3, v4
    v_mul_u32_u24 v3, 1280, v3
    v_and_b32 v4, 3, v1
    v_lshlrev_b32 v4, 3, v4
    s_mul_i32 s21, s8, 320
    v_add3_u32 v3, v3, v4, s21
    v_lshlrev_b32 v5, 4, v1
    s_mul_i32 s22, s8, 1310720
    s_lshl_b32 s23, s9, 10
    s_add_u32 s22, s22, s23
    s_add_u32 s22, s22, 88080384
    ds_read_b64_tr_b16 v[8:9], v3 offset:0
    ds_read_b64_tr_b16 v[10:11], v3 offset:5120
    ds_read_b64_tr_b16 v[12:13], v3 offset:32
    ds_read_b64_tr_b16 v[14:15], v3 offset:5152
    ds_read_b64_tr_b16 v[16:17], v3 offset:64
    ds_read_b64_tr_b16 v[18:19], v3 offset:5184
    ds_read_b64_tr_b16 v[20:21], v3 offset:96
    ds_read_b64_tr_b16 v[22:23], v3 offset:5216
    ds_read_b64_tr_b16 v[24:25], v3 offset:128
    ds_read_b64_tr_b16 v[26:27], v3 offset:5248
    ds_read_b64_tr_b16 v[28:29], v3 offset:160
    ds_read_b64_tr_b16 v[30:31], v3 offset:5280
    ds_read_b64_tr_b16 v[32:33], v3 offset:192
    ds_read_b64_tr_b16 v[34:35], v3 offset:5312
    ds_read_b64_tr_b16 v[36:37], v3 offset:224
    ds_read_b64_tr_b16 v[38:39], v3 offset:5344
    ds_read_b64_tr_b16 v[40:41], v3 offset:256
    ds_read_b64_tr_b16 v[42:43], v3 offset:5376
    ds_read_b64_tr_b16 v[44:45], v3 offset:288
    ds_read_b64_tr_b16 v[46:47], v3 offset:5408
    s_waitcnt lgkmcnt(0)
    buffer_store_dwordx4 v[8:11], v5, s[4:7], s22 offen sc1
    s_add_u32 s22, s22, 131072
    buffer_store_dwordx4 v[12:15], v5, s[4:7], s22 offen sc1
    s_add_u32 s22, s22, 131072
    buffer_store_dwordx4 v[16:19], v5, s[4:7], s22 offen sc1
    s_add_u32 s22, s22, 131072
    buffer_store_dwordx4 v[20:23], v5, s[4:7], s22 offen sc1
    s_add_u32 s22, s22, 131072
    buffer_store_dwordx4 v[24:27], v5, s[4:7], s22 offen sc1
    s_add_u32 s22, s22, 131072
    buffer_store_dwordx4 v[28:31], v5, s[4:7], s22 offen sc1
    s_add_u32 s22, s22, 131072
    buffer_store_dwordx4 v[32:35], v5, s[4:7], s22 offen sc1
    s_add_u32 s22, s22, 131072
    buffer_store_dwordx4 v[36:39], v5, s[4:7], s22 offen sc1
    s_add_u32 s22, s22, 131072
    buffer_store_dwordx4 v[40:43], v5, s[4:7], s22 offen sc1
    s_add_u32 s22, s22, 131072
    buffer_store_dwordx4 v[44:47], v5, s[4:7], s22 offen sc1
    s_add_u32 s22, s22, 131072
    s_waitcnt vmcnt(0)
    s_barrier
    s_add_u32 s9, s10, 3
    s_load_dwordx2 s[26:27], s[0:1], 112
    s_waitcnt lgkmcnt(0)
    s_mov_b32 s16, s26
    s_and_b32 s17, s27, 0xffff
    s_mov_b32 s18, 5242880
    s_mov_b32 s19, 0x20000
    s_mul_i32 s20, s9, 40960
    v_lshlrev_b32 v2, 4, v0
    s_lshl_b32 s21, s8, 10
    s_add_u32 m0, s21, 0
    s_add_u32 s22, s20, 0
    s_nop 0
    buffer_load_dwordx4 v2, s[16:19], s22 offen lds
    s_add_u32 m0, s21, 4096
    s_add_u32 s22, s20, 4096
    s_nop 0
    buffer_load_dwordx4 v2, s[16:19], s22 offen lds
    s_add_u32 m0, s21, 8192
    s_add_u32 s22, s20, 8192
    s_nop 0
    buffer_load_dwordx4 v2, s[16:19], s22 offen lds
    s_add_u32 m0, s21, 12288
    s_add_u32 s22, s20, 12288
    s_nop 0
    buffer_load_dwordx4 v2, s[16:19], s22 offen lds
    s_add_u32 m0, s21, 16384
    s_add_u32 s22, s20, 16384
    s_nop 0
    buffer_load_dwordx4 v2, s[16:19], s22 offen lds
    s_add_u32 m0, s21, 20480
    s_add_u32 s22, s20, 20480
    s_nop 0
    buffer_load_dwordx4 v2, s[16:19], s22 offen lds
    s_add_u32 m0, s21, 24576
    s_add_u32 s22, s20, 24576
    s_nop 0
    buffer_load_dwordx4 v2, s[16:19], s22 offen lds
    s_add_u32 m0, s21, 28672
    s_add_u32 s22, s20, 28672
    s_nop 0
    buffer_load_dwordx4 v2, s[16:19], s22 offen lds
    s_add_u32 m0, s21, 32768
    s_add_u32 s22, s20, 32768
    s_nop 0
    buffer_load_dwordx4 v2, s[16:19], s22 offen lds
    s_add_u32 m0, s21, 36864
    s_add_u32 s22, s20, 36864
    s_nop 0
    buffer_load_dwordx4 v2, s[16:19], s22 offen lds
    s_waitcnt vmcnt(0)
    s_barrier
    v_and_b32 v3, 15, v1
    v_lshrrev_b32 v3, 2, v3
    v_lshrrev_b32 v4, 4, v1
    v_lshlrev_b32 v4, 3, v4
    v_add_u32 v3, v3, v4
    v_mul_u32_u24 v3, 1280, v3
    v_and_b32 v4, 3, v1
    v_lshlrev_b32 v4, 3, v4
    s_mul_i32 s21, s8, 320
    v_add3_u32 v3, v3, v4, s21
    v_lshlrev_b32 v5, 4, v1
    s_mul_i32 s22, s8, 1310720
    s_lshl_b32 s23, s9, 10
    s_add_u32 s22, s22, s23
    s_add_u32 s22, s22, 88080384
    ds_read_b64_tr_b16 v[8:9], v3 offset:0
    ds_read_b64_tr_b16 v[10:11], v3 offset:5120
    ds_read_b64_tr_b16 v[12:13], v3 offset:32
    ds_read_b64_tr_b16 v[14:15], v3 offset:5152
    ds_read_b64_tr_b16 v[16:17], v3 offset:64
    ds_read_b64_tr_b16 v[18:19], v3 offset:5184
    ds_read_b64_tr_b16 v[20:21], v3 offset:96
    ds_read_b64_tr_b16 v[22:23], v3 offset:5216
    ds_read_b64_tr_b16 v[24:25], v3 offset:128
    ds_read_b64_tr_b16 v[26:27], v3 offset:5248
    ds_read_b64_tr_b16 v[28:29], v3 offset:160
    ds_read_b64_tr_b16 v[30:31], v3 offset:5280
    ds_read_b64_tr_b16 v[32:33], v3 offset:192
    ds_read_b64_tr_b16 v[34:35], v3 offset:5312
    ds_read_b64_tr_b16 v[36:37], v3 offset:224
    ds_read_b64_tr_b16 v[38:39], v3 offset:5344
    ds_read_b64_tr_b16 v[40:41], v3 offset:256
    ds_read_b64_tr_b16 v[42:43], v3 offset:5376
    ds_read_b64_tr_b16 v[44:45], v3 offset:288
    ds_read_b64_tr_b16 v[46:47], v3 offset:5408
    s_waitcnt lgkmcnt(0)
    buffer_store_dwordx4 v[8:11], v5, s[4:7], s22 offen sc1
    s_add_u32 s22, s22, 131072
    buffer_store_dwordx4 v[12:15], v5, s[4:7], s22 offen sc1
    s_add_u32 s22, s22, 131072
    buffer_store_dwordx4 v[16:19], v5, s[4:7], s22 offen sc1
    s_add_u32 s22, s22, 131072
    buffer_store_dwordx4 v[20:23], v5, s[4:7], s22 offen sc1
    s_add_u32 s22, s22, 131072
    buffer_store_dwordx4 v[24:27], v5, s[4:7], s22 offen sc1
    s_add_u32 s22, s22, 131072
    buffer_store_dwordx4 v[28:31], v5, s[4:7], s22 offen sc1
    s_add_u32 s22, s22, 131072
    buffer_store_dwordx4 v[32:35], v5, s[4:7], s22 offen sc1
    s_add_u32 s22, s22, 131072
    buffer_store_dwordx4 v[36:39], v5, s[4:7], s22 offen sc1
    s_add_u32 s22, s22, 131072
    buffer_store_dwordx4 v[40:43], v5, s[4:7], s22 offen sc1
    s_add_u32 s22, s22, 131072
    buffer_store_dwordx4 v[44:47], v5, s[4:7], s22 offen sc1
    s_add_u32 s22, s22, 131072
    s_waitcnt vmcnt(0)
    s_barrier
    s_mov_b32 s12, 85997568
    s_cmp_lg_u32 s8, 0
    s_cbranch_scc1 CH_sig114
    v_mov_b32 v2, s12
    v_mov_b32 v3, 1
    s_mov_b64 exec, 1
    buffer_atomic_add v3, v2, s[4:7], 0 offen sc1
    s_mov_b64 exec, -1
CH_sig114:
    s_branch CH_wtop86
CH_wssm90:
    s_sub_u32 s13, s13, 160
CH_wssm90_go:
    s_load_dwordx2 s[16:17], s[0:1], 8
    s_load_dwordx2 s[18:19], s[0:1], 16
    s_load_dwordx2 s[20:21], s[0:1], 24
    s_load_dwordx2 s[22:23], s[0:1], 32
    s_load_dwordx2 s[24:25], s[0:1], 40
    s_load_dwordx2 s[26:27], s[0:1], 48
    s_load_dwordx2 s[28:29], s[0:1], 56
    s_load_dwordx2 s[30:31], s[0:1], 64
    s_load_dwordx2 s[32:33], s[0:1], 0
    s_load_dwordx2 s[34:35], s[0:1], 128
    s_lshl_b32 s9, s13, 2
    s_mul_i32 s10, s8, 20480
    s_waitcnt lgkmcnt(0)
    s_mov_b32 s36, s32
    s_and_b32 s37, s33, 0xffff
    s_mov_b32 s38, 2621440
    s_mov_b32 s39, 0x20000
    v_mul_u32_u24 v2, 1280, v0
    s_lshl_b32 s11, s9, 1
    v_add_u32 v2, s11, v2
    s_mov_b32 s12, 0
    buffer_load_dwordx2 v[100:101], v2, s[36:39], s12 offen
    s_mov_b32 s12, 327680
    buffer_load_dwordx2 v[102:103], v2, s[36:39], s12 offen
    s_mov_b32 s12, 655360
    buffer_load_dwordx2 v[104:105], v2, s[36:39], s12 offen
    s_mov_b32 s12, 983040
    buffer_load_dwordx2 v[106:107], v2, s[36:39], s12 offen
    s_mov_b32 s12, 1310720
    buffer_load_dwordx2 v[108:109], v2, s[36:39], s12 offen
    s_mov_b32 s12, 1638400
    buffer_load_dwordx2 v[110:111], v2, s[36:39], s12 offen
    s_mov_b32 s12, 1966080
    buffer_load_dwordx2 v[112:113], v2, s[36:39], s12 offen
    s_mov_b32 s12, 2293760
    buffer_load_dwordx2 v[114:115], v2, s[36:39], s12 offen
    s_add_u32 s11, s9, s8
    s_lshl_b32 s12, s11, 8
    v_lshlrev_b32 v3, 1, v1
    v_add_u32 v3, s12, v3
    s_mov_b32 s40, s16
    s_and_b32 s41, s17, 0xffff
    s_mov_b32 s42, 163840
    s_mov_b32 s43, 0x20000
    buffer_load_ushort v10, v3, s[40:43], 0 offen
    buffer_load_ushort v11, v3, s[40:43], 0 offen offset:128
    s_mov_b32 s40, s18
    s_and_b32 s41, s19, 0xffff
    s_mov_b32 s42, 163840
    s_mov_b32 s43, 0x20000
    buffer_load_ushort v12, v3, s[40:43], 0 offen
    buffer_load_ushort v13, v3, s[40:43], 0 offen offset:128
    s_mov_b32 s40, s20
    s_and_b32 s41, s21, 0xffff
    s_mov_b32 s42, 163840
    s_mov_b32 s43, 0x20000
    buffer_load_ushort v14, v3, s[40:43], 0 offen
    buffer_load_ushort v15, v3, s[40:43], 0 offen offset:128
    s_mov_b32 s40, s22
    s_and_b32 s41, s23, 0xffff
    s_mov_b32 s42, 163840
    s_mov_b32 s43, 0x20000
    buffer_load_ushort v16, v3, s[40:43], 0 offen
    buffer_load_ushort v17, v3, s[40:43], 0 offen offset:128
    s_mov_b32 s40, s24
    s_and_b32 s41, s25, 0xffff
    s_mov_b32 s42, 163840
    s_mov_b32 s43, 0x20000
    buffer_load_ushort v18, v3, s[40:43], 0 offen
    buffer_load_ushort v19, v3, s[40:43], 0 offen offset:128
    s_mov_b32 s40, s26
    s_and_b32 s41, s27, 0xffff
    s_mov_b32 s42, 163840
    s_mov_b32 s43, 0x20000
    buffer_load_ushort v20, v3, s[40:43], 0 offen
    buffer_load_ushort v21, v3, s[40:43], 0 offen offset:128
    s_mov_b32 s40, s28
    s_and_b32 s41, s29, 0xffff
    s_mov_b32 s42, 1280
    s_mov_b32 s43, 0x20000
    s_lshl_b32 s12, s11, 1
    v_mov_b32 v4, s12
    buffer_load_ushort v22, v4, s[40:43], 0 offen
    s_mov_b32 s40, s30
    s_and_b32 s41, s31, 0xffff
    s_mov_b32 s42, 1280
    s_mov_b32 s43, 0x20000
    s_lshl_b32 s12, s9, 1
    v_mov_b32 v4, s12
    buffer_load_dwordx2 v[116:117], v4, s[40:43], 0 offen
    s_waitcnt vmcnt(0)
    v_lshlrev_b32 v22, 16, v22
    v_mul_f32 v22, 0x3fb8aa3b, v22
    v_exp_f32 v22, v22
    s_nop 0
    v_cvt_pk_bf16_f32 v22, v22, v22
    v_lshlrev_b32 v22, 16, v22
    v_lshlrev_b32 v10, 16, v10
    v_lshlrev_b32 v11, 16, v11
    v_lshlrev_b32 v12, 16, v12
    v_lshlrev_b32 v13, 16, v13
    v_lshlrev_b32 v14, 16, v14
    v_lshlrev_b32 v15, 16, v15
    v_lshlrev_b32 v16, 16, v16
    v_lshlrev_b32 v17, 16, v17
    v_lshlrev_b32 v18, 16, v18
    v_lshlrev_b32 v19, 16, v19
    v_lshlrev_b32 v20, 16, v20
    v_lshlrev_b32 v21, 16, v21
    v_lshlrev_b32 v5, 5, v1
    v_add_u32 v5, s10, v5
    v_mul_f32 v24, v22, v10
    v_mul_f32 v24, 0x3fb8aa3b, v24
    v_mul_f32 v25, v22, v12
    v_mul_f32 v25, 0x3e22f983, v25
    v_mul_f32 v30, v22, v14
    v_mul_f32 v31, v22, v16
    v_mul_f32 v26, v18, v30
    v_fma_f32 v26, -v20, v31, v26
    v_mul_f32 v32, v18, v31
    v_fma_f32 v32, v20, v30, v32
    v_sub_f32 v27, 0, v32
    ds_write_b128 v5, v[24:27] offset:0
    v_mov_b32 v28, v24
    v_mov_b32 v29, v25
    v_sub_f32 v31, 0, v26
    v_mov_b32 v30, v27
    ds_write_b128 v5, v[28:31] offset:16
    v_mul_f32 v24, v22, v11
    v_mul_f32 v24, 0x3fb8aa3b, v24
    v_mul_f32 v25, v22, v13
    v_mul_f32 v25, 0x3e22f983, v25
    v_mul_f32 v30, v22, v15
    v_mul_f32 v31, v22, v17
    v_mul_f32 v26, v19, v30
    v_fma_f32 v26, -v21, v31, v26
    v_mul_f32 v32, v19, v31
    v_fma_f32 v32, v21, v30, v32
    v_sub_f32 v27, 0, v32
    ds_write_b128 v5, v[24:27] offset:2048
    v_mov_b32 v28, v24
    v_mov_b32 v29, v25
    v_sub_f32 v31, 0, v26
    v_mov_b32 v30, v27
    ds_write_b128 v5, v[28:31] offset:2064
    v_lshrrev_b32 v6, 6, v0
    v_and_b32 v7, 63, v0
    v_lshlrev_b32 v7, 1, v7
    v_mul_u32_u24 v6, 144, v6
    v_add_u32 v6, v6, v7
    v_add_u32 v6, 15840, v6
    v_add_u32 v8, 0x8000, v6
    ds_write_b16 v6, v100 offset:0
    ds_write_b16_d16_hi v6, v100 offset:20480
    ds_write_b16 v6, v101 offset:40960
    ds_write_b16_d16_hi v6, v101 offset:61440
    ds_write_b16 v6, v102 offset:576
    ds_write_b16_d16_hi v6, v102 offset:21056
    ds_write_b16 v6, v103 offset:41536
    ds_write_b16_d16_hi v6, v103 offset:62016
    ds_write_b16 v6, v104 offset:1152
    ds_write_b16_d16_hi v6, v104 offset:21632
    ds_write_b16 v6, v105 offset:42112
    ds_write_b16_d16_hi v6, v105 offset:62592
    ds_write_b16 v6, v106 offset:1728
    ds_write_b16_d16_hi v6, v106 offset:22208
    ds_write_b16 v6, v107 offset:42688
    ds_write_b16_d16_hi v6, v107 offset:63168
    ds_write_b16 v6, v108 offset:2304
    ds_write_b16_d16_hi v6, v108 offset:22784
    ds_write_b16 v6, v109 offset:43264
    ds_write_b16_d16_hi v6, v109 offset:63744
    ds_write_b16 v6, v110 offset:2880
    ds_write_b16_d16_hi v6, v110 offset:23360
    ds_write_b16 v6, v111 offset:43840
    ds_write_b16_d16_hi v6, v111 offset:64320
    ds_write_b16 v6, v112 offset:3456
    ds_write_b16_d16_hi v6, v112 offset:23936
    ds_write_b16 v6, v113 offset:44416
    ds_write_b16_d16_hi v6, v113 offset:64896
    ds_write_b16 v6, v114 offset:4032
    ds_write_b16_d16_hi v6, v114 offset:24512
    ds_write_b16 v6, v115 offset:44992
    ds_write_b16_d16_hi v6, v115 offset:65472
    v_lshlrev_b32 v9, 2, v1
    v_add_u32 v9, s10, v9
    v_mov_b32 v24, 0
    v_cmp_gt_u32 vcc, 36, v1
    s_and_saveexec_b64 s[44:45], vcc
    ds_write_b32 v9, v24 offset:15696
    s_mov_b64 exec, s[44:45]
    s_waitcnt lgkmcnt(0)
    s_barrier
    v_and_b32 v6, 15, v1
    v_lshrrev_b32 v7, 4, v1
    v_cvt_f32_u32 v8, v6
    v_lshlrev_b32 v9, 4, v7
    v_add_u32 v9, s10, v9
    v_and_b32 v10, 1, v7
    v_cvt_f32_u32 v10, v10
    v_mul_f32 v10, 0xbe800000, v10
    v_lshlrev_b32 v11, 6, v7
    v_add_u32 v11, v11, v6
    v_lshlrev_b32 v11, 2, v11
    v_add_u32 v11, s10, v11
    v_mul_f32 v12, 0x41800000, v8
    v_mul_f32 v13, 0x3f800000, v8
    ds_read_b128 v[40:43], v9 offset:0
    ds_read_b128 v[44:47], v9 offset:64
    ds_read_b128 v[48:51], v9 offset:128
    ds_read_b128 v[52:55], v9 offset:192
    s_mov_b32 s11, 0
    v_mov_b32 v14, v9
    v_mov_b32 v60, 0
    v_mov_b32 v61, 0
    v_mov_b32 v62, 0
    v_mov_b32 v63, 0
CH_kg115:
    s_waitcnt lgkmcnt(3)
    v_mul_f32 v20, v40, v12
    v_mul_f32 v21, v41, v12
    v_mul_f32 v22, v40, v13
    v_fma_f32 v23, v41, v13, v10
    v_exp_f32 v20, v20
    v_fract_f32 v21, v21
    v_exp_f32 v22, v22
    v_fract_f32 v23, v23
    v_sin_f32 v24, v21
    v_cos_f32 v21, v21
    v_cos_f32 v23, v23
    v_mul_f32 v24, v43, v24
    v_fma_f32 v24, v42, v21, v24
    v_mul_f32 v26, v20, v24
    v_mul_f32 v27, v22, v23
    ds_read_b128 v[40:43], v14 offset:256
    s_nop 0
    v_mfma_f32_16x16x4_f32 v[60:63], v26, v27, v[60:63]
    s_waitcnt lgkmcnt(3)
    v_mul_f32 v20, v44, v12
    v_mul_f32 v21, v45, v12
    v_mul_f32 v22, v44, v13
    v_fma_f32 v23, v45, v13, v10
    v_exp_f32 v20, v20
    v_fract_f32 v21, v21
    v_exp_f32 v22, v22
    v_fract_f32 v23, v23
    v_sin_f32 v24, v21
    v_cos_f32 v21, v21
    v_cos_f32 v23, v23
    v_mul_f32 v24, v47, v24
    v_fma_f32 v24, v46, v21, v24
    v_mul_f32 v28, v20, v24
    v_mul_f32 v29, v22, v23
    ds_read_b128 v[44:47], v14 offset:320
    s_nop 0
    v_mfma_f32_16x16x4_f32 v[60:63], v28, v29, v[60:63]
    s_waitcnt lgkmcnt(3)
    v_mul_f32 v20, v48, v12
    v_mul_f32 v21, v49, v12
    v_mul_f32 v22, v48, v13
    v_fma_f32 v23, v49, v13, v10
    v_exp_f32 v20, v20
    v_fract_f32 v21, v21
    v_exp_f32 v22, v22
    v_fract_f32 v23, v23
    v_sin_f32 v24, v21
    v_cos_f32 v21, v21
    v_cos_f32 v23, v23
    v_mul_f32 v24, v51, v24
    v_fma_f32 v24, v50, v21, v24
    v_mul_f32 v26, v20, v24
    v_mul_f32 v27, v22, v23
    ds_read_b128 v[48:51], v14 offset:384
    s_nop 0
    v_mfma_f32_16x16x4_f32 v[60:63], v26, v27, v[60:63]
    s_waitcnt lgkmcnt(3)
    v_mul_f32 v20, v52, v12
    v_mul_f32 v21, v53, v12
    v_mul_f32 v22, v52, v13
    v_fma_f32 v23, v53, v13, v10
    v_exp_f32 v20, v20
    v_fract_f32 v21, v21
    v_exp_f32 v22, v22
    v_fract_f32 v23, v23
    v_sin_f32 v24, v21
    v_cos_f32 v21, v21
    v_cos_f32 v23, v23
    v_mul_f32 v24, v55, v24
    v_fma_f32 v24, v54, v21, v24
    v_mul_f32 v28, v20, v24
    v_mul_f32 v29, v22, v23
    ds_read_b128 v[52:55], v14 offset:448
    s_nop 0
    v_mfma_f32_16x16x4_f32 v[60:63], v28, v29, v[60:63]
    v_add_u32 v14, 256, v14
    s_add_u32 s11, s11, 4
    s_cmp_lt_u32 s11, 64
    s_cbranch_scc1 CH_kg115
    s_waitcnt lgkmcnt(0)
    s_nop 11
    ds_write_b32 v11, v60 offset:4096
    ds_write_b32 v11, v61 offset:4160
    ds_write_b32 v11, v62 offset:4224
    ds_write_b32 v11, v63 offset:4288
    v_mul_f32 v12, 0x42000000, v8
    v_add_f32 v12, 0x43800000, v12
    v_mul_f32 v13, 0x40000000, v8
    ds_read_b128 v[40:43], v9 offset:0
    ds_read_b128 v[44:47], v9 offset:64
    ds_read_b128 v[48:51], v9 offset:128
    ds_read_b128 v[52:55], v9 offset:192
    s_mov_b32 s11, 0
    v_mov_b32 v14, v9
    v_mov_b32 v60, 0
    v_mov_b32 v61, 0
    v_mov_b32 v62, 0
    v_mov_b32 v63, 0
CH_kg116:
    s_waitcnt lgkmcnt(3)
    v_mul_f32 v20, v40, v12
    v_mul_f32 v21, v41, v12
    v_mul_f32 v22, v40, v13
    v_fma_f32 v23, v41, v13, v10
    v_exp_f32 v20, v20
    v_fract_f32 v21, v21
    v_exp_f32 v22, v22
    v_fract_f32 v23, v23
    v_sin_f32 v24, v21
    v_cos_f32 v21, v21
    v_cos_f32 v23, v23
    v_mul_f32 v24, v43, v24
    v_fma_f32 v24, v42, v21, v24
    v_mul_f32 v26, v20, v24
    v_mul_f32 v27, v22, v23
    ds_read_b128 v[40:43], v14 offset:256
    s_nop 0
    v_mfma_f32_16x16x4_f32 v[60:63], v26, v27, v[60:63]
    s_waitcnt lgkmcnt(3)
    v_mul_f32 v20, v44, v12
    v_mul_f32 v21, v45, v12
    v_mul_f32 v22, v44, v13
    v_fma_f32 v23, v45, v13, v10
    v_exp_f32 v20, v20
    v_fract_f32 v21, v21
    v_exp_f32 v22, v22
    v_fract_f32 v23, v23
    v_sin_f32 v24, v21
    v_cos_f32 v21, v21
    v_cos_f32 v23, v23
    v_mul_f32 v24, v47, v24
    v_fma_f32 v24, v46, v21, v24
    v_mul_f32 v28, v20, v24
    v_mul_f32 v29, v22, v23
    ds_read_b128 v[44:47], v14 offset:320
    s_nop 0
    v_mfma_f32_16x16x4_f32 v[60:63], v28, v29, v[60:63]
    s_waitcnt lgkmcnt(3)
    v_mul_f32 v20, v48, v12
    v_mul_f32 v21, v49, v12
    v_mul_f32 v22, v48, v13
    v_fma_f32 v23, v49, v13, v10
    v_exp_f32 v20, v20
    v_fract_f32 v21, v21
    v_exp_f32 v22, v22
    v_fract_f32 v23, v23
    v_sin_f32 v24, v21
    v_cos_f32 v21, v21
    v_cos_f32 v23, v23
    v_mul_f32 v24, v51, v24
    v_fma_f32 v24, v50, v21, v24
    v_mul_f32 v26, v20, v24
    v_mul_f32 v27, v22, v23
    ds_read_b128 v[48:51], v14 offset:384
    s_nop 0
    v_mfma_f32_16x16x4_f32 v[60:63], v26, v27, v[60:63]
    s_waitcnt lgkmcnt(3)
    v_mul_f32 v20, v52, v12
    v_mul_f32 v21, v53, v12
    v_mul_f32 v22, v52, v13
    v_fma_f32 v23, v53, v13, v10
    v_exp_f32 v20, v20
    v_fract_f32 v21, v21
    v_exp_f32 v22, v22
    v_fract_f32 v23, v23
    v_sin_f32 v24, v21
    v_cos_f32 v21, v21
    v_cos_f32 v23, v23
    v_mul_f32 v24, v55, v24
    v_fma_f32 v24, v54, v21, v24
    v_mul_f32 v28, v20, v24
    v_mul_f32 v29, v22, v23
    ds_read_b128 v[52:55], v14 offset:448
    s_nop 0
    v_mfma_f32_16x16x4_f32 v[60:63], v28, v29, v[60:63]
    v_add_u32 v14, 256, v14
    s_add_u32 s11, s11, 4
    s_cmp_lt_u32 s11, 64
    s_cbranch_scc1 CH_kg116
    s_waitcnt lgkmcnt(0)
    s_nop 11
    ds_write_b32 v11, v60 offset:5120
    ds_write_b32 v11, v61 offset:5184
    ds_write_b32 v11, v62 offset:5248
    ds_write_b32 v11, v63 offset:5312
    v_mul_f32 v12, 0x42800000, v8
    v_add_f32 v12, 0x44000000, v12
    v_mul_f32 v13, 0x40800000, v8
    ds_read_b128 v[40:43], v9 offset:0
    ds_read_b128 v[44:47], v9 offset:64
    ds_read_b128 v[48:51], v9 offset:128
    ds_read_b128 v[52:55], v9 offset:192
    s_mov_b32 s11, 0
    v_mov_b32 v14, v9
    v_mov_b32 v60, 0
    v_mov_b32 v61, 0
    v_mov_b32 v62, 0
    v_mov_b32 v63, 0
CH_kg117:
    s_waitcnt lgkmcnt(3)
    v_mul_f32 v20, v40, v12
    v_mul_f32 v21, v41, v12
    v_mul_f32 v22, v40, v13
    v_fma_f32 v23, v41, v13, v10
    v_exp_f32 v20, v20
    v_fract_f32 v21, v21
    v_exp_f32 v22, v22
    v_fract_f32 v23, v23
    v_sin_f32 v24, v21
    v_cos_f32 v21, v21
    v_cos_f32 v23, v23
    v_mul_f32 v24, v43, v24
    v_fma_f32 v24, v42, v21, v24
    v_mul_f32 v26, v20, v24
    v_mul_f32 v27, v22, v23
    ds_read_b128 v[40:43], v14 offset:256
    s_nop 0
    v_mfma_f32_16x16x4_f32 v[60:63], v26, v27, v[60:63]
    s_waitcnt lgkmcnt(3)
    v_mul_f32 v20, v44, v12
    v_mul_f32 v21, v45, v12
    v_mul_f32 v22, v44, v13
    v_fma_f32 v23, v45, v13, v10
    v_exp_f32 v20, v20
    v_fract_f32 v21, v21
    v_exp_f32 v22, v22
    v_fract_f32 v23, v23
    v_sin_f32 v24, v21
    v_cos_f32 v21, v21
    v_cos_f32 v23, v23
    v_mul_f32 v24, v47, v24
    v_fma_f32 v24, v46, v21, v24
    v_mul_f32 v28, v20, v24
    v_mul_f32 v29, v22, v23
    ds_read_b128 v[44:47], v14 offset:320
    s_nop 0
    v_mfma_f32_16x16x4_f32 v[60:63], v28, v29, v[60:63]
    s_waitcnt lgkmcnt(3)
    v_mul_f32 v20, v48, v12
    v_mul_f32 v21, v49, v12
    v_mul_f32 v22, v48, v13
    v_fma_f32 v23, v49, v13, v10
    v_exp_f32 v20, v20
    v_fract_f32 v21, v21
    v_exp_f32 v22, v22
    v_fract_f32 v23, v23
    v_sin_f32 v24, v21
    v_cos_f32 v21, v21
    v_cos_f32 v23, v23
    v_mul_f32 v24, v51, v24
    v_fma_f32 v24, v50, v21, v24
    v_mul_f32 v26, v20, v24
    v_mul_f32 v27, v22, v23
    ds_read_b128 v[48:51], v14 offset:384
    s_nop 0
    v_mfma_f32_16x16x4_f32 v[60:63], v26, v27, v[60:63]
    s_waitcnt lgkmcnt(3)
    v_mul_f32 v20, v52, v12
    v_mul_f32 v21, v53, v12
    v_mul_f32 v22, v52, v13
    v_fma_f32 v23, v53, v13, v10
    v_exp_f32 v20, v20
    v_fract_f32 v21, v21
    v_exp_f32 v22, v22
    v_fract_f32 v23, v23
    v_sin_f32 v24, v21
    v_cos_f32 v21, v21
    v_cos_f32 v23, v23
    v_mul_f32 v24, v55, v24
    v_fma_f32 v24, v54, v21, v24
    v_mul_f32 v28, v20, v24
    v_mul_f32 v29, v22, v23
    ds_read_b128 v[52:55], v14 offset:448
    s_nop 0
    v_mfma_f32_16x16x4_f32 v[60:63], v28, v29, v[60:63]
    v_add_u32 v14, 256, v14
    s_add_u32 s11, s11, 4
    s_cmp_lt_u32 s11, 64
    s_cbranch_scc1 CH_kg117
    s_waitcnt lgkmcnt(0)
    s_nop 11
    ds_write_b32 v11, v60 offset:5632
    ds_write_b32 v11, v61 offset:5696
    ds_write_b32 v11, v62 offset:5760
    ds_write_b32 v11, v63 offset:5824
    v_mul_f32 v12, 0x43000000, v8
    v_add_f32 v12, 0x44800000, v12
    v_mul_f32 v13, 0x41000000, v8
    ds_read_b128 v[40:43], v9 offset:0
    ds_read_b128 v[44:47], v9 offset:64
    ds_read_b128 v[48:51], v9 offset:128
    ds_read_b128 v[52:55], v9 offset:192
    s_mov_b32 s11, 0
    v_mov_b32 v14, v9
    v_mov_b32 v60, 0
    v_mov_b32 v61, 0
    v_mov_b32 v62, 0
    v_mov_b32 v63, 0
CH_kg118:
    s_waitcnt lgkmcnt(3)
    v_mul_f32 v20, v40, v12
    v_mul_f32 v21, v41, v12
    v_mul_f32 v22, v40, v13
    v_fma_f32 v23, v41, v13, v10
    v_exp_f32 v20, v20
    v_fract_f32 v21, v21
    v_exp_f32 v22, v22
    v_fract_f32 v23, v23
    v_sin_f32 v24, v21
    v_cos_f32 v21, v21
    v_cos_f32 v23, v23
    v_mul_f32 v24, v43, v24
    v_fma_f32 v24, v42, v21, v24
    v_mul_f32 v26, v20, v24
    v_mul_f32 v27, v22, v23
    ds_read_b128 v[40:43], v14 offset:256
    s_nop 0
    v_mfma_f32_16x16x4_f32 v[60:63], v26, v27, v[60:63]
    s_waitcnt lgkmcnt(3)
    v_mul_f32 v20, v44, v12
    v_mul_f32 v21, v45, v12
    v_mul_f32 v22, v44, v13
    v_fma_f32 v23, v45, v13, v10
    v_exp_f32 v20, v20
    v_fract_f32 v21, v21
    v_exp_f32 v22, v22
    v_fract_f32 v23, v23
    v_sin_f32 v24, v21
    v_cos_f32 v21, v21
    v_cos_f32 v23, v23
    v_mul_f32 v24, v47, v24
    v_fma_f32 v24, v46, v21, v24
    v_mul_f32 v28, v20, v24
    v_mul_f32 v29, v22, v23
    ds_read_b128 v[44:47], v14 offset:320
    s_nop 0
    v_mfma_f32_16x16x4_f32 v[60:63], v28, v29, v[60:63]
    s_waitcnt lgkmcnt(3)
    v_mul_f32 v20, v48, v12
    v_mul_f32 v21, v49, v12
    v_mul_f32 v22, v48, v13
    v_fma_f32 v23, v49, v13, v10
    v_exp_f32 v20, v20
    v_fract_f32 v21, v21
    v_exp_f32 v22, v22
    v_fract_f32 v23, v23
    v_sin_f32 v24, v21
    v_cos_f32 v21, v21
    v_cos_f32 v23, v23
    v_mul_f32 v24, v51, v24
    v_fma_f32 v24, v50, v21, v24
    v_mul_f32 v26, v20, v24
    v_mul_f32 v27, v22, v23
    ds_read_b128 v[48:51], v14 offset:384
    s_nop 0
    v_mfma_f32_16x16x4_f32 v[60:63], v26, v27, v[60:63]
    s_waitcnt lgkmcnt(3)
    v_mul_f32 v20, v52, v12
    v_mul_f32 v21, v53, v12
    v_mul_f32 v22, v52, v13
    v_fma_f32 v23, v53, v13, v10
    v_exp_f32 v20, v20
    v_fract_f32 v21, v21
    v_exp_f32 v22, v22
    v_fract_f32 v23, v23
    v_sin_f32 v24, v21
    v_cos_f32 v21, v21
    v_cos_f32 v23, v23
    v_mul_f32 v24, v55, v24
    v_fma_f32 v24, v54, v21, v24
    v_mul_f32 v28, v20, v24
    v_mul_f32 v29, v22, v23
    ds_read_b128 v[52:55], v14 offset:448
    s_nop 0
    v_mfma_f32_16x16x4_f32 v[60:63], v28, v29, v[60:63]
    v_add_u32 v14, 256, v14
    s_add_u32 s11, s11, 4
    s_cmp_lt_u32 s11, 64
    s_cbranch_scc1 CH_kg118
    s_waitcnt lgkmcnt(0)
    s_nop 11
    ds_write_b32 v11, v60 offset:6144
    ds_write_b32 v11, v61 offset:6208
    ds_write_b32 v11, v62 offset:6272
    ds_write_b32 v11, v63 offset:6336
    s_waitcnt lgkmcnt(0)
    s_mov_b32 s11, 17024
    v_lshlrev_b32 v9, 2, v1
    v_add_u32 v9, s10, v9
    v_lshlrev_b32 v10, 1, v1
    v_sub_u32 v10, 2048, v10
    v_subrev_u32 v12, 0, v10
    v_cvt_f32_i32 v16, v12
    v_cvt_pk_bf16_f32 v16, v16, v16
    v_and_b32 v16, 0xffff, v16
    v_subrev_u32 v16, s11, v16
    v_cmp_gt_i32 vcc, 0x100, v12
    s_nop 1
    v_cndmask_b32 v16, v16, v12, vcc
    v_max_i32 v16, 0, v16
    v_min_i32 v16, 0x2ff, v16
    v_lshlrev_b32 v16, 2, v16
    v_add_u32 v16, s10, v16
    ds_read_b32 v20, v16 offset:4096
    v_subrev_u32 v13, 1, v10
    v_cvt_f32_i32 v16, v13
    v_cvt_pk_bf16_f32 v16, v16, v16
    v_and_b32 v16, 0xffff, v16
    v_subrev_u32 v16, s11, v16
    v_cmp_gt_i32 vcc, 0x100, v13
    s_nop 1
    v_cndmask_b32 v16, v16, v13, vcc
    v_max_i32 v16, 0, v16
    v_min_i32 v16, 0x2ff, v16
    v_lshlrev_b32 v16, 2, v16
    v_add_u32 v16, s10, v16
    ds_read_b32 v21, v16 offset:4096
    v_subrev_u32 v14, 2, v10
    v_cvt_f32_i32 v16, v14
    v_cvt_pk_bf16_f32 v16, v16, v16
    v_and_b32 v16, 0xffff, v16
    v_subrev_u32 v16, s11, v16
    v_cmp_gt_i32 vcc, 0x100, v14
    s_nop 1
    v_cndmask_b32 v16, v16, v14, vcc
    v_max_i32 v16, 0, v16
    v_min_i32 v16, 0x2ff, v16
    v_lshlrev_b32 v16, 2, v16
    v_add_u32 v16, s10, v16
    ds_read_b32 v22, v16 offset:4096
    s_waitcnt lgkmcnt(0)
    v_cmp_gt_u32 vcc, 0x800, v12
    s_nop 1
    v_cndmask_b32 v20, 0, v20, vcc
    v_cmp_gt_u32 vcc, 0x800, v13
    s_nop 1
    v_cndmask_b32 v21, 0, v21, vcc
    v_cmp_gt_u32 vcc, 0x800, v14
    s_nop 1
    v_cndmask_b32 v22, 0, v22, vcc
    v_cvt_pk_bf16_f32 v24, v20, v21
    v_cvt_pk_bf16_f32 v25, v21, v22
    ds_write_b32 v9, v24 offset:7168
    ds_write_b32 v9, v25 offset:11460
    v_lshlrev_b32 v10, 1, v1
    v_sub_u32 v10, 1920, v10
    v_subrev_u32 v12, 0, v10
    v_cvt_f32_i32 v16, v12
    v_cvt_pk_bf16_f32 v16, v16, v16
    v_and_b32 v16, 0xffff, v16
    v_subrev_u32 v16, s11, v16
    v_cmp_gt_i32 vcc, 0x100, v12
    s_nop 1
    v_cndmask_b32 v16, v16, v12, vcc
    v_max_i32 v16, 0, v16
    v_min_i32 v16, 0x2ff, v16
    v_lshlrev_b32 v16, 2, v16
    v_add_u32 v16, s10, v16
    ds_read_b32 v20, v16 offset:4096
    v_subrev_u32 v13, 1, v10
    v_cvt_f32_i32 v16, v13
    v_cvt_pk_bf16_f32 v16, v16, v16
    v_and_b32 v16, 0xffff, v16
    v_subrev_u32 v16, s11, v16
    v_cmp_gt_i32 vcc, 0x100, v13
    s_nop 1
    v_cndmask_b32 v16, v16, v13, vcc
    v_max_i32 v16, 0, v16
    v_min_i32 v16, 0x2ff, v16
    v_lshlrev_b32 v16, 2, v16
    v_add_u32 v16, s10, v16
    ds_read_b32 v21, v16 offset:4096
    v_subrev_u32 v14, 2, v10
    v_cvt_f32_i32 v16, v14
    v_cvt_pk_bf16_f32 v16, v16, v16
    v_and_b32 v16, 0xffff, v16
    v_subrev_u32 v16, s11, v16
    v_cmp_gt_i32 vcc, 0x100, v14
    s_nop 1
    v_cndmask_b32 v16, v16, v14, vcc
    v_max_i32 v16, 0, v16
    v_min_i32 v16, 0x2ff, v16
    v_lshlrev_b32 v16, 2, v16
    v_add_u32 v16, s10, v16
    ds_read_b32 v22, v16 offset:4096
    s_waitcnt lgkmcnt(0)
    v_cmp_gt_u32 vcc, 0x800, v12
    s_nop 1
    v_cndmask_b32 v20, 0, v20, vcc
    v_cmp_gt_u32 vcc, 0x800, v13
    s_nop 1
    v_cndmask_b32 v21, 0, v21, vcc
    v_cmp_gt_u32 vcc, 0x800, v14
    s_nop 1
    v_cndmask_b32 v22, 0, v22, vcc
    v_cvt_pk_bf16_f32 v24, v20, v21
    v_cvt_pk_bf16_f32 v25, v21, v22
    ds_write_b32 v9, v24 offset:7424
    ds_write_b32 v9, v25 offset:11716
    v_lshlrev_b32 v10, 1, v1
    v_sub_u32 v10, 1792, v10
    v_subrev_u32 v12, 0, v10
    v_cvt_f32_i32 v16, v12
    v_cvt_pk_bf16_f32 v16, v16, v16
    v_and_b32 v16, 0xffff, v16
    v_subrev_u32 v16, s11, v16
    v_cmp_gt_i32 vcc, 0x100, v12
    s_nop 1
    v_cndmask_b32 v16, v16, v12, vcc
    v_max_i32 v16, 0, v16
    v_min_i32 v16, 0x2ff, v16
    v_lshlrev_b32 v16, 2, v16
    v_add_u32 v16, s10, v16
    ds_read_b32 v20, v16 offset:4096
    v_subrev_u32 v13, 1, v10
    v_cvt_f32_i32 v16, v13
    v_cvt_pk_bf16_f32 v16, v16, v16
    v_and_b32 v16, 0xffff, v16
    v_subrev_u32 v16, s11, v16
    v_cmp_gt_i32 vcc, 0x100, v13
    s_nop 1
    v_cndmask_b32 v16, v16, v13, vcc
    v_max_i32 v16, 0, v16
    v_min_i32 v16, 0x2ff, v16
    v_lshlrev_b32 v16, 2, v16
    v_add_u32 v16, s10, v16
    ds_read_b32 v21, v16 offset:4096
    v_subrev_u32 v14, 2, v10
    v_cvt_f32_i32 v16, v14
    v_cvt_pk_bf16_f32 v16, v16, v16
    v_and_b32 v16, 0xffff, v16
    v_subrev_u32 v16, s11, v16
    v_cmp_gt_i32 vcc, 0x100, v14
    s_nop 1
    v_cndmask_b32 v16, v16, v14, vcc
    v_max_i32 v16, 0, v16
    v_min_i32 v16, 0x2ff, v16
    v_lshlrev_b32 v16, 2, v16
    v_add_u32 v16, s10, v16
    ds_read_b32 v22, v16 offset:4096
    s_waitcnt lgkmcnt(0)
    v_cmp_gt_u32 vcc, 0x800, v12
    s_nop 1
    v_cndmask_b32 v20, 0, v20, vcc
    v_cmp_gt_u32 vcc, 0x800, v13
    s_nop 1
    v_cndmask_b32 v21, 0, v21, vcc
    v_cmp_gt_u32 vcc, 0x800, v14
    s_nop 1
    v_cndmask_b32 v22, 0, v22, vcc
    v_cvt_pk_bf16_f32 v24, v20, v21
    v_cvt_pk_bf16_f32 v25, v21, v22
    ds_write_b32 v9, v24 offset:7680
    ds_write_b32 v9, v25 offset:11972
    v_lshlrev_b32 v10, 1, v1
    v_sub_u32 v10, 1664, v10
    v_subrev_u32 v12, 0, v10
    v_cvt_f32_i32 v16, v12
    v_cvt_pk_bf16_f32 v16, v16, v16
    v_and_b32 v16, 0xffff, v16
    v_subrev_u32 v16, s11, v16
    v_cmp_gt_i32 vcc, 0x100, v12
    s_nop 1
    v_cndmask_b32 v16, v16, v12, vcc
    v_max_i32 v16, 0, v16
    v_min_i32 v16, 0x2ff, v16
    v_lshlrev_b32 v16, 2, v16
    v_add_u32 v16, s10, v16
    ds_read_b32 v20, v16 offset:4096
    v_subrev_u32 v13, 1, v10
    v_cvt_f32_i32 v16, v13
    v_cvt_pk_bf16_f32 v16, v16, v16
    v_and_b32 v16, 0xffff, v16
    v_subrev_u32 v16, s11, v16
    v_cmp_gt_i32 vcc, 0x100, v13
    s_nop 1
    v_cndmask_b32 v16, v16, v13, vcc
    v_max_i32 v16, 0, v16
    v_min_i32 v16, 0x2ff, v16
    v_lshlrev_b32 v16, 2, v16
    v_add_u32 v16, s10, v16
    ds_read_b32 v21, v16 offset:4096
    v_subrev_u32 v14, 2, v10
    v_cvt_f32_i32 v16, v14
    v_cvt_pk_bf16_f32 v16, v16, v16
    v_and_b32 v16, 0xffff, v16
    v_subrev_u32 v16, s11, v16
    v_cmp_gt_i32 vcc, 0x100, v14
    s_nop 1
    v_cndmask_b32 v16, v16, v14, vcc
    v_max_i32 v16, 0, v16
    v_min_i32 v16, 0x2ff, v16
    v_lshlrev_b32 v16, 2, v16
    v_add_u32 v16, s10, v16
    ds_read_b32 v22, v16 offset:4096
    s_waitcnt lgkmcnt(0)
    v_cmp_gt_u32 vcc, 0x800, v12
    s_nop 1
    v_cndmask_b32 v20, 0, v20, vcc
    v_cmp_gt_u32 vcc, 0x800, v13
    s_nop 1
    v_cndmask_b32 v21, 0, v21, vcc
    v_cmp_gt_u32 vcc, 0x800, v14
    s_nop 1
    v_cndmask_b32 v22, 0, v22, vcc
    v_cvt_pk_bf16_f32 v24, v20, v21
    v_cvt_pk_bf16_f32 v25, v21, v22
    ds_write_b32 v9, v24 offset:7936
    ds_write_b32 v9, v25 offset:12228
    v_lshlrev_b32 v10, 1, v1
    v_sub_u32 v10, 1536, v10
    v_subrev_u32 v12, 0, v10
    v_cvt_f32_i32 v16, v12
    v_cvt_pk_bf16_f32 v16, v16, v16
    v_and_b32 v16, 0xffff, v16
    v_subrev_u32 v16, s11, v16
    v_cmp_gt_i32 vcc, 0x100, v12
    s_nop 1
    v_cndmask_b32 v16, v16, v12, vcc
    v_max_i32 v16, 0, v16
    v_min_i32 v16, 0x2ff, v16
    v_lshlrev_b32 v16, 2, v16
    v_add_u32 v16, s10, v16
    ds_read_b32 v20, v16 offset:4096
    v_subrev_u32 v13, 1, v10
    v_cvt_f32_i32 v16, v13
    v_cvt_pk_bf16_f32 v16, v16, v16
    v_and_b32 v16, 0xffff, v16
    v_subrev_u32 v16, s11, v16
    v_cmp_gt_i32 vcc, 0x100, v13
    s_nop 1
    v_cndmask_b32 v16, v16, v13, vcc
    v_max_i32 v16, 0, v16
    v_min_i32 v16, 0x2ff, v16
    v_lshlrev_b32 v16, 2, v16
    v_add_u32 v16, s10, v16
    ds_read_b32 v21, v16 offset:4096
    v_subrev_u32 v14, 2, v10
    v_cvt_f32_i32 v16, v14
    v_cvt_pk_bf16_f32 v16, v16, v16
    v_and_b32 v16, 0xffff, v16
    v_subrev_u32 v16, s11, v16
    v_cmp_gt_i32 vcc, 0x100, v14
    s_nop 1
    v_cndmask_b32 v16, v16, v14, vcc
    v_max_i32 v16, 0, v16
    v_min_i32 v16, 0x2ff, v16
    v_lshlrev_b32 v16, 2, v16
    v_add_u32 v16, s10, v16
    ds_read_b32 v22, v16 offset:4096
    s_waitcnt lgkmcnt(0)
    v_cmp_gt_u32 vcc, 0x800, v12
    s_nop 1
    v_cndmask_b32 v20, 0, v20, vcc
    v_cmp_gt_u32 vcc, 0x800, v13
    s_nop 1
    v_cndmask_b32 v21, 0, v21, vcc
    v_cmp_gt_u32 vcc, 0x800, v14
    s_nop 1
    v_cndmask_b32 v22, 0, v22, vcc
    v_cvt_pk_bf16_f32 v24, v20, v21
    v_cvt_pk_bf16_f32 v25, v21, v22
    ds_write_b32 v9, v24 offset:8192
    ds_write_b32 v9, v25 offset:12484
    v_lshlrev_b32 v10, 1, v1
    v_sub_u32 v10, 1408, v10
    v_subrev_u32 v12, 0, v10
    v_cvt_f32_i32 v16, v12
    v_cvt_pk_bf16_f32 v16, v16, v16
    v_and_b32 v16, 0xffff, v16
    v_subrev_u32 v16, s11, v16
    v_cmp_gt_i32 vcc, 0x100, v12
    s_nop 1
    v_cndmask_b32 v16, v16, v12, vcc
    v_max_i32 v16, 0, v16
    v_min_i32 v16, 0x2ff, v16
    v_lshlrev_b32 v16, 2, v16
    v_add_u32 v16, s10, v16
    ds_read_b32 v20, v16 offset:4096
    v_subrev_u32 v13, 1, v10
    v_cvt_f32_i32 v16, v13
    v_cvt_pk_bf16_f32 v16, v16, v16
    v_and_b32 v16, 0xffff, v16
    v_subrev_u32 v16, s11, v16
    v_cmp_gt_i32 vcc, 0x100, v13
    s_nop 1
    v_cndmask_b32 v16, v16, v13, vcc
    v_max_i32 v16, 0, v16
    v_min_i32 v16, 0x2ff, v16
    v_lshlrev_b32 v16, 2, v16
    v_add_u32 v16, s10, v16
    ds_read_b32 v21, v16 offset:4096
    v_subrev_u32 v14, 2, v10
    v_cvt_f32_i32 v16, v14
    v_cvt_pk_bf16_f32 v16, v16, v16
    v_and_b32 v16, 0xffff, v16
    v_subrev_u32 v16, s11, v16
    v_cmp_gt_i32 vcc, 0x100, v14
    s_nop 1
    v_cndmask_b32 v16, v16, v14, vcc
    v_max_i32 v16, 0, v16
    v_min_i32 v16, 0x2ff, v16
    v_lshlrev_b32 v16, 2, v16
    v_add_u32 v16, s10, v16
    ds_read_b32 v22, v16 offset:4096
    s_waitcnt lgkmcnt(0)
    v_cmp_gt_u32 vcc, 0x800, v12
    s_nop 1
    v_cndmask_b32 v20, 0, v20, vcc
    v_cmp_gt_u32 vcc, 0x800, v13
    s_nop 1
    v_cndmask_b32 v21, 0, v21, vcc
    v_cmp_gt_u32 vcc, 0x800, v14
    s_nop 1
    v_cndmask_b32 v22, 0, v22, vcc
    v_cvt_pk_bf16_f32 v24, v20, v21
    v_cvt_pk_bf16_f32 v25, v21, v22
    ds_write_b32 v9, v24 offset:8448
    ds_write_b32 v9, v25 offset:12740
    v_lshlrev_b32 v10, 1, v1
    v_sub_u32 v10, 1280, v10
    v_subrev_u32 v12, 0, v10
    v_cvt_f32_i32 v16, v12
    v_cvt_pk_bf16_f32 v16, v16, v16
    v_and_b32 v16, 0xffff, v16
    v_subrev_u32 v16, s11, v16
    v_cmp_gt_i32 vcc, 0x100, v12
    s_nop 1
    v_cndmask_b32 v16, v16, v12, vcc
    v_max_i32 v16, 0, v16
    v_min_i32 v16, 0x2ff, v16
    v_lshlrev_b32 v16, 2, v16
    v_add_u32 v16, s10, v16
    ds_read_b32 v20, v16 offset:4096
    v_subrev_u32 v13, 1, v10
    v_cvt_f32_i32 v16, v13
    v_cvt_pk_bf16_f32 v16, v16, v16
    v_and_b32 v16, 0xffff, v16
    v_subrev_u32 v16, s11, v16
    v_cmp_gt_i32 vcc, 0x100, v13
    s_nop 1
    v_cndmask_b32 v16, v16, v13, vcc
    v_max_i32 v16, 0, v16
    v_min_i32 v16, 0x2ff, v16
    v_lshlrev_b32 v16, 2, v16
    v_add_u32 v16, s10, v16
    ds_read_b32 v21, v16 offset:4096
    v_subrev_u32 v14, 2, v10
    v_cvt_f32_i32 v16, v14
    v_cvt_pk_bf16_f32 v16, v16, v16
    v_and_b32 v16, 0xffff, v16
    v_subrev_u32 v16, s11, v16
    v_cmp_gt_i32 vcc, 0x100, v14
    s_nop 1
    v_cndmask_b32 v16, v16, v14, vcc
    v_max_i32 v16, 0, v16
    v_min_i32 v16, 0x2ff, v16
    v_lshlrev_b32 v16, 2, v16
    v_add_u32 v16, s10, v16
    ds_read_b32 v22, v16 offset:4096
    s_waitcnt lgkmcnt(0)
    v_cmp_gt_u32 vcc, 0x800, v12
    s_nop 1
    v_cndmask_b32 v20, 0, v20, vcc
    v_cmp_gt_u32 vcc, 0x800, v13
    s_nop 1
    v_cndmask_b32 v21, 0, v21, vcc
    v_cmp_gt_u32 vcc, 0x800, v14
    s_nop 1
    v_cndmask_b32 v22, 0, v22, vcc
    v_cvt_pk_bf16_f32 v24, v20, v21
    v_cvt_pk_bf16_f32 v25, v21, v22
    ds_write_b32 v9, v24 offset:8704
    ds_write_b32 v9, v25 offset:12996
    v_lshlrev_b32 v10, 1, v1
    v_sub_u32 v10, 1152, v10
    v_subrev_u32 v12, 0, v10
    v_cvt_f32_i32 v16, v12
    v_cvt_pk_bf16_f32 v16, v16, v16
    v_and_b32 v16, 0xffff, v16
    v_subrev_u32 v16, s11, v16
    v_cmp_gt_i32 vcc, 0x100, v12
    s_nop 1
    v_cndmask_b32 v16, v16, v12, vcc
    v_max_i32 v16, 0, v16
    v_min_i32 v16, 0x2ff, v16
    v_lshlrev_b32 v16, 2, v16
    v_add_u32 v16, s10, v16
    ds_read_b32 v20, v16 offset:4096
    v_subrev_u32 v13, 1, v10
    v_cvt_f32_i32 v16, v13
    v_cvt_pk_bf16_f32 v16, v16, v16
    v_and_b32 v16, 0xffff, v16
    v_subrev_u32 v16, s11, v16
    v_cmp_gt_i32 vcc, 0x100, v13
    s_nop 1
    v_cndmask_b32 v16, v16, v13, vcc
    v_max_i32 v16, 0, v16
    v_min_i32 v16, 0x2ff, v16
    v_lshlrev_b32 v16, 2, v16
    v_add_u32 v16, s10, v16
    ds_read_b32 v21, v16 offset:4096
    v_subrev_u32 v14, 2, v10
    v_cvt_f32_i32 v16, v14
    v_cvt_pk_bf16_f32 v16, v16, v16
    v_and_b32 v16, 0xffff, v16
    v_subrev_u32 v16, s11, v16
    v_cmp_gt_i32 vcc, 0x100, v14
    s_nop 1
    v_cndmask_b32 v16, v16, v14, vcc
    v_max_i32 v16, 0, v16
    v_min_i32 v16, 0x2ff, v16
    v_lshlrev_b32 v16, 2, v16
    v_add_u32 v16, s10, v16
    ds_read_b32 v22, v16 offset:4096
    s_waitcnt lgkmcnt(0)
    v_cmp_gt_u32 vcc, 0x800, v12
    s_nop 1
    v_cndmask_b32 v20, 0, v20, vcc
    v_cmp_gt_u32 vcc, 0x800, v13
    s_nop 1
    v_cndmask_b32 v21, 0, v21, vcc
    v_cmp_gt_u32 vcc, 0x800, v14
    s_nop 1
    v_cndmask_b32 v22, 0, v22, vcc
    v_cvt_pk_bf16_f32 v24, v20, v21
    v_cvt_pk_bf16_f32 v25, v21, v22
    ds_write_b32 v9, v24 offset:8960
    ds_write_b32 v9, v25 offset:13252
    v_lshlrev_b32 v10, 1, v1
    v_sub_u32 v10, 1024, v10
    v_subrev_u32 v12, 0, v10
    v_cvt_f32_i32 v16, v12
    v_cvt_pk_bf16_f32 v16, v16, v16
    v_and_b32 v16, 0xffff, v16
    v_subrev_u32 v16, s11, v16
    v_cmp_gt_i32 vcc, 0x100, v12
    s_nop 1
    v_cndmask_b32 v16, v16, v12, vcc
    v_max_i32 v16, 0, v16
    v_min_i32 v16, 0x2ff, v16
    v_lshlrev_b32 v16, 2, v16
    v_add_u32 v16, s10, v16
    ds_read_b32 v20, v16 offset:4096
    v_subrev_u32 v13, 1, v10
    v_cvt_f32_i32 v16, v13
    v_cvt_pk_bf16_f32 v16, v16, v16
    v_and_b32 v16, 0xffff, v16
    v_subrev_u32 v16, s11, v16
    v_cmp_gt_i32 vcc, 0x100, v13
    s_nop 1
    v_cndmask_b32 v16, v16, v13, vcc
    v_max_i32 v16, 0, v16
    v_min_i32 v16, 0x2ff, v16
    v_lshlrev_b32 v16, 2, v16
    v_add_u32 v16, s10, v16
    ds_read_b32 v21, v16 offset:4096
    v_subrev_u32 v14, 2, v10
    v_cvt_f32_i32 v16, v14
    v_cvt_pk_bf16_f32 v16, v16, v16
    v_and_b32 v16, 0xffff, v16
    v_subrev_u32 v16, s11, v16
    v_cmp_gt_i32 vcc, 0x100, v14
    s_nop 1
    v_cndmask_b32 v16, v16, v14, vcc
    v_max_i32 v16, 0, v16
    v_min_i32 v16, 0x2ff, v16
    v_lshlrev_b32 v16, 2, v16
    v_add_u32 v16, s10, v16
    ds_read_b32 v22, v16 offset:4096
    s_waitcnt lgkmcnt(0)
    v_cmp_gt_u32 vcc, 0x800, v12
    s_nop 1
    v_cndmask_b32 v20, 0, v20, vcc
    v_cmp_gt_u32 vcc, 0x800, v13
    s_nop 1
    v_cndmask_b32 v21, 0, v21, vcc
    v_cmp_gt_u32 vcc, 0x800, v14
    s_nop 1
    v_cndmask_b32 v22, 0, v22, vcc
    v_cvt_pk_bf16_f32 v24, v20, v21
    v_cvt_pk_bf16_f32 v25, v21, v22
    ds_write_b32 v9, v24 offset:9216
    ds_write_b32 v9, v25 offset:13508
    v_lshlrev_b32 v10, 1, v1
    v_sub_u32 v10, 896, v10
    v_subrev_u32 v12, 0, v10
    v_cvt_f32_i32 v16, v12
    v_cvt_pk_bf16_f32 v16, v16, v16
    v_and_b32 v16, 0xffff, v16
    v_subrev_u32 v16, s11, v16
    v_cmp_gt_i32 vcc, 0x100, v12
    s_nop 1
    v_cndmask_b32 v16, v16, v12, vcc
    v_max_i32 v16, 0, v16
    v_min_i32 v16, 0x2ff, v16
    v_lshlrev_b32 v16, 2, v16
    v_add_u32 v16, s10, v16
    ds_read_b32 v20, v16 offset:4096
    v_subrev_u32 v13, 1, v10
    v_cvt_f32_i32 v16, v13
    v_cvt_pk_bf16_f32 v16, v16, v16
    v_and_b32 v16, 0xffff, v16
    v_subrev_u32 v16, s11, v16
    v_cmp_gt_i32 vcc, 0x100, v13
    s_nop 1
    v_cndmask_b32 v16, v16, v13, vcc
    v_max_i32 v16, 0, v16
    v_min_i32 v16, 0x2ff, v16
    v_lshlrev_b32 v16, 2, v16
    v_add_u32 v16, s10, v16
    ds_read_b32 v21, v16 offset:4096
    v_subrev_u32 v14, 2, v10
    v_cvt_f32_i32 v16, v14
    v_cvt_pk_bf16_f32 v16, v16, v16
    v_and_b32 v16, 0xffff, v16
    v_subrev_u32 v16, s11, v16
    v_cmp_gt_i32 vcc, 0x100, v14
    s_nop 1
    v_cndmask_b32 v16, v16, v14, vcc
    v_max_i32 v16, 0, v16
    v_min_i32 v16, 0x2ff, v16
    v_lshlrev_b32 v16, 2, v16
    v_add_u32 v16, s10, v16
    ds_read_b32 v22, v16 offset:4096
    s_waitcnt lgkmcnt(0)
    v_cmp_gt_u32 vcc, 0x800, v12
    s_nop 1
    v_cndmask_b32 v20, 0, v20, vcc
    v_cmp_gt_u32 vcc, 0x800, v13
    s_nop 1
    v_cndmask_b32 v21, 0, v21, vcc
    v_cmp_gt_u32 vcc, 0x800, v14
    s_nop 1
    v_cndmask_b32 v22, 0, v22, vcc
    v_cvt_pk_bf16_f32 v24, v20, v21
    v_cvt_pk_bf16_f32 v25, v21, v22
    ds_write_b32 v9, v24 offset:9472
    ds_write_b32 v9, v25 offset:13764
    v_lshlrev_b32 v10, 1, v1
    v_sub_u32 v10, 768, v10
    v_subrev_u32 v12, 0, v10
    v_cvt_f32_i32 v16, v12
    v_cvt_pk_bf16_f32 v16, v16, v16
    v_and_b32 v16, 0xffff, v16
    v_subrev_u32 v16, s11, v16
    v_cmp_gt_i32 vcc, 0x100, v12
    s_nop 1
    v_cndmask_b32 v16, v16, v12, vcc
    v_max_i32 v16, 0, v16
    v_min_i32 v16, 0x2ff, v16
    v_lshlrev_b32 v16, 2, v16
    v_add_u32 v16, s10, v16
    ds_read_b32 v20, v16 offset:4096
    v_subrev_u32 v13, 1, v10
    v_cvt_f32_i32 v16, v13
    v_cvt_pk_bf16_f32 v16, v16, v16
    v_and_b32 v16, 0xffff, v16
    v_subrev_u32 v16, s11, v16
    v_cmp_gt_i32 vcc, 0x100, v13
    s_nop 1
    v_cndmask_b32 v16, v16, v13, vcc
    v_max_i32 v16, 0, v16
    v_min_i32 v16, 0x2ff, v16
    v_lshlrev_b32 v16, 2, v16
    v_add_u32 v16, s10, v16
    ds_read_b32 v21, v16 offset:4096
    v_subrev_u32 v14, 2, v10
    v_cvt_f32_i32 v16, v14
    v_cvt_pk_bf16_f32 v16, v16, v16
    v_and_b32 v16, 0xffff, v16
    v_subrev_u32 v16, s11, v16
    v_cmp_gt_i32 vcc, 0x100, v14
    s_nop 1
    v_cndmask_b32 v16, v16, v14, vcc
    v_max_i32 v16, 0, v16
    v_min_i32 v16, 0x2ff, v16
    v_lshlrev_b32 v16, 2, v16
    v_add_u32 v16, s10, v16
    ds_read_b32 v22, v16 offset:4096
    s_waitcnt lgkmcnt(0)
    v_cmp_gt_u32 vcc, 0x800, v12
    s_nop 1
    v_cndmask_b32 v20, 0, v20, vcc
    v_cmp_gt_u32 vcc, 0x800, v13
    s_nop 1
    v_cndmask_b32 v21, 0, v21, vcc
    v_cmp_gt_u32 vcc, 0x800, v14
    s_nop 1
    v_cndmask_b32 v22, 0, v22, vcc
    v_cvt_pk_bf16_f32 v24, v20, v21
    v_cvt_pk_bf16_f32 v25, v21, v22
    ds_write_b32 v9, v24 offset:9728
    ds_write_b32 v9, v25 offset:14020
    v_lshlrev_b32 v10, 1, v1
    v_sub_u32 v10, 640, v10
    v_subrev_u32 v12, 0, v10
    v_cvt_f32_i32 v16, v12
    v_cvt_pk_bf16_f32 v16, v16, v16
    v_and_b32 v16, 0xffff, v16
    v_subrev_u32 v16, s11, v16
    v_cmp_gt_i32 vcc, 0x100, v12
    s_nop 1
    v_cndmask_b32 v16, v16, v12, vcc
    v_max_i32 v16, 0, v16
    v_min_i32 v16, 0x2ff, v16
    v_lshlrev_b32 v16, 2, v16
    v_add_u32 v16, s10, v16
    ds_read_b32 v20, v16 offset:4096
    v_subrev_u32 v13, 1, v10
    v_cvt_f32_i32 v16, v13
    v_cvt_pk_bf16_f32 v16, v16, v16
    v_and_b32 v16, 0xffff, v16
    v_subrev_u32 v16, s11, v16
    v_cmp_gt_i32 vcc, 0x100, v13
    s_nop 1
    v_cndmask_b32 v16, v16, v13, vcc
    v_max_i32 v16, 0, v16
    v_min_i32 v16, 0x2ff, v16
    v_lshlrev_b32 v16, 2, v16
    v_add_u32 v16, s10, v16
    ds_read_b32 v21, v16 offset:4096
    v_subrev_u32 v14, 2, v10
    v_cvt_f32_i32 v16, v14
    v_cvt_pk_bf16_f32 v16, v16, v16
    v_and_b32 v16, 0xffff, v16
    v_subrev_u32 v16, s11, v16
    v_cmp_gt_i32 vcc, 0x100, v14
    s_nop 1
    v_cndmask_b32 v16, v16, v14, vcc
    v_max_i32 v16, 0, v16
    v_min_i32 v16, 0x2ff, v16
    v_lshlrev_b32 v16, 2, v16
    v_add_u32 v16, s10, v16
    ds_read_b32 v22, v16 offset:4096
    s_waitcnt lgkmcnt(0)
    v_cmp_gt_u32 vcc, 0x800, v12
    s_nop 1
    v_cndmask_b32 v20, 0, v20, vcc
    v_cmp_gt_u32 vcc, 0x800, v13
    s_nop 1
    v_cndmask_b32 v21, 0, v21, vcc
    v_cmp_gt_u32 vcc, 0x800, v14
    s_nop 1
    v_cndmask_b32 v22, 0, v22, vcc
    v_cvt_pk_bf16_f32 v24, v20, v21
    v_cvt_pk_bf16_f32 v25, v21, v22
    ds_write_b32 v9, v24 offset:9984
    ds_write_b32 v9, v25 offset:14276
    v_lshlrev_b32 v10, 1, v1
    v_sub_u32 v10, 512, v10
    v_subrev_u32 v12, 0, v10
    v_cvt_f32_i32 v16, v12
    v_cvt_pk_bf16_f32 v16, v16, v16
    v_and_b32 v16, 0xffff, v16
    v_subrev_u32 v16, s11, v16
    v_cmp_gt_i32 vcc, 0x100, v12
    s_nop 1
    v_cndmask_b32 v16, v16, v12, vcc
    v_max_i32 v16, 0, v16
    v_min_i32 v16, 0x2ff, v16
    v_lshlrev_b32 v16, 2, v16
    v_add_u32 v16, s10, v16
    ds_read_b32 v20, v16 offset:4096
    v_subrev_u32 v13, 1, v10
    v_cvt_f32_i32 v16, v13
    v_cvt_pk_bf16_f32 v16, v16, v16
    v_and_b32 v16, 0xffff, v16
    v_subrev_u32 v16, s11, v16
    v_cmp_gt_i32 vcc, 0x100, v13
    s_nop 1
    v_cndmask_b32 v16, v16, v13, vcc
    v_max_i32 v16, 0, v16
    v_min_i32 v16, 0x2ff, v16
    v_lshlrev_b32 v16, 2, v16
    v_add_u32 v16, s10, v16
    ds_read_b32 v21, v16 offset:4096
    v_subrev_u32 v14, 2, v10
    v_cvt_f32_i32 v16, v14
    v_cvt_pk_bf16_f32 v16, v16, v16
    v_and_b32 v16, 0xffff, v16
    v_subrev_u32 v16, s11, v16
    v_cmp_gt_i32 vcc, 0x100, v14
    s_nop 1
    v_cndmask_b32 v16, v16, v14, vcc
    v_max_i32 v16, 0, v16
    v_min_i32 v16, 0x2ff, v16
    v_lshlrev_b32 v16, 2, v16
    v_add_u32 v16, s10, v16
    ds_read_b32 v22, v16 offset:4096
    s_waitcnt lgkmcnt(0)
    v_cmp_gt_u32 vcc, 0x800, v12
    s_nop 1
    v_cndmask_b32 v20, 0, v20, vcc
    v_cmp_gt_u32 vcc, 0x800, v13
    s_nop 1
    v_cndmask_b32 v21, 0, v21, vcc
    v_cmp_gt_u32 vcc, 0x800, v14
    s_nop 1
    v_cndmask_b32 v22, 0, v22, vcc
    v_cvt_pk_bf16_f32 v24, v20, v21
    v_cvt_pk_bf16_f32 v25, v21, v22
    ds_write_b32 v9, v24 offset:10240
    ds_write_b32 v9, v25 offset:14532
    v_lshlrev_b32 v10, 1, v1
    v_sub_u32 v10, 384, v10
    v_subrev_u32 v12, 0, v10
    v_cvt_f32_i32 v16, v12
    v_cvt_pk_bf16_f32 v16, v16, v16
    v_and_b32 v16, 0xffff, v16
    v_subrev_u32 v16, s11, v16
    v_cmp_gt_i32 vcc, 0x100, v12
    s_nop 1
    v_cndmask_b32 v16, v16, v12, vcc
    v_max_i32 v16, 0, v16
    v_min_i32 v16, 0x2ff, v16
    v_lshlrev_b32 v16, 2, v16
    v_add_u32 v16, s10, v16
    ds_read_b32 v20, v16 offset:4096
    v_subrev_u32 v13, 1, v10
    v_cvt_f32_i32 v16, v13
    v_cvt_pk_bf16_f32 v16, v16, v16
    v_and_b32 v16, 0xffff, v16
    v_subrev_u32 v16, s11, v16
    v_cmp_gt_i32 vcc, 0x100, v13
    s_nop 1
    v_cndmask_b32 v16, v16, v13, vcc
    v_max_i32 v16, 0, v16
    v_min_i32 v16, 0x2ff, v16
    v_lshlrev_b32 v16, 2, v16
    v_add_u32 v16, s10, v16
    ds_read_b32 v21, v16 offset:4096
    v_subrev_u32 v14, 2, v10
    v_cvt_f32_i32 v16, v14
    v_cvt_pk_bf16_f32 v16, v16, v16
    v_and_b32 v16, 0xffff, v16
    v_subrev_u32 v16, s11, v16
    v_cmp_gt_i32 vcc, 0x100, v14
    s_nop 1
    v_cndmask_b32 v16, v16, v14, vcc
    v_max_i32 v16, 0, v16
    v_min_i32 v16, 0x2ff, v16
    v_lshlrev_b32 v16, 2, v16
    v_add_u32 v16, s10, v16
    ds_read_b32 v22, v16 offset:4096
    s_waitcnt lgkmcnt(0)
    v_cmp_gt_u32 vcc, 0x800, v12
    s_nop 1
    v_cndmask_b32 v20, 0, v20, vcc
    v_cmp_gt_u32 vcc, 0x800, v13
    s_nop 1
    v_cndmask_b32 v21, 0, v21, vcc
    v_cmp_gt_u32 vcc, 0x800, v14
    s_nop 1
    v_cndmask_b32 v22, 0, v22, vcc
    v_cvt_pk_bf16_f32 v24, v20, v21
    v_cvt_pk_bf16_f32 v25, v21, v22
    ds_write_b32 v9, v24 offset:10496
    ds_write_b32 v9, v25 offset:14788
    v_lshlrev_b32 v10, 1, v1
    v_sub_u32 v10, 256, v10
    v_subrev_u32 v12, 0, v10
    v_cvt_f32_i32 v16, v12
    v_cvt_pk_bf16_f32 v16, v16, v16
    v_and_b32 v16, 0xffff, v16
    v_subrev_u32 v16, s11, v16
    v_cmp_gt_i32 vcc, 0x100, v12
    s_nop 1
    v_cndmask_b32 v16, v16, v12, vcc
    v_max_i32 v16, 0, v16
    v_min_i32 v16, 0x2ff, v16
    v_lshlrev_b32 v16, 2, v16
    v_add_u32 v16, s10, v16
    ds_read_b32 v20, v16 offset:4096
    v_subrev_u32 v13, 1, v10
    v_cvt_f32_i32 v16, v13
    v_cvt_pk_bf16_f32 v16, v16, v16
    v_and_b32 v16, 0xffff, v16
    v_subrev_u32 v16, s11, v16
    v_cmp_gt_i32 vcc, 0x100, v13
    s_nop 1
    v_cndmask_b32 v16, v16, v13, vcc
    v_max_i32 v16, 0, v16
    v_min_i32 v16, 0x2ff, v16
    v_lshlrev_b32 v16, 2, v16
    v_add_u32 v16, s10, v16
    ds_read_b32 v21, v16 offset:4096
    v_subrev_u32 v14, 2, v10
    v_cvt_f32_i32 v16, v14
    v_cvt_pk_bf16_f32 v16, v16, v16
    v_and_b32 v16, 0xffff, v16
    v_subrev_u32 v16, s11, v16
    v_cmp_gt_i32 vcc, 0x100, v14
    s_nop 1
    v_cndmask_b32 v16, v16, v14, vcc
    v_max_i32 v16, 0, v16
    v_min_i32 v16, 0x2ff, v16
    v_lshlrev_b32 v16, 2, v16
    v_add_u32 v16, s10, v16
    ds_read_b32 v22, v16 offset:4096
    s_waitcnt lgkmcnt(0)
    v_cmp_gt_u32 vcc, 0x800, v12
    s_nop 1
    v_cndmask_b32 v20, 0, v20, vcc
    v_cmp_gt_u32 vcc, 0x800, v13
    s_nop 1
    v_cndmask_b32 v21, 0, v21, vcc
    v_cmp_gt_u32 vcc, 0x800, v14
    s_nop 1
    v_cndmask_b32 v22, 0, v22, vcc
    v_cvt_pk_bf16_f32 v24, v20, v21
    v_cvt_pk_bf16_f32 v25, v21, v22
    ds_write_b32 v9, v24 offset:10752
    ds_write_b32 v9, v25 offset:15044
    v_lshlrev_b32 v10, 1, v1
    v_sub_u32 v10, 128, v10
    v_subrev_u32 v12, 0, v10
    v_cvt_f32_i32 v16, v12
    v_cvt_pk_bf16_f32 v16, v16, v16
    v_and_b32 v16, 0xffff, v16
    v_subrev_u32 v16, s11, v16
    v_cmp_gt_i32 vcc, 0x100, v12
    s_nop 1
    v_cndmask_b32 v16, v16, v12, vcc
    v_max_i32 v16, 0, v16
    v_min_i32 v16, 0x2ff, v16
    v_lshlrev_b32 v16, 2, v16
    v_add_u32 v16, s10, v16
    ds_read_b32 v20, v16 offset:4096
    v_subrev_u32 v13, 1, v10
    v_cvt_f32_i32 v16, v13
    v_cvt_pk_bf16_f32 v16, v16, v16
    v_and_b32 v16, 0xffff, v16
    v_subrev_u32 v16, s11, v16
    v_cmp_gt_i32 vcc, 0x100, v13
    s_nop 1
    v_cndmask_b32 v16, v16, v13, vcc
    v_max_i32 v16, 0, v16
    v_min_i32 v16, 0x2ff, v16
    v_lshlrev_b32 v16, 2, v16
    v_add_u32 v16, s10, v16
    ds_read_b32 v21, v16 offset:4096
    v_subrev_u32 v14, 2, v10
    v_cvt_f32_i32 v16, v14
    v_cvt_pk_bf16_f32 v16, v16, v16
    v_and_b32 v16, 0xffff, v16
    v_subrev_u32 v16, s11, v16
    v_cmp_gt_i32 vcc, 0x100, v14
    s_nop 1
    v_cndmask_b32 v16, v16, v14, vcc
    v_max_i32 v16, 0, v16
    v_min_i32 v16, 0x2ff, v16
    v_lshlrev_b32 v16, 2, v16
    v_add_u32 v16, s10, v16
    ds_read_b32 v22, v16 offset:4096
    s_waitcnt lgkmcnt(0)
    v_cmp_gt_u32 vcc, 0x800, v12
    s_nop 1
    v_cndmask_b32 v20, 0, v20, vcc
    v_cmp_gt_u32 vcc, 0x800, v13
    s_nop 1
    v_cndmask_b32 v21, 0, v21, vcc
    v_cmp_gt_u32 vcc, 0x800, v14
    s_nop 1
    v_cndmask_b32 v22, 0, v22, vcc
    v_cvt_pk_bf16_f32 v24, v20, v21
    v_cvt_pk_bf16_f32 v25, v21, v22
    ds_write_b32 v9, v24 offset:11008
    ds_write_b32 v9, v25 offset:15300
    v_lshlrev_b32 v10, 1, v1
    v_sub_u32 v10, 0, v10
    v_subrev_u32 v12, 0, v10
    v_cvt_f32_i32 v16, v12
    v_cvt_pk_bf16_f32 v16, v16, v16
    v_and_b32 v16, 0xffff, v16
    v_subrev_u32 v16, s11, v16
    v_cmp_gt_i32 vcc, 0x100, v12
    s_nop 1
    v_cndmask_b32 v16, v16, v12, vcc
    v_max_i32 v16, 0, v16
    v_min_i32 v16, 0x2ff, v16
    v_lshlrev_b32 v16, 2, v16
    v_add_u32 v16, s10, v16
    ds_read_b32 v20, v16 offset:4096
    v_subrev_u32 v13, 1, v10
    v_cvt_f32_i32 v16, v13
    v_cvt_pk_bf16_f32 v16, v16, v16
    v_and_b32 v16, 0xffff, v16
    v_subrev_u32 v16, s11, v16
    v_cmp_gt_i32 vcc, 0x100, v13
    s_nop 1
    v_cndmask_b32 v16, v16, v13, vcc
    v_max_i32 v16, 0, v16
    v_min_i32 v16, 0x2ff, v16
    v_lshlrev_b32 v16, 2, v16
    v_add_u32 v16, s10, v16
    ds_read_b32 v21, v16 offset:4096
    v_subrev_u32 v14, 2, v10
    v_cvt_f32_i32 v16, v14
    v_cvt_pk_bf16_f32 v16, v16, v16
    v_and_b32 v16, 0xffff, v16
    v_subrev_u32 v16, s11, v16
    v_cmp_gt_i32 vcc, 0x100, v14
    s_nop 1
    v_cndmask_b32 v16, v16, v14, vcc
    v_max_i32 v16, 0, v16
    v_min_i32 v16, 0x2ff, v16
    v_lshlrev_b32 v16, 2, v16
    v_add_u32 v16, s10, v16
    ds_read_b32 v22, v16 offset:4096
    s_waitcnt lgkmcnt(0)
    v_cmp_gt_u32 vcc, 0x800, v12
    s_nop 1
    v_cndmask_b32 v20, 0, v20, vcc
    v_cmp_gt_u32 vcc, 0x800, v13
    s_nop 1
    v_cndmask_b32 v21, 0, v21, vcc
    v_cmp_gt_u32 vcc, 0x800, v14
    s_nop 1
    v_cndmask_b32 v22, 0, v22, vcc
    v_cvt_pk_bf16_f32 v24, v20, v21
    v_cvt_pk_bf16_f32 v25, v21, v22
    v_cmp_gt_u32 vcc, 32, v1
    s_and_saveexec_b64 s[44:45], vcc
    ds_write_b32 v9, v24 offset:11264
    ds_write_b32 v9, v25 offset:15556
    s_mov_b64 exec, s[44:45]
    s_waitcnt lgkmcnt(0)
    v_and_b32 v6, 31, v1
    v_lshrrev_b32 v7, 5, v1
    v_add_u32 v8, 1, v6
    v_lshrrev_b32 v8, 1, v8
    v_lshlrev_b32 v9, 2, v7
    v_sub_u32 v9, v9, v8
    v_add_u32 v9, 1008, v9
    v_lshlrev_b32 v9, 2, v9
    v_and_b32 v8, 1, v6
    v_mul_u32_u24 v8, 4292, v8
    v_add3_u32 v9, v9, v8, s10
    v_add_u32 v9, 7168, v9
    v_lshlrev_b32 v10, 4, v7
    v_add_u32 v10, s10, v10
    v_add_u32 v10, 15696, v10
    ds_read2_b32 v[24:25], v9 offset0:40 offset1:41
    ds_read2_b32 v[26:27], v9 offset0:42 offset1:43
    ds_read2_b32 v[28:29], v9 offset0:32 offset1:33
    ds_read2_b32 v[30:31], v9 offset0:34 offset1:35
    v_subrev_u32 v12, 0, v6
    v_max_i32 v12, -1, v12
    v_add_u32 v12, 1, v12
    v_mul_u32_u24 v12, 144, v12
    v_add_u32 v11, v10, v12
    ds_read_b128 v[48:51], v11 offset:0
    ds_read_b128 v[52:55], v11 offset:32
    ds_read_b128 v[56:59], v11 offset:64
    ds_read_b128 v[60:63], v11 offset:96
    ds_read2_b32 v[32:33], v9 offset0:24 offset1:25
    ds_read2_b32 v[34:35], v9 offset0:26 offset1:27
    ds_read2_b32 v[36:37], v9 offset0:16 offset1:17
    ds_read2_b32 v[38:39], v9 offset0:18 offset1:19
    ds_read2_b32 v[40:41], v9 offset0:8 offset1:9
    ds_read2_b32 v[42:43], v9 offset0:10 offset1:11
    ds_read2_b32 v[44:45], v9 offset0:0 offset1:1
    ds_read2_b32 v[46:47], v9 offset0:2 offset1:3
    s_waitcnt lgkmcnt(0)
    v_mfma_f32_32x32x16_bf16 v[120:135], v[36:39], v[48:51], 0
    v_mfma_f32_32x32x16_bf16 v[136:151], v[44:47], v[48:51], 0
    v_mfma_f32_32x32x16_bf16 v[120:135], v[32:35], v[52:55], v[120:135]
    v_mfma_f32_32x32x16_bf16 v[136:151], v[40:43], v[52:55], v[136:151]
    v_mfma_f32_32x32x16_bf16 v[120:135], v[28:31], v[56:59], v[120:135]
    v_mfma_f32_32x32x16_bf16 v[136:151], v[36:39], v[56:59], v[136:151]
    v_mfma_f32_32x32x16_bf16 v[120:135], v[24:27], v[60:63], v[120:135]
    v_mfma_f32_32x32x16_bf16 v[136:151], v[32:35], v[60:63], v[136:151]
    v_subrev_u32 v9, 128, v9
    v_subrev_u32 v12, 1, v6
    v_max_i32 v12, -1, v12
    v_add_u32 v12, 1, v12
    v_mul_u32_u24 v12, 144, v12
    v_add_u32 v11, v10, v12
    ds_read_b128 v[64:67], v11 offset:0
    ds_read_b128 v[68:71], v11 offset:32
    ds_read_b128 v[72:75], v11 offset:64
    ds_read_b128 v[76:79], v11 offset:96
    ds_read2_b32 v[24:25], v9 offset0:24 offset1:25
    ds_read2_b32 v[26:27], v9 offset0:26 offset1:27
    ds_read2_b32 v[28:29], v9 offset0:16 offset1:17
    ds_read2_b32 v[30:31], v9 offset0:18 offset1:19
    ds_read2_b32 v[32:33], v9 offset0:8 offset1:9
    ds_read2_b32 v[34:35], v9 offset0:10 offset1:11
    ds_read2_b32 v[36:37], v9 offset0:0 offset1:1
    ds_read2_b32 v[38:39], v9 offset0:2 offset1:3
    s_waitcnt lgkmcnt(0)
    v_mfma_f32_32x32x16_bf16 v[120:135], v[28:31], v[64:67], v[120:135]
    v_mfma_f32_32x32x16_bf16 v[136:151], v[36:39], v[64:67], v[136:151]
    v_mfma_f32_32x32x16_bf16 v[120:135], v[24:27], v[68:71], v[120:135]
    v_mfma_f32_32x32x16_bf16 v[136:151], v[32:35], v[68:71], v[136:151]
    v_mfma_f32_32x32x16_bf16 v[120:135], v[44:47], v[72:75], v[120:135]
    v_mfma_f32_32x32x16_bf16 v[136:151], v[28:31], v[72:75], v[136:151]
    v_mfma_f32_32x32x16_bf16 v[120:135], v[40:43], v[76:79], v[120:135]
    v_mfma_f32_32x32x16_bf16 v[136:151], v[24:27], v[76:79], v[136:151]
    v_subrev_u32 v9, 128, v9
    v_subrev_u32 v12, 2, v6
    v_max_i32 v12, -1, v12
    v_add_u32 v12, 1, v12
    v_mul_u32_u24 v12, 144, v12
    v_add_u32 v11, v10, v12
    ds_read_b128 v[48:51], v11 offset:0
    ds_read_b128 v[52:55], v11 offset:32
    ds_read_b128 v[56:59], v11 offset:64
    ds_read_b128 v[60:63], v11 offset:96
    ds_read2_b32 v[40:41], v9 offset0:24 offset1:25
    ds_read2_b32 v[42:43], v9 offset0:26 offset1:27
    ds_read2_b32 v[44:45], v9 offset0:16 offset1:17
    ds_read2_b32 v[46:47], v9 offset0:18 offset1:19
    ds_read2_b32 v[24:25], v9 offset0:8 offset1:9
    ds_read2_b32 v[26:27], v9 offset0:10 offset1:11
    ds_read2_b32 v[28:29], v9 offset0:0 offset1:1
    ds_read2_b32 v[30:31], v9 offset0:2 offset1:3
    s_waitcnt lgkmcnt(0)
    v_mfma_f32_32x32x16_bf16 v[120:135], v[44:47], v[48:51], v[120:135]
    v_mfma_f32_32x32x16_bf16 v[136:151], v[28:31], v[48:51], v[136:151]
    v_mfma_f32_32x32x16_bf16 v[120:135], v[40:43], v[52:55], v[120:135]
    v_mfma_f32_32x32x16_bf16 v[136:151], v[24:27], v[52:55], v[136:151]
    v_mfma_f32_32x32x16_bf16 v[120:135], v[36:39], v[56:59], v[120:135]
    v_mfma_f32_32x32x16_bf16 v[136:151], v[44:47], v[56:59], v[136:151]
    v_mfma_f32_32x32x16_bf16 v[120:135], v[32:35], v[60:63], v[120:135]
    v_mfma_f32_32x32x16_bf16 v[136:151], v[40:43], v[60:63], v[136:151]
    v_subrev_u32 v9, 128, v9
    v_subrev_u32 v12, 3, v6
    v_max_i32 v12, -1, v12
    v_add_u32 v12, 1, v12
    v_mul_u32_u24 v12, 144, v12
    v_add_u32 v11, v10, v12
    ds_read_b128 v[64:67], v11 offset:0
    ds_read_b128 v[68:71], v11 offset:32
    ds_read_b128 v[72:75], v11 offset:64
    ds_read_b128 v[76:79], v11 offset:96
    ds_read2_b32 v[32:33], v9 offset0:24 offset1:25
    ds_read2_b32 v[34:35], v9 offset0:26 offset1:27
    ds_read2_b32 v[36:37], v9 offset0:16 offset1:17
    ds_read2_b32 v[38:39], v9 offset0:18 offset1:19
    ds_read2_b32 v[40:41], v9 offset0:8 offset1:9
    ds_read2_b32 v[42:43], v9 offset0:10 offset1:11
    ds_read2_b32 v[44:45], v9 offset0:0 offset1:1
    ds_read2_b32 v[46:47], v9 offset0:2 offset1:3
    s_waitcnt lgkmcnt(0)
    v_mfma_f32_32x32x16_bf16 v[120:135], v[36:39], v[64:67], v[120:135]
    v_mfma_f32_32x32x16_bf16 v[136:151], v[44:47], v[64:67], v[136:151]
    v_mfma_f32_32x32x16_bf16 v[120:135], v[32:35], v[68:71], v[120:135]
    v_mfma_f32_32x32x16_bf16 v[136:151], v[40:43], v[68:71], v[136:151]
    v_mfma_f32_32x32x16_bf16 v[120:135], v[28:31], v[72:75], v[120:135]
    v_mfma_f32_32x32x16_bf16 v[136:151], v[36:39], v[72:75], v[136:151]
    v_mfma_f32_32x32x16_bf16 v[120:135], v[24:27], v[76:79], v[120:135]
    v_mfma_f32_32x32x16_bf16 v[136:151], v[32:35], v[76:79], v[136:151]
    v_subrev_u32 v9, 128, v9
    v_subrev_u32 v12, 4, v6
    v_max_i32 v12, -1, v12
    v_add_u32 v12, 1, v12
    v_mul_u32_u24 v12, 144, v12
    v_add_u32 v11, v10, v12
    ds_read_b128 v[48:51], v11 offset:0
    ds_read_b128 v[52:55], v11 offset:32
    ds_read_b128 v[56:59], v11 offset:64
    ds_read_b128 v[60:63], v11 offset:96
    ds_read2_b32 v[24:25], v9 offset0:24 offset1:25
    ds_read2_b32 v[26:27], v9 offset0:26 offset1:27
    ds_read2_b32 v[28:29], v9 offset0:16 offset1:17
    ds_read2_b32 v[30:31], v9 offset0:18 offset1:19
    ds_read2_b32 v[32:33], v9 offset0:8 offset1:9
    ds_read2_b32 v[34:35], v9 offset0:10 offset1:11
    ds_read2_b32 v[36:37], v9 offset0:0 offset1:1
    ds_read2_b32 v[38:39], v9 offset0:2 offset1:3
    s_waitcnt lgkmcnt(0)
    v_mfma_f32_32x32x16_bf16 v[120:135], v[28:31], v[48:51], v[120:135]
    v_mfma_f32_32x32x16_bf16 v[136:151], v[36:39], v[48:51], v[136:151]
    v_mfma_f32_32x32x16_bf16 v[120:135], v[24:27], v[52:55], v[120:135]
    v_mfma_f32_32x32x16_bf16 v[136:151], v[32:35], v[52:55], v[136:151]
    v_mfma_f32_32x32x16_bf16 v[120:135], v[44:47], v[56:59], v[120:135]
    v_mfma_f32_32x32x16_bf16 v[136:151], v[28:31], v[56:59], v[136:151]
    v_mfma_f32_32x32x16_bf16 v[120:135], v[40:43], v[60:63], v[120:135]
    v_mfma_f32_32x32x16_bf16 v[136:151], v[24:27], v[60:63], v[136:151]
    v_subrev_u32 v9, 128, v9
    v_subrev_u32 v12, 5, v6
    v_max_i32 v12, -1, v12
    v_add_u32 v12, 1, v12
    v_mul_u32_u24 v12, 144, v12
    v_add_u32 v11, v10, v12
    ds_read_b128 v[64:67], v11 offset:0
    ds_read_b128 v[68:71], v11 offset:32
    ds_read_b128 v[72:75], v11 offset:64
    ds_read_b128 v[76:79], v11 offset:96
    ds_read2_b32 v[40:41], v9 offset0:24 offset1:25
    ds_read2_b32 v[42:43], v9 offset0:26 offset1:27
    ds_read2_b32 v[44:45], v9 offset0:16 offset1:17
    ds_read2_b32 v[46:47], v9 offset0:18 offset1:19
    ds_read2_b32 v[24:25], v9 offset0:8 offset1:9
    ds_read2_b32 v[26:27], v9 offset0:10 offset1:11
    ds_read2_b32 v[28:29], v9 offset0:0 offset1:1
    ds_read2_b32 v[30:31], v9 offset0:2 offset1:3
    s_waitcnt lgkmcnt(0)
    v_mfma_f32_32x32x16_bf16 v[120:135], v[44:47], v[64:67], v[120:135]
    v_mfma_f32_32x32x16_bf16 v[136:151], v[28:31], v[64:67], v[136:151]
    v_mfma_f32_32x32x16_bf16 v[120:135], v[40:43], v[68:71], v[120:135]
    v_mfma_f32_32x32x16_bf16 v[136:151], v[24:27], v[68:71], v[136:151]
    v_mfma_f32_32x32x16_bf16 v[120:135], v[36:39], v[72:75], v[120:135]
    v_mfma_f32_32x32x16_bf16 v[136:151], v[44:47], v[72:75], v[136:151]
    v_mfma_f32_32x32x16_bf16 v[120:135], v[32:35], v[76:79], v[120:135]
    v_mfma_f32_32x32x16_bf16 v[136:151], v[40:43], v[76:79], v[136:151]
    v_subrev_u32 v9, 128, v9
    v_subrev_u32 v12, 6, v6
    v_max_i32 v12, -1, v12
    v_add_u32 v12, 1, v12
    v_mul_u32_u24 v12, 144, v12
    v_add_u32 v11, v10, v12
    ds_read_b128 v[48:51], v11 offset:0
    ds_read_b128 v[52:55], v11 offset:32
    ds_read_b128 v[56:59], v11 offset:64
    ds_read_b128 v[60:63], v11 offset:96
    ds_read2_b32 v[32:33], v9 offset0:24 offset1:25
    ds_read2_b32 v[34:35], v9 offset0:26 offset1:27
    ds_read2_b32 v[36:37], v9 offset0:16 offset1:17
    ds_read2_b32 v[38:39], v9 offset0:18 offset1:19
    ds_read2_b32 v[40:41], v9 offset0:8 offset1:9
    ds_read2_b32 v[42:43], v9 offset0:10 offset1:11
    ds_read2_b32 v[44:45], v9 offset0:0 offset1:1
    ds_read2_b32 v[46:47], v9 offset0:2 offset1:3
    s_waitcnt lgkmcnt(0)
    v_mfma_f32_32x32x16_bf16 v[120:135], v[36:39], v[48:51], v[120:135]
    v_mfma_f32_32x32x16_bf16 v[136:151], v[44:47], v[48:51], v[136:151]
    v_mfma_f32_32x32x16_bf16 v[120:135], v[32:35], v[52:55], v[120:135]
    v_mfma_f32_32x32x16_bf16 v[136:151], v[40:43], v[52:55], v[136:151]
    v_mfma_f32_32x32x16_bf16 v[120:135], v[28:31], v[56:59], v[120:135]
    v_mfma_f32_32x32x16_bf16 v[136:151], v[36:39], v[56:59], v[136:151]
    v_mfma_f32_32x32x16_bf16 v[120:135], v[24:27], v[60:63], v[120:135]
    v_mfma_f32_32x32x16_bf16 v[136:151], v[32:35], v[60:63], v[136:151]
    v_subrev_u32 v9, 128, v9
    v_subrev_u32 v12, 7, v6
    v_max_i32 v12, -1, v12
    v_add_u32 v12, 1, v12
    v_mul_u32_u24 v12, 144, v12
    v_add_u32 v11, v10, v12
    ds_read_b128 v[64:67], v11 offset:0
    ds_read_b128 v[68:71], v11 offset:32
    ds_read_b128 v[72:75], v11 offset:64
    ds_read_b128 v[76:79], v11 offset:96
    ds_read2_b32 v[24:25], v9 offset0:24 offset1:25
    ds_read2_b32 v[26:27], v9 offset0:26 offset1:27
    ds_read2_b32 v[28:29], v9 offset0:16 offset1:17
    ds_read2_b32 v[30:31], v9 offset0:18 offset1:19
    ds_read2_b32 v[32:33], v9 offset0:8 offset1:9
    ds_read2_b32 v[34:35], v9 offset0:10 offset1:11
    ds_read2_b32 v[36:37], v9 offset0:0 offset1:1
    ds_read2_b32 v[38:39], v9 offset0:2 offset1:3
    s_waitcnt lgkmcnt(0)
    v_mfma_f32_32x32x16_bf16 v[120:135], v[28:31], v[64:67], v[120:135]
    v_mfma_f32_32x32x16_bf16 v[136:151], v[36:39], v[64:67], v[136:151]
    v_mfma_f32_32x32x16_bf16 v[120:135], v[24:27], v[68:71], v[120:135]
    v_mfma_f32_32x32x16_bf16 v[136:151], v[32:35], v[68:71], v[136:151]
    v_mfma_f32_32x32x16_bf16 v[120:135], v[44:47], v[72:75], v[120:135]
    v_mfma_f32_32x32x16_bf16 v[136:151], v[28:31], v[72:75], v[136:151]
    v_mfma_f32_32x32x16_bf16 v[120:135], v[40:43], v[76:79], v[120:135]
    v_mfma_f32_32x32x16_bf16 v[136:151], v[24:27], v[76:79], v[136:151]
    v_subrev_u32 v9, 128, v9
    v_subrev_u32 v12, 8, v6
    v_max_i32 v12, -1, v12
    v_add_u32 v12, 1, v12
    v_mul_u32_u24 v12, 144, v12
    v_add_u32 v11, v10, v12
    ds_read_b128 v[48:51], v11 offset:0
    ds_read_b128 v[52:55], v11 offset:32
    ds_read_b128 v[56:59], v11 offset:64
    ds_read_b128 v[60:63], v11 offset:96
    ds_read2_b32 v[40:41], v9 offset0:24 offset1:25
    ds_read2_b32 v[42:43], v9 offset0:26 offset1:27
    ds_read2_b32 v[44:45], v9 offset0:16 offset1:17
    ds_read2_b32 v[46:47], v9 offset0:18 offset1:19
    ds_read2_b32 v[24:25], v9 offset0:8 offset1:9
    ds_read2_b32 v[26:27], v9 offset0:10 offset1:11
    ds_read2_b32 v[28:29], v9 offset0:0 offset1:1
    ds_read2_b32 v[30:31], v9 offset0:2 offset1:3
    s_waitcnt lgkmcnt(0)
    v_mfma_f32_32x32x16_bf16 v[120:135], v[44:47], v[48:51], v[120:135]
    v_mfma_f32_32x32x16_bf16 v[136:151], v[28:31], v[48:51], v[136:151]
    v_mfma_f32_32x32x16_bf16 v[120:135], v[40:43], v[52:55], v[120:135]
    v_mfma_f32_32x32x16_bf16 v[136:151], v[24:27], v[52:55], v[136:151]
    v_mfma_f32_32x32x16_bf16 v[120:135], v[36:39], v[56:59], v[120:135]
    v_mfma_f32_32x32x16_bf16 v[136:151], v[44:47], v[56:59], v[136:151]
    v_mfma_f32_32x32x16_bf16 v[120:135], v[32:35], v[60:63], v[120:135]
    v_mfma_f32_32x32x16_bf16 v[136:151], v[40:43], v[60:63], v[136:151]
    v_subrev_u32 v9, 128, v9
    v_subrev_u32 v12, 9, v6
    v_max_i32 v12, -1, v12
    v_add_u32 v12, 1, v12
    v_mul_u32_u24 v12, 144, v12
    v_add_u32 v11, v10, v12
    ds_read_b128 v[64:67], v11 offset:0
    ds_read_b128 v[68:71], v11 offset:32
    ds_read_b128 v[72:75], v11 offset:64
    ds_read_b128 v[76:79], v11 offset:96
    ds_read2_b32 v[32:33], v9 offset0:24 offset1:25
    ds_read2_b32 v[34:35], v9 offset0:26 offset1:27
    ds_read2_b32 v[36:37], v9 offset0:16 offset1:17
    ds_read2_b32 v[38:39], v9 offset0:18 offset1:19
    ds_read2_b32 v[40:41], v9 offset0:8 offset1:9
    ds_read2_b32 v[42:43], v9 offset0:10 offset1:11
    ds_read2_b32 v[44:45], v9 offset0:0 offset1:1
    ds_read2_b32 v[46:47], v9 offset0:2 offset1:3
    s_waitcnt lgkmcnt(0)
    v_mfma_f32_32x32x16_bf16 v[120:135], v[36:39], v[64:67], v[120:135]
    v_mfma_f32_32x32x16_bf16 v[136:151], v[44:47], v[64:67], v[136:151]
    v_mfma_f32_32x32x16_bf16 v[120:135], v[32:35], v[68:71], v[120:135]
    v_mfma_f32_32x32x16_bf16 v[136:151], v[40:43], v[68:71], v[136:151]
    v_mfma_f32_32x32x16_bf16 v[120:135], v[28:31], v[72:75], v[120:135]
    v_mfma_f32_32x32x16_bf16 v[136:151], v[36:39], v[72:75], v[136:151]
    v_mfma_f32_32x32x16_bf16 v[120:135], v[24:27], v[76:79], v[120:135]
    v_mfma_f32_32x32x16_bf16 v[136:151], v[32:35], v[76:79], v[136:151]
    v_subrev_u32 v9, 128, v9
    v_subrev_u32 v12, 10, v6
    v_max_i32 v12, -1, v12
    v_add_u32 v12, 1, v12
    v_mul_u32_u24 v12, 144, v12
    v_add_u32 v11, v10, v12
    ds_read_b128 v[48:51], v11 offset:0
    ds_read_b128 v[52:55], v11 offset:32
    ds_read_b128 v[56:59], v11 offset:64
    ds_read_b128 v[60:63], v11 offset:96
    ds_read2_b32 v[24:25], v9 offset0:24 offset1:25
    ds_read2_b32 v[26:27], v9 offset0:26 offset1:27
    ds_read2_b32 v[28:29], v9 offset0:16 offset1:17
    ds_read2_b32 v[30:31], v9 offset0:18 offset1:19
    ds_read2_b32 v[32:33], v9 offset0:8 offset1:9
    ds_read2_b32 v[34:35], v9 offset0:10 offset1:11
    ds_read2_b32 v[36:37], v9 offset0:0 offset1:1
    ds_read2_b32 v[38:39], v9 offset0:2 offset1:3
    s_waitcnt lgkmcnt(0)
    v_mfma_f32_32x32x16_bf16 v[120:135], v[28:31], v[48:51], v[120:135]
    v_mfma_f32_32x32x16_bf16 v[136:151], v[36:39], v[48:51], v[136:151]
    v_mfma_f32_32x32x16_bf16 v[120:135], v[24:27], v[52:55], v[120:135]
    v_mfma_f32_32x32x16_bf16 v[136:151], v[32:35], v[52:55], v[136:151]
    v_mfma_f32_32x32x16_bf16 v[120:135], v[44:47], v[56:59], v[120:135]
    v_mfma_f32_32x32x16_bf16 v[136:151], v[28:31], v[56:59], v[136:151]
    v_mfma_f32_32x32x16_bf16 v[120:135], v[40:43], v[60:63], v[120:135]
    v_mfma_f32_32x32x16_bf16 v[136:151], v[24:27], v[60:63], v[136:151]
    v_subrev_u32 v9, 128, v9
    v_subrev_u32 v12, 11, v6
    v_max_i32 v12, -1, v12
    v_add_u32 v12, 1, v12
    v_mul_u32_u24 v12, 144, v12
    v_add_u32 v11, v10, v12
    ds_read_b128 v[64:67], v11 offset:0
    ds_read_b128 v[68:71], v11 offset:32
    ds_read_b128 v[72:75], v11 offset:64
    ds_read_b128 v[76:79], v11 offset:96
    ds_read2_b32 v[40:41], v9 offset0:24 offset1:25
    ds_read2_b32 v[42:43], v9 offset0:26 offset1:27
    ds_read2_b32 v[44:45], v9 offset0:16 offset1:17
    ds_read2_b32 v[46:47], v9 offset0:18 offset1:19
    ds_read2_b32 v[24:25], v9 offset0:8 offset1:9
    ds_read2_b32 v[26:27], v9 offset0:10 offset1:11
    ds_read2_b32 v[28:29], v9 offset0:0 offset1:1
    ds_read2_b32 v[30:31], v9 offset0:2 offset1:3
    s_waitcnt lgkmcnt(0)
    v_mfma_f32_32x32x16_bf16 v[120:135], v[44:47], v[64:67], v[120:135]
    v_mfma_f32_32x32x16_bf16 v[136:151], v[28:31], v[64:67], v[136:151]
    v_mfma_f32_32x32x16_bf16 v[120:135], v[40:43], v[68:71], v[120:135]
    v_mfma_f32_32x32x16_bf16 v[136:151], v[24:27], v[68:71], v[136:151]
    v_mfma_f32_32x32x16_bf16 v[120:135], v[36:39], v[72:75], v[120:135]
    v_mfma_f32_32x32x16_bf16 v[136:151], v[44:47], v[72:75], v[136:151]
    v_mfma_f32_32x32x16_bf16 v[120:135], v[32:35], v[76:79], v[120:135]
    v_mfma_f32_32x32x16_bf16 v[136:151], v[40:43], v[76:79], v[136:151]
    v_subrev_u32 v9, 128, v9
    v_subrev_u32 v12, 12, v6
    v_max_i32 v12, -1, v12
    v_add_u32 v12, 1, v12
    v_mul_u32_u24 v12, 144, v12
    v_add_u32 v11, v10, v12
    ds_read_b128 v[48:51], v11 offset:0
    ds_read_b128 v[52:55], v11 offset:32
    ds_read_b128 v[56:59], v11 offset:64
    ds_read_b128 v[60:63], v11 offset:96
    ds_read2_b32 v[32:33], v9 offset0:24 offset1:25
    ds_read2_b32 v[34:35], v9 offset0:26 offset1:27
    ds_read2_b32 v[36:37], v9 offset0:16 offset1:17
    ds_read2_b32 v[38:39], v9 offset0:18 offset1:19
    ds_read2_b32 v[40:41], v9 offset0:8 offset1:9
    ds_read2_b32 v[42:43], v9 offset0:10 offset1:11
    ds_read2_b32 v[44:45], v9 offset0:0 offset1:1
    ds_read2_b32 v[46:47], v9 offset0:2 offset1:3
    s_waitcnt lgkmcnt(0)
    v_mfma_f32_32x32x16_bf16 v[120:135], v[36:39], v[48:51], v[120:135]
    v_mfma_f32_32x32x16_bf16 v[136:151], v[44:47], v[48:51], v[136:151]
    v_mfma_f32_32x32x16_bf16 v[120:135], v[32:35], v[52:55], v[120:135]
    v_mfma_f32_32x32x16_bf16 v[136:151], v[40:43], v[52:55], v[136:151]
    v_mfma_f32_32x32x16_bf16 v[120:135], v[28:31], v[56:59], v[120:135]
    v_mfma_f32_32x32x16_bf16 v[136:151], v[36:39], v[56:59], v[136:151]
    v_mfma_f32_32x32x16_bf16 v[120:135], v[24:27], v[60:63], v[120:135]
    v_mfma_f32_32x32x16_bf16 v[136:151], v[32:35], v[60:63], v[136:151]
    v_subrev_u32 v9, 128, v9
    v_subrev_u32 v12, 13, v6
    v_max_i32 v12, -1, v12
    v_add_u32 v12, 1, v12
    v_mul_u32_u24 v12, 144, v12
    v_add_u32 v11, v10, v12
    ds_read_b128 v[64:67], v11 offset:0
    ds_read_b128 v[68:71], v11 offset:32
    ds_read_b128 v[72:75], v11 offset:64
    ds_read_b128 v[76:79], v11 offset:96
    ds_read2_b32 v[24:25], v9 offset0:24 offset1:25
    ds_read2_b32 v[26:27], v9 offset0:26 offset1:27
    ds_read2_b32 v[28:29], v9 offset0:16 offset1:17
    ds_read2_b32 v[30:31], v9 offset0:18 offset1:19
    ds_read2_b32 v[32:33], v9 offset0:8 offset1:9
    ds_read2_b32 v[34:35], v9 offset0:10 offset1:11
    ds_read2_b32 v[36:37], v9 offset0:0 offset1:1
    ds_read2_b32 v[38:39], v9 offset0:2 offset1:3
    s_waitcnt lgkmcnt(0)
    v_mfma_f32_32x32x16_bf16 v[120:135], v[28:31], v[64:67], v[120:135]
    v_mfma_f32_32x32x16_bf16 v[136:151], v[36:39], v[64:67], v[136:151]
    v_mfma_f32_32x32x16_bf16 v[120:135], v[24:27], v[68:71], v[120:135]
    v_mfma_f32_32x32x16_bf16 v[136:151], v[32:35], v[68:71], v[136:151]
    v_mfma_f32_32x32x16_bf16 v[120:135], v[44:47], v[72:75], v[120:135]
    v_mfma_f32_32x32x16_bf16 v[136:151], v[28:31], v[72:75], v[136:151]
    v_mfma_f32_32x32x16_bf16 v[120:135], v[40:43], v[76:79], v[120:135]
    v_mfma_f32_32x32x16_bf16 v[136:151], v[24:27], v[76:79], v[136:151]
    v_subrev_u32 v9, 128, v9
    v_subrev_u32 v12, 14, v6
    v_max_i32 v12, -1, v12
    v_add_u32 v12, 1, v12
    v_mul_u32_u24 v12, 144, v12
    v_add_u32 v11, v10, v12
    ds_read_b128 v[48:51], v11 offset:0
    ds_read_b128 v[52:55], v11 offset:32
    ds_read_b128 v[56:59], v11 offset:64
    ds_read_b128 v[60:63], v11 offset:96
    ds_read2_b32 v[40:41], v9 offset0:24 offset1:25
    ds_read2_b32 v[42:43], v9 offset0:26 offset1:27
    ds_read2_b32 v[44:45], v9 offset0:16 offset1:17
    ds_read2_b32 v[46:47], v9 offset0:18 offset1:19
    ds_read2_b32 v[24:25], v9 offset0:8 offset1:9
    ds_read2_b32 v[26:27], v9 offset0:10 offset1:11
    ds_read2_b32 v[28:29], v9 offset0:0 offset1:1
    ds_read2_b32 v[30:31], v9 offset0:2 offset1:3
    s_waitcnt lgkmcnt(0)
    v_mfma_f32_32x32x16_bf16 v[120:135], v[44:47], v[48:51], v[120:135]
    v_mfma_f32_32x32x16_bf16 v[136:151], v[28:31], v[48:51], v[136:151]
    v_mfma_f32_32x32x16_bf16 v[120:135], v[40:43], v[52:55], v[120:135]
    v_mfma_f32_32x32x16_bf16 v[136:151], v[24:27], v[52:55], v[136:151]
    v_mfma_f32_32x32x16_bf16 v[120:135], v[36:39], v[56:59], v[120:135]
    v_mfma_f32_32x32x16_bf16 v[136:151], v[44:47], v[56:59], v[136:151]
    v_mfma_f32_32x32x16_bf16 v[120:135], v[32:35], v[60:63], v[120:135]
    v_mfma_f32_32x32x16_bf16 v[136:151], v[40:43], v[60:63], v[136:151]
    v_subrev_u32 v9, 128, v9
    v_subrev_u32 v12, 15, v6
    v_max_i32 v12, -1, v12
    v_add_u32 v12, 1, v12
    v_mul_u32_u24 v12, 144, v12
    v_add_u32 v11, v10, v12
    ds_read_b128 v[64:67], v11 offset:0
    ds_read_b128 v[68:71], v11 offset:32
    ds_read_b128 v[72:75], v11 offset:64
    ds_read_b128 v[76:79], v11 offset:96
    ds_read2_b32 v[32:33], v9 offset0:24 offset1:25
    ds_read2_b32 v[34:35], v9 offset0:26 offset1:27
    ds_read2_b32 v[36:37], v9 offset0:16 offset1:17
    ds_read2_b32 v[38:39], v9 offset0:18 offset1:19
    ds_read2_b32 v[40:41], v9 offset0:8 offset1:9
    ds_read2_b32 v[42:43], v9 offset0:10 offset1:11
    ds_read2_b32 v[44:45], v9 offset0:0 offset1:1
    ds_read2_b32 v[46:47], v9 offset0:2 offset1:3
    s_waitcnt lgkmcnt(0)
    v_mfma_f32_32x32x16_bf16 v[120:135], v[36:39], v[64:67], v[120:135]
    v_mfma_f32_32x32x16_bf16 v[136:151], v[44:47], v[64:67], v[136:151]
    v_mfma_f32_32x32x16_bf16 v[120:135], v[32:35], v[68:71], v[120:135]
    v_mfma_f32_32x32x16_bf16 v[136:151], v[40:43], v[68:71], v[136:151]
    v_mfma_f32_32x32x16_bf16 v[120:135], v[28:31], v[72:75], v[120:135]
    v_mfma_f32_32x32x16_bf16 v[136:151], v[36:39], v[72:75], v[136:151]
    v_mfma_f32_32x32x16_bf16 v[120:135], v[24:27], v[76:79], v[120:135]
    v_mfma_f32_32x32x16_bf16 v[136:151], v[32:35], v[76:79], v[136:151]
    v_subrev_u32 v9, 128, v9
    v_subrev_u32 v12, 16, v6
    v_max_i32 v12, -1, v12
    v_add_u32 v12, 1, v12
    v_mul_u32_u24 v12, 144, v12
    v_add_u32 v11, v10, v12
    ds_read_b128 v[48:51], v11 offset:0
    ds_read_b128 v[52:55], v11 offset:32
    ds_read_b128 v[56:59], v11 offset:64
    ds_read_b128 v[60:63], v11 offset:96
    ds_read2_b32 v[24:25], v9 offset0:24 offset1:25
    ds_read2_b32 v[26:27], v9 offset0:26 offset1:27
    ds_read2_b32 v[28:29], v9 offset0:16 offset1:17
    ds_read2_b32 v[30:31], v9 offset0:18 offset1:19
    ds_read2_b32 v[32:33], v9 offset0:8 offset1:9
    ds_read2_b32 v[34:35], v9 offset0:10 offset1:11
    ds_read2_b32 v[36:37], v9 offset0:0 offset1:1
    ds_read2_b32 v[38:39], v9 offset0:2 offset1:3
    s_waitcnt lgkmcnt(0)
    v_mfma_f32_32x32x16_bf16 v[120:135], v[28:31], v[48:51], v[120:135]
    v_mfma_f32_32x32x16_bf16 v[136:151], v[36:39], v[48:51], v[136:151]
    v_mfma_f32_32x32x16_bf16 v[120:135], v[24:27], v[52:55], v[120:135]
    v_mfma_f32_32x32x16_bf16 v[136:151], v[32:35], v[52:55], v[136:151]
    v_mfma_f32_32x32x16_bf16 v[120:135], v[44:47], v[56:59], v[120:135]
    v_mfma_f32_32x32x16_bf16 v[136:151], v[28:31], v[56:59], v[136:151]
    v_mfma_f32_32x32x16_bf16 v[120:135], v[40:43], v[60:63], v[120:135]
    v_mfma_f32_32x32x16_bf16 v[136:151], v[24:27], v[60:63], v[136:151]
    v_subrev_u32 v9, 128, v9
    v_subrev_u32 v12, 17, v6
    v_max_i32 v12, -1, v12
    v_add_u32 v12, 1, v12
    v_mul_u32_u24 v12, 144, v12
    v_add_u32 v11, v10, v12
    ds_read_b128 v[64:67], v11 offset:0
    ds_read_b128 v[68:71], v11 offset:32
    ds_read_b128 v[72:75], v11 offset:64
    ds_read_b128 v[76:79], v11 offset:96
    ds_read2_b32 v[40:41], v9 offset0:24 offset1:25
    ds_read2_b32 v[42:43], v9 offset0:26 offset1:27
    ds_read2_b32 v[44:45], v9 offset0:16 offset1:17
    ds_read2_b32 v[46:47], v9 offset0:18 offset1:19
    ds_read2_b32 v[24:25], v9 offset0:8 offset1:9
    ds_read2_b32 v[26:27], v9 offset0:10 offset1:11
    ds_read2_b32 v[28:29], v9 offset0:0 offset1:1
    ds_read2_b32 v[30:31], v9 offset0:2 offset1:3
    s_waitcnt lgkmcnt(0)
    v_mfma_f32_32x32x16_bf16 v[120:135], v[44:47], v[64:67], v[120:135]
    v_mfma_f32_32x32x16_bf16 v[136:151], v[28:31], v[64:67], v[136:151]
    v_mfma_f32_32x32x16_bf16 v[120:135], v[40:43], v[68:71], v[120:135]
    v_mfma_f32_32x32x16_bf16 v[136:151], v[24:27], v[68:71], v[136:151]
    v_mfma_f32_32x32x16_bf16 v[120:135], v[36:39], v[72:75], v[120:135]
    v_mfma_f32_32x32x16_bf16 v[136:151], v[44:47], v[72:75], v[136:151]
    v_mfma_f32_32x32x16_bf16 v[120:135], v[32:35], v[76:79], v[120:135]
    v_mfma_f32_32x32x16_bf16 v[136:151], v[40:43], v[76:79], v[136:151]
    v_subrev_u32 v9, 128, v9
    v_subrev_u32 v12, 18, v6
    v_max_i32 v12, -1, v12
    v_add_u32 v12, 1, v12
    v_mul_u32_u24 v12, 144, v12
    v_add_u32 v11, v10, v12
    ds_read_b128 v[48:51], v11 offset:0
    ds_read_b128 v[52:55], v11 offset:32
    ds_read_b128 v[56:59], v11 offset:64
    ds_read_b128 v[60:63], v11 offset:96
    ds_read2_b32 v[32:33], v9 offset0:24 offset1:25
    ds_read2_b32 v[34:35], v9 offset0:26 offset1:27
    ds_read2_b32 v[36:37], v9 offset0:16 offset1:17
    ds_read2_b32 v[38:39], v9 offset0:18 offset1:19
    ds_read2_b32 v[40:41], v9 offset0:8 offset1:9
    ds_read2_b32 v[42:43], v9 offset0:10 offset1:11
    ds_read2_b32 v[44:45], v9 offset0:0 offset1:1
    ds_read2_b32 v[46:47], v9 offset0:2 offset1:3
    s_waitcnt lgkmcnt(0)
    v_mfma_f32_32x32x16_bf16 v[120:135], v[36:39], v[48:51], v[120:135]
    v_mfma_f32_32x32x16_bf16 v[136:151], v[44:47], v[48:51], v[136:151]
    v_mfma_f32_32x32x16_bf16 v[120:135], v[32:35], v[52:55], v[120:135]
    v_mfma_f32_32x32x16_bf16 v[136:151], v[40:43], v[52:55], v[136:151]
    v_mfma_f32_32x32x16_bf16 v[120:135], v[28:31], v[56:59], v[120:135]
    v_mfma_f32_32x32x16_bf16 v[136:151], v[36:39], v[56:59], v[136:151]
    v_mfma_f32_32x32x16_bf16 v[120:135], v[24:27], v[60:63], v[120:135]
    v_mfma_f32_32x32x16_bf16 v[136:151], v[32:35], v[60:63], v[136:151]
    v_subrev_u32 v9, 128, v9
    v_subrev_u32 v12, 19, v6
    v_max_i32 v12, -1, v12
    v_add_u32 v12, 1, v12
    v_mul_u32_u24 v12, 144, v12
    v_add_u32 v11, v10, v12
    ds_read_b128 v[64:67], v11 offset:0
    ds_read_b128 v[68:71], v11 offset:32
    ds_read_b128 v[72:75], v11 offset:64
    ds_read_b128 v[76:79], v11 offset:96
    ds_read2_b32 v[24:25], v9 offset0:24 offset1:25
    ds_read2_b32 v[26:27], v9 offset0:26 offset1:27
    ds_read2_b32 v[28:29], v9 offset0:16 offset1:17
    ds_read2_b32 v[30:31], v9 offset0:18 offset1:19
    ds_read2_b32 v[32:33], v9 offset0:8 offset1:9
    ds_read2_b32 v[34:35], v9 offset0:10 offset1:11
    ds_read2_b32 v[36:37], v9 offset0:0 offset1:1
    ds_read2_b32 v[38:39], v9 offset0:2 offset1:3
    s_waitcnt lgkmcnt(0)
    v_mfma_f32_32x32x16_bf16 v[120:135], v[28:31], v[64:67], v[120:135]
    v_mfma_f32_32x32x16_bf16 v[136:151], v[36:39], v[64:67], v[136:151]
    v_mfma_f32_32x32x16_bf16 v[120:135], v[24:27], v[68:71], v[120:135]
    v_mfma_f32_32x32x16_bf16 v[136:151], v[32:35], v[68:71], v[136:151]
    v_mfma_f32_32x32x16_bf16 v[120:135], v[44:47], v[72:75], v[120:135]
    v_mfma_f32_32x32x16_bf16 v[136:151], v[28:31], v[72:75], v[136:151]
    v_mfma_f32_32x32x16_bf16 v[120:135], v[40:43], v[76:79], v[120:135]
    v_mfma_f32_32x32x16_bf16 v[136:151], v[24:27], v[76:79], v[136:151]
    v_subrev_u32 v9, 128, v9
    v_subrev_u32 v12, 20, v6
    v_max_i32 v12, -1, v12
    v_add_u32 v12, 1, v12
    v_mul_u32_u24 v12, 144, v12
    v_add_u32 v11, v10, v12
    ds_read_b128 v[48:51], v11 offset:0
    ds_read_b128 v[52:55], v11 offset:32
    ds_read_b128 v[56:59], v11 offset:64
    ds_read_b128 v[60:63], v11 offset:96
    ds_read2_b32 v[40:41], v9 offset0:24 offset1:25
    ds_read2_b32 v[42:43], v9 offset0:26 offset1:27
    ds_read2_b32 v[44:45], v9 offset0:16 offset1:17
    ds_read2_b32 v[46:47], v9 offset0:18 offset1:19
    ds_read2_b32 v[24:25], v9 offset0:8 offset1:9
    ds_read2_b32 v[26:27], v9 offset0:10 offset1:11
    ds_read2_b32 v[28:29], v9 offset0:0 offset1:1
    ds_read2_b32 v[30:31], v9 offset0:2 offset1:3
    s_waitcnt lgkmcnt(0)
    v_mfma_f32_32x32x16_bf16 v[120:135], v[44:47], v[48:51], v[120:135]
    v_mfma_f32_32x32x16_bf16 v[136:151], v[28:31], v[48:51], v[136:151]
    v_mfma_f32_32x32x16_bf16 v[120:135], v[40:43], v[52:55], v[120:135]
    v_mfma_f32_32x32x16_bf16 v[136:151], v[24:27], v[52:55], v[136:151]
    v_mfma_f32_32x32x16_bf16 v[120:135], v[36:39], v[56:59], v[120:135]
    v_mfma_f32_32x32x16_bf16 v[136:151], v[44:47], v[56:59], v[136:151]
    v_mfma_f32_32x32x16_bf16 v[120:135], v[32:35], v[60:63], v[120:135]
    v_mfma_f32_32x32x16_bf16 v[136:151], v[40:43], v[60:63], v[136:151]
    v_subrev_u32 v9, 128, v9
    v_subrev_u32 v12, 21, v6
    v_max_i32 v12, -1, v12
    v_add_u32 v12, 1, v12
    v_mul_u32_u24 v12, 144, v12
    v_add_u32 v11, v10, v12
    ds_read_b128 v[64:67], v11 offset:0
    ds_read_b128 v[68:71], v11 offset:32
    ds_read_b128 v[72:75], v11 offset:64
    ds_read_b128 v[76:79], v11 offset:96
    ds_read2_b32 v[32:33], v9 offset0:24 offset1:25
    ds_read2_b32 v[34:35], v9 offset0:26 offset1:27
    ds_read2_b32 v[36:37], v9 offset0:16 offset1:17
    ds_read2_b32 v[38:39], v9 offset0:18 offset1:19
    ds_read2_b32 v[40:41], v9 offset0:8 offset1:9
    ds_read2_b32 v[42:43], v9 offset0:10 offset1:11
    ds_read2_b32 v[44:45], v9 offset0:0 offset1:1
    ds_read2_b32 v[46:47], v9 offset0:2 offset1:3
    s_waitcnt lgkmcnt(0)
    v_mfma_f32_32x32x16_bf16 v[120:135], v[36:39], v[64:67], v[120:135]
    v_mfma_f32_32x32x16_bf16 v[136:151], v[44:47], v[64:67], v[136:151]
    v_mfma_f32_32x32x16_bf16 v[120:135], v[32:35], v[68:71], v[120:135]
    v_mfma_f32_32x32x16_bf16 v[136:151], v[40:43], v[68:71], v[136:151]
    v_mfma_f32_32x32x16_bf16 v[120:135], v[28:31], v[72:75], v[120:135]
    v_mfma_f32_32x32x16_bf16 v[136:151], v[36:39], v[72:75], v[136:151]
    v_mfma_f32_32x32x16_bf16 v[120:135], v[24:27], v[76:79], v[120:135]
    v_mfma_f32_32x32x16_bf16 v[136:151], v[32:35], v[76:79], v[136:151]
    v_subrev_u32 v9, 128, v9
    v_subrev_u32 v12, 22, v6
    v_max_i32 v12, -1, v12
    v_add_u32 v12, 1, v12
    v_mul_u32_u24 v12, 144, v12
    v_add_u32 v11, v10, v12
    ds_read_b128 v[48:51], v11 offset:0
    ds_read_b128 v[52:55], v11 offset:32
    ds_read_b128 v[56:59], v11 offset:64
    ds_read_b128 v[60:63], v11 offset:96
    ds_read2_b32 v[24:25], v9 offset0:24 offset1:25
    ds_read2_b32 v[26:27], v9 offset0:26 offset1:27
    ds_read2_b32 v[28:29], v9 offset0:16 offset1:17
    ds_read2_b32 v[30:31], v9 offset0:18 offset1:19
    ds_read2_b32 v[32:33], v9 offset0:8 offset1:9
    ds_read2_b32 v[34:35], v9 offset0:10 offset1:11
    ds_read2_b32 v[36:37], v9 offset0:0 offset1:1
    ds_read2_b32 v[38:39], v9 offset0:2 offset1:3
    s_waitcnt lgkmcnt(0)
    v_mfma_f32_32x32x16_bf16 v[120:135], v[28:31], v[48:51], v[120:135]
    v_mfma_f32_32x32x16_bf16 v[136:151], v[36:39], v[48:51], v[136:151]
    v_mfma_f32_32x32x16_bf16 v[120:135], v[24:27], v[52:55], v[120:135]
    v_mfma_f32_32x32x16_bf16 v[136:151], v[32:35], v[52:55], v[136:151]
    v_mfma_f32_32x32x16_bf16 v[120:135], v[44:47], v[56:59], v[120:135]
    v_mfma_f32_32x32x16_bf16 v[136:151], v[28:31], v[56:59], v[136:151]
    v_mfma_f32_32x32x16_bf16 v[120:135], v[40:43], v[60:63], v[120:135]
    v_mfma_f32_32x32x16_bf16 v[136:151], v[24:27], v[60:63], v[136:151]
    v_subrev_u32 v9, 128, v9
    v_subrev_u32 v12, 23, v6
    v_max_i32 v12, -1, v12
    v_add_u32 v12, 1, v12
    v_mul_u32_u24 v12, 144, v12
    v_add_u32 v11, v10, v12
    ds_read_b128 v[64:67], v11 offset:0
    ds_read_b128 v[68:71], v11 offset:32
    ds_read_b128 v[72:75], v11 offset:64
    ds_read_b128 v[76:79], v11 offset:96
    ds_read2_b32 v[40:41], v9 offset0:24 offset1:25
    ds_read2_b32 v[42:43], v9 offset0:26 offset1:27
    ds_read2_b32 v[44:45], v9 offset0:16 offset1:17
    ds_read2_b32 v[46:47], v9 offset0:18 offset1:19
    ds_read2_b32 v[24:25], v9 offset0:8 offset1:9
    ds_read2_b32 v[26:27], v9 offset0:10 offset1:11
    ds_read2_b32 v[28:29], v9 offset0:0 offset1:1
    ds_read2_b32 v[30:31], v9 offset0:2 offset1:3
    s_waitcnt lgkmcnt(0)
    v_mfma_f32_32x32x16_bf16 v[120:135], v[44:47], v[64:67], v[120:135]
    v_mfma_f32_32x32x16_bf16 v[136:151], v[28:31], v[64:67], v[136:151]
    v_mfma_f32_32x32x16_bf16 v[120:135], v[40:43], v[68:71], v[120:135]
    v_mfma_f32_32x32x16_bf16 v[136:151], v[24:27], v[68:71], v[136:151]
    v_mfma_f32_32x32x16_bf16 v[120:135], v[36:39], v[72:75], v[120:135]
    v_mfma_f32_32x32x16_bf16 v[136:151], v[44:47], v[72:75], v[136:151]
    v_mfma_f32_32x32x16_bf16 v[120:135], v[32:35], v[76:79], v[120:135]
    v_mfma_f32_32x32x16_bf16 v[136:151], v[40:43], v[76:79], v[136:151]
    v_subrev_u32 v9, 128, v9
    v_subrev_u32 v12, 24, v6
    v_max_i32 v12, -1, v12
    v_add_u32 v12, 1, v12
    v_mul_u32_u24 v12, 144, v12
    v_add_u32 v11, v10, v12
    ds_read_b128 v[48:51], v11 offset:0
    ds_read_b128 v[52:55], v11 offset:32
    ds_read_b128 v[56:59], v11 offset:64
    ds_read_b128 v[60:63], v11 offset:96
    ds_read2_b32 v[32:33], v9 offset0:24 offset1:25
    ds_read2_b32 v[34:35], v9 offset0:26 offset1:27
    ds_read2_b32 v[36:37], v9 offset0:16 offset1:17
    ds_read2_b32 v[38:39], v9 offset0:18 offset1:19
    ds_read2_b32 v[40:41], v9 offset0:8 offset1:9
    ds_read2_b32 v[42:43], v9 offset0:10 offset1:11
    ds_read2_b32 v[44:45], v9 offset0:0 offset1:1
    ds_read2_b32 v[46:47], v9 offset0:2 offset1:3
    s_waitcnt lgkmcnt(0)
    v_mfma_f32_32x32x16_bf16 v[120:135], v[36:39], v[48:51], v[120:135]
    v_mfma_f32_32x32x16_bf16 v[136:151], v[44:47], v[48:51], v[136:151]
    v_mfma_f32_32x32x16_bf16 v[120:135], v[32:35], v[52:55], v[120:135]
    v_mfma_f32_32x32x16_bf16 v[136:151], v[40:43], v[52:55], v[136:151]
    v_mfma_f32_32x32x16_bf16 v[120:135], v[28:31], v[56:59], v[120:135]
    v_mfma_f32_32x32x16_bf16 v[136:151], v[36:39], v[56:59], v[136:151]
    v_mfma_f32_32x32x16_bf16 v[120:135], v[24:27], v[60:63], v[120:135]
    v_mfma_f32_32x32x16_bf16 v[136:151], v[32:35], v[60:63], v[136:151]
    v_subrev_u32 v9, 128, v9
    v_subrev_u32 v12, 25, v6
    v_max_i32 v12, -1, v12
    v_add_u32 v12, 1, v12
    v_mul_u32_u24 v12, 144, v12
    v_add_u32 v11, v10, v12
    ds_read_b128 v[64:67], v11 offset:0
    ds_read_b128 v[68:71], v11 offset:32
    ds_read_b128 v[72:75], v11 offset:64
    ds_read_b128 v[76:79], v11 offset:96
    ds_read2_b32 v[24:25], v9 offset0:24 offset1:25
    ds_read2_b32 v[26:27], v9 offset0:26 offset1:27
    ds_read2_b32 v[28:29], v9 offset0:16 offset1:17
    ds_read2_b32 v[30:31], v9 offset0:18 offset1:19
    ds_read2_b32 v[32:33], v9 offset0:8 offset1:9
    ds_read2_b32 v[34:35], v9 offset0:10 offset1:11
    ds_read2_b32 v[36:37], v9 offset0:0 offset1:1
    ds_read2_b32 v[38:39], v9 offset0:2 offset1:3
    s_waitcnt lgkmcnt(0)
    v_mfma_f32_32x32x16_bf16 v[120:135], v[28:31], v[64:67], v[120:135]
    v_mfma_f32_32x32x16_bf16 v[136:151], v[36:39], v[64:67], v[136:151]
    v_mfma_f32_32x32x16_bf16 v[120:135], v[24:27], v[68:71], v[120:135]
    v_mfma_f32_32x32x16_bf16 v[136:151], v[32:35], v[68:71], v[136:151]
    v_mfma_f32_32x32x16_bf16 v[120:135], v[44:47], v[72:75], v[120:135]
    v_mfma_f32_32x32x16_bf16 v[136:151], v[28:31], v[72:75], v[136:151]
    v_mfma_f32_32x32x16_bf16 v[120:135], v[40:43], v[76:79], v[120:135]
    v_mfma_f32_32x32x16_bf16 v[136:151], v[24:27], v[76:79], v[136:151]
    v_subrev_u32 v9, 128, v9
    v_subrev_u32 v12, 26, v6
    v_max_i32 v12, -1, v12
    v_add_u32 v12, 1, v12
    v_mul_u32_u24 v12, 144, v12
    v_add_u32 v11, v10, v12
    ds_read_b128 v[48:51], v11 offset:0
    ds_read_b128 v[52:55], v11 offset:32
    ds_read_b128 v[56:59], v11 offset:64
    ds_read_b128 v[60:63], v11 offset:96
    ds_read2_b32 v[40:41], v9 offset0:24 offset1:25
    ds_read2_b32 v[42:43], v9 offset0:26 offset1:27
    ds_read2_b32 v[44:45], v9 offset0:16 offset1:17
    ds_read2_b32 v[46:47], v9 offset0:18 offset1:19
    ds_read2_b32 v[24:25], v9 offset0:8 offset1:9
    ds_read2_b32 v[26:27], v9 offset0:10 offset1:11
    ds_read2_b32 v[28:29], v9 offset0:0 offset1:1
    ds_read2_b32 v[30:31], v9 offset0:2 offset1:3
    s_waitcnt lgkmcnt(0)
    v_mfma_f32_32x32x16_bf16 v[120:135], v[44:47], v[48:51], v[120:135]
    v_mfma_f32_32x32x16_bf16 v[136:151], v[28:31], v[48:51], v[136:151]
    v_mfma_f32_32x32x16_bf16 v[120:135], v[40:43], v[52:55], v[120:135]
    v_mfma_f32_32x32x16_bf16 v[136:151], v[24:27], v[52:55], v[136:151]
    v_mfma_f32_32x32x16_bf16 v[120:135], v[36:39], v[56:59], v[120:135]
    v_mfma_f32_32x32x16_bf16 v[136:151], v[44:47], v[56:59], v[136:151]
    v_mfma_f32_32x32x16_bf16 v[120:135], v[32:35], v[60:63], v[120:135]
    v_mfma_f32_32x32x16_bf16 v[136:151], v[40:43], v[60:63], v[136:151]
    v_subrev_u32 v9, 128, v9
    v_subrev_u32 v12, 27, v6
    v_max_i32 v12, -1, v12
    v_add_u32 v12, 1, v12
    v_mul_u32_u24 v12, 144, v12
    v_add_u32 v11, v10, v12
    ds_read_b128 v[64:67], v11 offset:0
    ds_read_b128 v[68:71], v11 offset:32
    ds_read_b128 v[72:75], v11 offset:64
    ds_read_b128 v[76:79], v11 offset:96
    ds_read2_b32 v[32:33], v9 offset0:24 offset1:25
    ds_read2_b32 v[34:35], v9 offset0:26 offset1:27
    ds_read2_b32 v[36:37], v9 offset0:16 offset1:17
    ds_read2_b32 v[38:39], v9 offset0:18 offset1:19
    ds_read2_b32 v[40:41], v9 offset0:8 offset1:9
    ds_read2_b32 v[42:43], v9 offset0:10 offset1:11
    ds_read2_b32 v[44:45], v9 offset0:0 offset1:1
    ds_read2_b32 v[46:47], v9 offset0:2 offset1:3
    s_waitcnt lgkmcnt(0)
    v_mfma_f32_32x32x16_bf16 v[120:135], v[36:39], v[64:67], v[120:135]
    v_mfma_f32_32x32x16_bf16 v[136:151], v[44:47], v[64:67], v[136:151]
    v_mfma_f32_32x32x16_bf16 v[120:135], v[32:35], v[68:71], v[120:135]
    v_mfma_f32_32x32x16_bf16 v[136:151], v[40:43], v[68:71], v[136:151]
    v_mfma_f32_32x32x16_bf16 v[120:135], v[28:31], v[72:75], v[120:135]
    v_mfma_f32_32x32x16_bf16 v[136:151], v[36:39], v[72:75], v[136:151]
    v_mfma_f32_32x32x16_bf16 v[120:135], v[24:27], v[76:79], v[120:135]
    v_mfma_f32_32x32x16_bf16 v[136:151], v[32:35], v[76:79], v[136:151]
    v_subrev_u32 v9, 128, v9
    v_subrev_u32 v12, 28, v6
    v_max_i32 v12, -1, v12
    v_add_u32 v12, 1, v12
    v_mul_u32_u24 v12, 144, v12
    v_add_u32 v11, v10, v12
    ds_read_b128 v[48:51], v11 offset:0
    ds_read_b128 v[52:55], v11 offset:32
    ds_read_b128 v[56:59], v11 offset:64
    ds_read_b128 v[60:63], v11 offset:96
    ds_read2_b32 v[24:25], v9 offset0:24 offset1:25
    ds_read2_b32 v[26:27], v9 offset0:26 offset1:27
    ds_read2_b32 v[28:29], v9 offset0:16 offset1:17
    ds_read2_b32 v[30:31], v9 offset0:18 offset1:19
    ds_read2_b32 v[32:33], v9 offset0:8 offset1:9
    ds_read2_b32 v[34:35], v9 offset0:10 offset1:11
    ds_read2_b32 v[36:37], v9 offset0:0 offset1:1
    ds_read2_b32 v[38:39], v9 offset0:2 offset1:3
    s_waitcnt lgkmcnt(0)
    v_mfma_f32_32x32x16_bf16 v[120:135], v[28:31], v[48:51], v[120:135]
    v_mfma_f32_32x32x16_bf16 v[136:151], v[36:39], v[48:51], v[136:151]
    v_mfma_f32_32x32x16_bf16 v[120:135], v[24:27], v[52:55], v[120:135]
    v_mfma_f32_32x32x16_bf16 v[136:151], v[32:35], v[52:55], v[136:151]
    v_mfma_f32_32x32x16_bf16 v[120:135], v[44:47], v[56:59], v[120:135]
    v_mfma_f32_32x32x16_bf16 v[136:151], v[28:31], v[56:59], v[136:151]
    v_mfma_f32_32x32x16_bf16 v[120:135], v[40:43], v[60:63], v[120:135]
    v_mfma_f32_32x32x16_bf16 v[136:151], v[24:27], v[60:63], v[136:151]
    v_subrev_u32 v9, 128, v9
    v_subrev_u32 v12, 29, v6
    v_max_i32 v12, -1, v12
    v_add_u32 v12, 1, v12
    v_mul_u32_u24 v12, 144, v12
    v_add_u32 v11, v10, v12
    ds_read_b128 v[64:67], v11 offset:0
    ds_read_b128 v[68:71], v11 offset:32
    ds_read_b128 v[72:75], v11 offset:64
    ds_read_b128 v[76:79], v11 offset:96
    ds_read2_b32 v[40:41], v9 offset0:24 offset1:25
    ds_read2_b32 v[42:43], v9 offset0:26 offset1:27
    ds_read2_b32 v[44:45], v9 offset0:16 offset1:17
    ds_read2_b32 v[46:47], v9 offset0:18 offset1:19
    ds_read2_b32 v[24:25], v9 offset0:8 offset1:9
    ds_read2_b32 v[26:27], v9 offset0:10 offset1:11
    ds_read2_b32 v[28:29], v9 offset0:0 offset1:1
    ds_read2_b32 v[30:31], v9 offset0:2 offset1:3
    s_waitcnt lgkmcnt(0)
    v_mfma_f32_32x32x16_bf16 v[120:135], v[44:47], v[64:67], v[120:135]
    v_mfma_f32_32x32x16_bf16 v[136:151], v[28:31], v[64:67], v[136:151]
    v_mfma_f32_32x32x16_bf16 v[120:135], v[40:43], v[68:71], v[120:135]
    v_mfma_f32_32x32x16_bf16 v[136:151], v[24:27], v[68:71], v[136:151]
    v_mfma_f32_32x32x16_bf16 v[120:135], v[36:39], v[72:75], v[120:135]
    v_mfma_f32_32x32x16_bf16 v[136:151], v[44:47], v[72:75], v[136:151]
    v_mfma_f32_32x32x16_bf16 v[120:135], v[32:35], v[76:79], v[120:135]
    v_mfma_f32_32x32x16_bf16 v[136:151], v[40:43], v[76:79], v[136:151]
    v_subrev_u32 v9, 128, v9
    v_subrev_u32 v12, 30, v6
    v_max_i32 v12, -1, v12
    v_add_u32 v12, 1, v12
    v_mul_u32_u24 v12, 144, v12
    v_add_u32 v11, v10, v12
    ds_read_b128 v[48:51], v11 offset:0
    ds_read_b128 v[52:55], v11 offset:32
    ds_read_b128 v[56:59], v11 offset:64
    ds_read_b128 v[60:63], v11 offset:96
    ds_read2_b32 v[32:33], v9 offset0:24 offset1:25
    ds_read2_b32 v[34:35], v9 offset0:26 offset1:27
    ds_read2_b32 v[36:37], v9 offset0:16 offset1:17
    ds_read2_b32 v[38:39], v9 offset0:18 offset1:19
    ds_read2_b32 v[40:41], v9 offset0:8 offset1:9
    ds_read2_b32 v[42:43], v9 offset0:10 offset1:11
    ds_read2_b32 v[44:45], v9 offset0:0 offset1:1
    ds_read2_b32 v[46:47], v9 offset0:2 offset1:3
    s_waitcnt lgkmcnt(0)
    v_mfma_f32_32x32x16_bf16 v[120:135], v[36:39], v[48:51], v[120:135]
    v_mfma_f32_32x32x16_bf16 v[136:151], v[44:47], v[48:51], v[136:151]
    v_mfma_f32_32x32x16_bf16 v[120:135], v[32:35], v[52:55], v[120:135]
    v_mfma_f32_32x32x16_bf16 v[136:151], v[40:43], v[52:55], v[136:151]
    v_mfma_f32_32x32x16_bf16 v[120:135], v[28:31], v[56:59], v[120:135]
    v_mfma_f32_32x32x16_bf16 v[136:151], v[36:39], v[56:59], v[136:151]
    v_mfma_f32_32x32x16_bf16 v[120:135], v[24:27], v[60:63], v[120:135]
    v_mfma_f32_32x32x16_bf16 v[136:151], v[32:35], v[60:63], v[136:151]
    v_subrev_u32 v9, 128, v9
    v_subrev_u32 v12, 31, v6
    v_max_i32 v12, -1, v12
    v_add_u32 v12, 1, v12
    v_mul_u32_u24 v12, 144, v12
    v_add_u32 v11, v10, v12
    ds_read_b128 v[64:67], v11 offset:0
    ds_read_b128 v[68:71], v11 offset:32
    ds_read_b128 v[72:75], v11 offset:64
    ds_read_b128 v[76:79], v11 offset:96
    ds_read2_b32 v[24:25], v9 offset0:24 offset1:25
    ds_read2_b32 v[26:27], v9 offset0:26 offset1:27
    ds_read2_b32 v[28:29], v9 offset0:16 offset1:17
    ds_read2_b32 v[30:31], v9 offset0:18 offset1:19
    ds_read2_b32 v[32:33], v9 offset0:8 offset1:9
    ds_read2_b32 v[34:35], v9 offset0:10 offset1:11
    ds_read2_b32 v[36:37], v9 offset0:0 offset1:1
    ds_read2_b32 v[38:39], v9 offset0:2 offset1:3
    s_waitcnt lgkmcnt(0)
    v_mfma_f32_32x32x16_bf16 v[120:135], v[28:31], v[64:67], v[120:135]
    v_mfma_f32_32x32x16_bf16 v[136:151], v[36:39], v[64:67], v[136:151]
    v_mfma_f32_32x32x16_bf16 v[120:135], v[24:27], v[68:71], v[120:135]
    v_mfma_f32_32x32x16_bf16 v[136:151], v[32:35], v[68:71], v[136:151]
    v_mfma_f32_32x32x16_bf16 v[120:135], v[44:47], v[72:75], v[120:135]
    v_mfma_f32_32x32x16_bf16 v[136:151], v[28:31], v[72:75], v[136:151]
    v_mfma_f32_32x32x16_bf16 v[120:135], v[40:43], v[76:79], v[120:135]
    v_mfma_f32_32x32x16_bf16 v[136:151], v[24:27], v[76:79], v[136:151]
    v_subrev_u32 v9, 128, v9
    s_nop 15
    s_barrier
    v_mul_u32_u24 v8, 520, v6
    v_lshlrev_b32 v11, 5, v7
    s_lshl_b32 s11, s8, 1
    v_add3_u32 v8, v8, v11, s11
    v_cvt_pk_bf16_f32 v12, v120, v121
    ds_write_b16 v8, v12 offset:0
    ds_write_b16_d16_hi v8, v12 offset:8
    v_cvt_pk_bf16_f32 v12, v122, v123
    ds_write_b16 v8, v12 offset:16
    ds_write_b16_d16_hi v8, v12 offset:24
    v_cvt_pk_bf16_f32 v12, v124, v125
    ds_write_b16 v8, v12 offset:64
    ds_write_b16_d16_hi v8, v12 offset:72
    v_cvt_pk_bf16_f32 v12, v126, v127
    ds_write_b16 v8, v12 offset:80
    ds_write_b16_d16_hi v8, v12 offset:88
    v_cvt_pk_bf16_f32 v12, v128, v129
    ds_write_b16 v8, v12 offset:128
    ds_write_b16_d16_hi v8, v12 offset:136
    v_cvt_pk_bf16_f32 v12, v130, v131
    ds_write_b16 v8, v12 offset:144
    ds_write_b16_d16_hi v8, v12 offset:152
    v_cvt_pk_bf16_f32 v12, v132, v133
    ds_write_b16 v8, v12 offset:192
    ds_write_b16_d16_hi v8, v12 offset:200
    v_cvt_pk_bf16_f32 v12, v134, v135
    ds_write_b16 v8, v12 offset:208
    ds_write_b16_d16_hi v8, v12 offset:216
    v_cvt_pk_bf16_f32 v12, v136, v137
    ds_write_b16 v8, v12 offset:256
    ds_write_b16_d16_hi v8, v12 offset:264
    v_cvt_pk_bf16_f32 v12, v138, v139
    ds_write_b16 v8, v12 offset:272
    ds_write_b16_d16_hi v8, v12 offset:280
    v_cvt_pk_bf16_f32 v12, v140, v141
    ds_write_b16 v8, v12 offset:320
    ds_write_b16_d16_hi v8, v12 offset:328
    v_cvt_pk_bf16_f32 v12, v142, v143
    ds_write_b16 v8, v12 offset:336
    ds_write_b16_d16_hi v8, v12 offset:344
    v_cvt_pk_bf16_f32 v12, v144, v145
    ds_write_b16 v8, v12 offset:384
    ds_write_b16_d16_hi v8, v12 offset:392
    v_cvt_pk_bf16_f32 v12, v146, v147
    ds_write_b16 v8, v12 offset:400
    ds_write_b16_d16_hi v8, v12 offset:408
    v_cvt_pk_bf16_f32 v12, v148, v149
    ds_write_b16 v8, v12 offset:448
    ds_write_b16_d16_hi v8, v12 offset:456
    v_cvt_pk_bf16_f32 v12, v150, v151
    ds_write_b16 v8, v12 offset:464
    ds_write_b16_d16_hi v8, v12 offset:472
    s_waitcnt lgkmcnt(0)
    s_barrier
    s_mov_b32 s36, s34
    s_and_b32 s37, s35, 0xffff
    s_mov_b32 s38, 5242880
    s_mov_b32 s39, 0x20000
    v_lshlrev_b32 v8, 3, v0
    v_lshrrev_b32 v11, 6, v0
    v_lshlrev_b32 v11, 3, v11
    v_add_u32 v8, v8, v11
    v_mul_u32_u24 v9, 2560, v0
    s_lshl_b32 s11, s9, 1
    v_add_u32 v9, s11, v9
    v_lshlrev_b32 v20, 16, v116
    v_and_b32 v21, 0xffff0000, v116
    v_lshlrev_b32 v22, 16, v117
    v_and_b32 v23, 0xffff0000, v117
    ds_read_b64 v[24:25], v8 offset:0
    ds_read_b64 v[26:27], v8 offset:2080
    ds_read_b64 v[28:29], v8 offset:4160
    ds_read_b64 v[30:31], v8 offset:6240
    ds_read_b64 v[32:33], v8 offset:8320
    ds_read_b64 v[34:35], v8 offset:10400
    ds_read_b64 v[36:37], v8 offset:12480
    ds_read_b64 v[38:39], v8 offset:14560
    s_waitcnt lgkmcnt(0)
    v_lshlrev_b32 v12, 16, v100
    v_and_b32 v13, 0xffff0000, v100
    v_mul_f32 v12, v12, v20
    v_mul_f32 v13, v13, v21
    v_cvt_pk_bf16_f32 v12, v12, v13
    v_lshlrev_b32 v14, 16, v12
    v_and_b32 v15, 0xffff0000, v12
    v_lshlrev_b32 v16, 16, v24
    v_and_b32 v17, 0xffff0000, v24
    v_add_f32 v14, v14, v16
    v_add_f32 v15, v15, v17
    v_cvt_pk_bf16_f32 v24, v14, v15
    v_lshlrev_b32 v12, 16, v101
    v_and_b32 v13, 0xffff0000, v101
    v_mul_f32 v12, v12, v22
    v_mul_f32 v13, v13, v23
    v_cvt_pk_bf16_f32 v12, v12, v13
    v_lshlrev_b32 v14, 16, v12
    v_and_b32 v15, 0xffff0000, v12
    v_lshlrev_b32 v16, 16, v25
    v_and_b32 v17, 0xffff0000, v25
    v_add_f32 v14, v14, v16
    v_add_f32 v15, v15, v17
    v_cvt_pk_bf16_f32 v25, v14, v15
    s_mov_b32 s12, 0
    buffer_store_dwordx2 v[24:25], v9, s[36:39], s12 offen
    v_lshlrev_b32 v12, 16, v102
    v_and_b32 v13, 0xffff0000, v102
    v_mul_f32 v12, v12, v20
    v_mul_f32 v13, v13, v21
    v_cvt_pk_bf16_f32 v12, v12, v13
    v_lshlrev_b32 v14, 16, v12
    v_and_b32 v15, 0xffff0000, v12
    v_lshlrev_b32 v16, 16, v26
    v_and_b32 v17, 0xffff0000, v26
    v_add_f32 v14, v14, v16
    v_add_f32 v15, v15, v17
    v_cvt_pk_bf16_f32 v26, v14, v15
    v_lshlrev_b32 v12, 16, v103
    v_and_b32 v13, 0xffff0000, v103
    v_mul_f32 v12, v12, v22
    v_mul_f32 v13, v13, v23
    v_cvt_pk_bf16_f32 v12, v12, v13
    v_lshlrev_b32 v14, 16, v12
    v_and_b32 v15, 0xffff0000, v12
    v_lshlrev_b32 v16, 16, v27
    v_and_b32 v17, 0xffff0000, v27
    v_add_f32 v14, v14, v16
    v_add_f32 v15, v15, v17
    v_cvt_pk_bf16_f32 v27, v14, v15
    s_mov_b32 s12, 655360
    buffer_store_dwordx2 v[26:27], v9, s[36:39], s12 offen
    v_lshlrev_b32 v12, 16, v104
    v_and_b32 v13, 0xffff0000, v104
    v_mul_f32 v12, v12, v20
    v_mul_f32 v13, v13, v21
    v_cvt_pk_bf16_f32 v12, v12, v13
    v_lshlrev_b32 v14, 16, v12
    v_and_b32 v15, 0xffff0000, v12
    v_lshlrev_b32 v16, 16, v28
    v_and_b32 v17, 0xffff0000, v28
    v_add_f32 v14, v14, v16
    v_add_f32 v15, v15, v17
    v_cvt_pk_bf16_f32 v28, v14, v15
    v_lshlrev_b32 v12, 16, v105
    v_and_b32 v13, 0xffff0000, v105
    v_mul_f32 v12, v12, v22
    v_mul_f32 v13, v13, v23
    v_cvt_pk_bf16_f32 v12, v12, v13
    v_lshlrev_b32 v14, 16, v12
    v_and_b32 v15, 0xffff0000, v12
    v_lshlrev_b32 v16, 16, v29
    v_and_b32 v17, 0xffff0000, v29
    v_add_f32 v14, v14, v16
    v_add_f32 v15, v15, v17
    v_cvt_pk_bf16_f32 v29, v14, v15
    s_mov_b32 s12, 1310720
    buffer_store_dwordx2 v[28:29], v9, s[36:39], s12 offen
    v_lshlrev_b32 v12, 16, v106
    v_and_b32 v13, 0xffff0000, v106
    v_mul_f32 v12, v12, v20
    v_mul_f32 v13, v13, v21
    v_cvt_pk_bf16_f32 v12, v12, v13
    v_lshlrev_b32 v14, 16, v12
    v_and_b32 v15, 0xffff0000, v12
    v_lshlrev_b32 v16, 16, v30
    v_and_b32 v17, 0xffff0000, v30
    v_add_f32 v14, v14, v16
    v_add_f32 v15, v15, v17
    v_cvt_pk_bf16_f32 v30, v14, v15
    v_lshlrev_b32 v12, 16, v107
    v_and_b32 v13, 0xffff0000, v107
    v_mul_f32 v12, v12, v22
    v_mul_f32 v13, v13, v23
    v_cvt_pk_bf16_f32 v12, v12, v13
    v_lshlrev_b32 v14, 16, v12
    v_and_b32 v15, 0xffff0000, v12
    v_lshlrev_b32 v16, 16, v31
    v_and_b32 v17, 0xffff0000, v31
    v_add_f32 v14, v14, v16
    v_add_f32 v15, v15, v17
    v_cvt_pk_bf16_f32 v31, v14, v15
    s_mov_b32 s12, 1966080
    buffer_store_dwordx2 v[30:31], v9, s[36:39], s12 offen
    v_lshlrev_b32 v12, 16, v108
    v_and_b32 v13, 0xffff0000, v108
    v_mul_f32 v12, v12, v20
    v_mul_f32 v13, v13, v21
    v_cvt_pk_bf16_f32 v12, v12, v13
    v_lshlrev_b32 v14, 16, v12
    v_and_b32 v15, 0xffff0000, v12
    v_lshlrev_b32 v16, 16, v32
    v_and_b32 v17, 0xffff0000, v32
    v_add_f32 v14, v14, v16
    v_add_f32 v15, v15, v17
    v_cvt_pk_bf16_f32 v32, v14, v15
    v_lshlrev_b32 v12, 16, v109
    v_and_b32 v13, 0xffff0000, v109
    v_mul_f32 v12, v12, v22
    v_mul_f32 v13, v13, v23
    v_cvt_pk_bf16_f32 v12, v12, v13
    v_lshlrev_b32 v14, 16, v12
    v_and_b32 v15, 0xffff0000, v12
    v_lshlrev_b32 v16, 16, v33
    v_and_b32 v17, 0xffff0000, v33
    v_add_f32 v14, v14, v16
    v_add_f32 v15, v15, v17
    v_cvt_pk_bf16_f32 v33, v14, v15
    s_mov_b32 s12, 2621440
    buffer_store_dwordx2 v[32:33], v9, s[36:39], s12 offen
    v_lshlrev_b32 v12, 16, v110
    v_and_b32 v13, 0xffff0000, v110
    v_mul_f32 v12, v12, v20
    v_mul_f32 v13, v13, v21
    v_cvt_pk_bf16_f32 v12, v12, v13
    v_lshlrev_b32 v14, 16, v12
    v_and_b32 v15, 0xffff0000, v12
    v_lshlrev_b32 v16, 16, v34
    v_and_b32 v17, 0xffff0000, v34
    v_add_f32 v14, v14, v16
    v_add_f32 v15, v15, v17
    v_cvt_pk_bf16_f32 v34, v14, v15
    v_lshlrev_b32 v12, 16, v111
    v_and_b32 v13, 0xffff0000, v111
    v_mul_f32 v12, v12, v22
    v_mul_f32 v13, v13, v23
    v_cvt_pk_bf16_f32 v12, v12, v13
    v_lshlrev_b32 v14, 16, v12
    v_and_b32 v15, 0xffff0000, v12
    v_lshlrev_b32 v16, 16, v35
    v_and_b32 v17, 0xffff0000, v35
    v_add_f32 v14, v14, v16
    v_add_f32 v15, v15, v17
    v_cvt_pk_bf16_f32 v35, v14, v15
    s_mov_b32 s12, 3276800
    buffer_store_dwordx2 v[34:35], v9, s[36:39], s12 offen
    v_lshlrev_b32 v12, 16, v112
    v_and_b32 v13, 0xffff0000, v112
    v_mul_f32 v12, v12, v20
    v_mul_f32 v13, v13, v21
    v_cvt_pk_bf16_f32 v12, v12, v13
    v_lshlrev_b32 v14, 16, v12
    v_and_b32 v15, 0xffff0000, v12
    v_lshlrev_b32 v16, 16, v36
    v_and_b32 v17, 0xffff0000, v36
    v_add_f32 v14, v14, v16
    v_add_f32 v15, v15, v17
    v_cvt_pk_bf16_f32 v36, v14, v15
    v_lshlrev_b32 v12, 16, v113
    v_and_b32 v13, 0xffff0000, v113
    v_mul_f32 v12, v12, v22
    v_mul_f32 v13, v13, v23
    v_cvt_pk_bf16_f32 v12, v12, v13
    v_lshlrev_b32 v14, 16, v12
    v_and_b32 v15, 0xffff0000, v12
    v_lshlrev_b32 v16, 16, v37
    v_and_b32 v17, 0xffff0000, v37
    v_add_f32 v14, v14, v16
    v_add_f32 v15, v15, v17
    v_cvt_pk_bf16_f32 v37, v14, v15
    s_mov_b32 s12, 3932160
    buffer_store_dwordx2 v[36:37], v9, s[36:39], s12 offen
    v_lshlrev_b32 v12, 16, v114
    v_and_b32 v13, 0xffff0000, v114
    v_mul_f32 v12, v12, v20
    v_mul_f32 v13, v13, v21
    v_cvt_pk_bf16_f32 v12, v12, v13
    v_lshlrev_b32 v14, 16, v12
    v_and_b32 v15, 0xffff0000, v12
    v_lshlrev_b32 v16, 16, v38
    v_and_b32 v17, 0xffff0000, v38
    v_add_f32 v14, v14, v16
    v_add_f32 v15, v15, v17
    v_cvt_pk_bf16_f32 v38, v14, v15
    v_lshlrev_b32 v12, 16, v115
    v_and_b32 v13, 0xffff0000, v115
    v_mul_f32 v12, v12, v22
    v_mul_f32 v13, v13, v23
    v_cvt_pk_bf16_f32 v12, v12, v13
    v_lshlrev_b32 v14, 16, v12
    v_and_b32 v15, 0xffff0000, v12
    v_lshlrev_b32 v16, 16, v39
    v_and_b32 v17, 0xffff0000, v39
    v_add_f32 v14, v14, v16
    v_add_f32 v15, v15, v17
    v_cvt_pk_bf16_f32 v39, v14, v15
    s_mov_b32 s12, 4587520
    buffer_store_dwordx2 v[38:39], v9, s[36:39], s12 offen
    s_barrier
    s_branch CH_wtop86
CH_wao91:
    s_sub_u32 s13, s13, 320
    s_cmp_ge_u32 s13, 688
    s_cbranch_scc1 CH_wr2122
    s_cmp_lt_u32 s13, 16
    s_cbranch_scc0 CH_wao2120
    s_mov_b32 s16, 0
    s_mov_b32 s17, s13
    s_branch CH_watt121
CH_wao2120:
    s_sub_u32 s13, s13, 16
    s_mul_hi_u32 s16, s13, 178956971
    s_mul_i32 s17, s16, 24
    s_sub_u32 s17, s13, s17
    s_add_u32 s16, s16, 1
    s_cmp_lt_u32 s17, 16
    s_cbranch_scc1 CH_watt121
    s_sub_u32 s10, s17, 16
    s_sub_u32 s9, s16, 1
    s_branch CH_wout119
CH_wr2122:
    s_sub_u32 s13, s13, 688
    s_cmp_ge_u32 s13, 8
    s_cbranch_scc1 CH_r2n128
    s_mov_b32 s9, 58
    s_mov_b32 s17, s13
    s_branch CH_wattseg124
CH_r2n128:
    s_sub_u32 s13, s13, 8
    s_cmp_ge_u32 s13, 8
    s_cbranch_scc1 CH_r2n129
    s_mov_b32 s9, 59
    s_mov_b32 s17, s13
    s_branch CH_wattseg124
CH_r2n129:
    s_sub_u32 s13, s13, 8
    s_cmp_ge_u32 s13, 8
    s_cbranch_scc1 CH_r2n130
    s_mov_b32 s9, 28
    s_mov_b32 s10, s13
    s_branch CH_wout119
CH_r2n130:
    s_sub_u32 s13, s13, 8
    s_cmp_ge_u32 s13, 8
    s_cbranch_scc1 CH_r2n131
    s_mov_b32 s9, 60
    s_mov_b32 s17, s13
    s_branch CH_wattseg124
CH_r2n131:
    s_sub_u32 s13, s13, 8
    s_cmp_ge_u32 s13, 20
    s_cbranch_scc1 CH_r2n132
    s_mov_b32 s9, 58
    s_mov_b32 s11, s13
    s_branch CH_wmed125
CH_r2n132:
    s_sub_u32 s13, s13, 20
    s_cmp_ge_u32 s13, 8
    s_cbranch_scc1 CH_r2n133
    s_mov_b32 s9, 61
    s_mov_b32 s17, s13
    s_branch CH_wattseg124
CH_r2n133:
    s_sub_u32 s13, s13, 8
    s_cmp_ge_u32 s13, 20
    s_cbranch_scc1 CH_r2n134
    s_mov_b32 s9, 59
    s_mov_b32 s11, s13
    s_branch CH_wmed125
CH_r2n134:
    s_sub_u32 s13, s13, 20
    s_cmp_ge_u32 s13, 8
    s_cbranch_scc1 CH_r2n135
    s_mov_b32 s9, 62
    s_mov_b32 s17, s13
    s_branch CH_wattseg124
CH_r2n135:
    s_sub_u32 s13, s13, 8
    s_cmp_ge_u32 s13, 20
    s_cbranch_scc1 CH_r2n136
    s_mov_b32 s9, 60
    s_mov_b32 s11, s13
    s_branch CH_wmed125
CH_r2n136:
    s_sub_u32 s13, s13, 20
    s_cmp_ge_u32 s13, 8
    s_cbranch_scc1 CH_r2n137
    s_mov_b32 s9, 63
    s_mov_b32 s17, s13
    s_branch CH_wattseg124
CH_r2n137:
    s_sub_u32 s13, s13, 8
    s_cmp_ge_u32 s13, 20
    s_cbranch_scc1 CH_r2n138
    s_mov_b32 s9, 61
    s_mov_b32 s11, s13
    s_branch CH_wmed125
CH_r2n138:
    s_sub_u32 s13, s13, 20
    s_cmp_ge_u32 s13, 40
    s_cbranch_scc1 CH_r2n139
    s_mov_b32 s9, 62
    s_and_b32 s10, s13, 1
    s_lshr_b32 s11, s13, 1
    s_branch CH_wfine126
CH_r2n139:
    s_sub_u32 s13, s13, 40
    s_cmp_ge_u32 s13, 40
    s_cbranch_scc1 CH_r2n140
    s_mov_b32 s9, 63
    s_and_b32 s10, s13, 1
    s_lshr_b32 s11, s13, 1
    s_branch CH_wfine126
CH_r2n140:
    s_sub_u32 s13, s13, 40
    s_branch CH_end
CH_wfine126:
    s_sub_u32 s45, s9, 29
    s_cmp_lg_u32 s8, 0
    s_cbranch_scc1 CH_cl_nw141
    s_mov_b64 exec, 1
    s_and_b32 s47, s101, 3
    s_mov_b32 s49, 0
CH_cl_lp142:
    s_lshl_b32 s46, s45, 4
    s_lshl_b32 s50, s47, 2
    s_add_u32 s46, s46, s50
    s_add_u32 s46, s46, 85997824
    v_mov_b32 v2, s46
    v_mov_b32 v3, 1
    buffer_atomic_add v3, v2, s[4:7], 0 offen sc0
    s_waitcnt vmcnt(0)
    s_nop 0
    v_readfirstlane_b32 s46, v3
    s_nop 3
    s_cmp_lt_u32 s46, 10
    s_cbranch_scc1 CH_cl_ok143
    s_add_u32 s47, s47, 1
    s_and_b32 s47, s47, 3
    s_add_u32 s49, s49, 1
    s_cmp_lt_u32 s49, 4
    s_cbranch_scc1 CH_cl_lp142
    s_mov_b32 s46, 0
CH_cl_ok143:
    s_mul_i32 s47, s47, 10
    s_add_u32 s46, s46, s47
    v_mov_b32 v2, 143300
    v_mov_b32 v3, s46
    ds_write_b32 v2, v3
    s_waitcnt lgkmcnt(0)
    s_mov_b64 exec, -1
CH_cl_nw141:
    s_barrier
    v_mov_b32 v2, 143300
    ds_read_b32 v3, v2
    s_waitcnt lgkmcnt(0)
    s_nop 0
    v_readfirstlane_b32 s46, v3
    s_nop 3
    s_barrier
    s_and_b32 s10, s46, 1
    s_lshr_b32 s11, s46, 1
    v_mov_b32 v2, 85997568
    v_mov_b32 v3, 32
    s_mov_b64 exec, 1
    s_mov_b32 s40, 0
CH_wf144:
    buffer_load_dword v9, v2, s[4:7], 0 offen sc1
    s_waitcnt vmcnt(0)
    v_cmp_lt_u32 vcc, v9, v3
    s_cbranch_vccz CH_wfok145
    s_sleep 16
    s_add_u32 s40, s40, 1
    s_cmp_lt_u32 s40, 174762
    s_cbranch_scc1 CH_wf144
    s_endpgm
CH_wfok145:
    s_mov_b64 exec, -1
    s_load_dwordx2 s[28:29], s[0:1], 128
    v_lshlrev_b32 v2, 4, v1
    s_lshl_b32 s12, s11, 18
    s_lshl_b32 s13, s8, 15
    s_add_u32 s12, s12, s13
    s_add_u32 s12, s12, 88080384
    s_waitcnt lgkmcnt(0)
    s_mov_b32 s20, s28
    s_and_b32 s21, s29, 0xffff
    s_mov_b32 s22, 5242880
    s_mov_b32 s23, 0x20000
    s_add_u32 s16, s12, 0
    buffer_load_dwordx4 a[0:3], v2, s[4:7], s16 offen offset:0
    buffer_load_dwordx4 a[4:7], v2, s[4:7], s16 offen offset:1024
    buffer_load_dwordx4 a[8:11], v2, s[4:7], s16 offen offset:2048
    buffer_load_dwordx4 a[12:15], v2, s[4:7], s16 offen offset:3072
    s_add_u32 s16, s12, 4096
    buffer_load_dwordx4 a[16:19], v2, s[4:7], s16 offen offset:0
    buffer_load_dwordx4 a[20:23], v2, s[4:7], s16 offen offset:1024
    buffer_load_dwordx4 a[24:27], v2, s[4:7], s16 offen offset:2048
    buffer_load_dwordx4 a[28:31], v2, s[4:7], s16 offen offset:3072
    s_add_u32 s16, s12, 8192
    buffer_load_dwordx4 a[32:35], v2, s[4:7], s16 offen offset:0
    buffer_load_dwordx4 a[36:39], v2, s[4:7], s16 offen offset:1024
    buffer_load_dwordx4 a[40:43], v2, s[4:7], s16 offen offset:2048
    buffer_load_dwordx4 a[44:47], v2, s[4:7], s16 offen offset:3072
    s_add_u32 s16, s12, 12288
    buffer_load_dwordx4 a[48:51], v2, s[4:7], s16 offen offset:0
    buffer_load_dwordx4 a[52:55], v2, s[4:7], s16 offen offset:1024
    buffer_load_dwordx4 a[56:59], v2, s[4:7], s16 offen offset:2048
    buffer_load_dwordx4 a[60:63], v2, s[4:7], s16 offen offset:3072
    s_add_u32 s16, s12, 16384
    buffer_load_dwordx4 a[64:67], v2, s[4:7], s16 offen offset:0
    buffer_load_dwordx4 a[68:71], v2, s[4:7], s16 offen offset:1024
    buffer_load_dwordx4 a[72:75], v2, s[4:7], s16 offen offset:2048
    buffer_load_dwordx4 a[76:79], v2, s[4:7], s16 offen offset:3072
    s_add_u32 s16, s12, 20480
    buffer_load_dwordx4 a[80:83], v2, s[4:7], s16 offen offset:0
    buffer_load_dwordx4 a[84:87], v2, s[4:7], s16 offen offset:1024
    buffer_load_dwordx4 a[88:91], v2, s[4:7], s16 offen offset:2048
    buffer_load_dwordx4 a[92:95], v2, s[4:7], s16 offen offset:3072
    s_add_u32 s16, s12, 24576
    buffer_load_dwordx4 a[96:99], v2, s[4:7], s16 offen offset:0
    buffer_load_dwordx4 a[100:103], v2, s[4:7], s16 offen offset:1024
    buffer_load_dwordx4 a[104:107], v2, s[4:7], s16 offen offset:2048
    buffer_load_dwordx4 a[108:111], v2, s[4:7], s16 offen offset:3072
    s_add_u32 s16, s12, 28672
    buffer_load_dwordx4 a[112:115], v2, s[4:7], s16 offen offset:0
    buffer_load_dwordx4 a[116:119], v2, s[4:7], s16 offen offset:1024
    buffer_load_dwordx4 a[120:123], v2, s[4:7], s16 offen offset:2048
    buffer_load_dwordx4 a[124:127], v2, s[4:7], s16 offen offset:3072
    s_waitcnt vmcnt(16)
    s_add_u32 s16, s12, 131072
    buffer_load_dwordx4 a[128:131], v2, s[4:7], s16 offen offset:0
    buffer_load_dwordx4 a[132:135], v2, s[4:7], s16 offen offset:1024
    buffer_load_dwordx4 a[136:139], v2, s[4:7], s16 offen offset:2048
    buffer_load_dwordx4 a[140:143], v2, s[4:7], s16 offen offset:3072
    s_add_u32 s16, s12, 135168
    buffer_load_dwordx4 a[144:147], v2, s[4:7], s16 offen offset:0
    buffer_load_dwordx4 a[148:151], v2, s[4:7], s16 offen offset:1024
    buffer_load_dwordx4 a[152:155], v2, s[4:7], s16 offen offset:2048
    buffer_load_dwordx4 a[156:159], v2, s[4:7], s16 offen offset:3072
    s_add_u32 s16, s12, 139264
    buffer_load_dwordx4 a[160:163], v2, s[4:7], s16 offen offset:0
    buffer_load_dwordx4 a[164:167], v2, s[4:7], s16 offen offset:1024
    buffer_load_dwordx4 a[168:171], v2, s[4:7], s16 offen offset:2048
    buffer_load_dwordx4 a[172:175], v2, s[4:7], s16 offen offset:3072
    s_add_u32 s16, s12, 143360
    buffer_load_dwordx4 a[176:179], v2, s[4:7], s16 offen offset:0
    buffer_load_dwordx4 a[180:183], v2, s[4:7], s16 offen offset:1024
    buffer_load_dwordx4 a[184:187], v2, s[4:7], s16 offen offset:2048
    buffer_load_dwordx4 a[188:191], v2, s[4:7], s16 offen offset:3072
    s_add_u32 s16, s12, 147456
    buffer_load_dwordx4 a[192:195], v2, s[4:7], s16 offen offset:0
    buffer_load_dwordx4 a[196:199], v2, s[4:7], s16 offen offset:1024
    buffer_load_dwordx4 a[200:203], v2, s[4:7], s16 offen offset:2048
    buffer_load_dwordx4 a[204:207], v2, s[4:7], s16 offen offset:3072
    s_add_u32 s16, s12, 151552
    buffer_load_dwordx4 a[208:211], v2, s[4:7], s16 offen offset:0
    buffer_load_dwordx4 a[212:215], v2, s[4:7], s16 offen offset:1024
    buffer_load_dwordx4 a[216:219], v2, s[4:7], s16 offen offset:2048
    buffer_load_dwordx4 a[220:223], v2, s[4:7], s16 offen offset:3072
    s_add_u32 s16, s12, 155648
    buffer_load_dwordx4 a[224:227], v2, s[4:7], s16 offen offset:0
    buffer_load_dwordx4 a[228:231], v2, s[4:7], s16 offen offset:1024
    buffer_load_dwordx4 a[232:235], v2, s[4:7], s16 offen offset:2048
    buffer_load_dwordx4 a[236:239], v2, s[4:7], s16 offen offset:3072
    s_add_u32 s16, s12, 159744
    buffer_load_dwordx4 a[240:243], v2, s[4:7], s16 offen offset:0
    buffer_load_dwordx4 a[244:247], v2, s[4:7], s16 offen offset:1024
    buffer_load_dwordx4 a[248:251], v2, s[4:7], s16 offen offset:2048
    buffer_load_dwordx4 a[252:255], v2, s[4:7], s16 offen offset:3072
    s_lshl_b32 s16, s9, 5
    s_add_u32 s16, s16, 85995520
    v_mov_b32 v4, s16
    v_mov_b32 v6, 85997568
    v_cmp_eq_u32 vcc, 1, v1
    s_nop 1
    v_cndmask_b32 v4, v4, v6, vcc
    v_mov_b32 v5, 8
    s_mov_b64 exec, 1
    s_mov_b32 s40, 0
CH_wf146:
    buffer_load_dword v7, v4, s[4:7], 0 offen sc1
    s_waitcnt vmcnt(0)
    v_cmp_lt_u32 vcc, v7, v5
    s_cbranch_vccz CH_wfok147
    s_cmp_ge_u32 s9, 63
    s_cbranch_scc1 CH_wf146_f
    s_sleep 8
CH_wf146_f:
    s_sleep 2
    s_add_u32 s40, s40, 1
    s_cmp_lt_u32 s40, 262144
    s_cbranch_scc1 CH_wf146
    s_endpgm
CH_wfok147:
    s_mov_b64 exec, -1
    s_lshl_b32 s13, s8, 22
    s_lshl_b32 s16, s9, 13
    s_add_u32 s13, s13, s16
    s_lshl_b32 s16, s10, 12
    s_add_u32 s13, s13, s16
    s_add_u32 s13, s13, 50331648
    s_mov_b32 s14, s13
    s_add_u32 s16, s13, 0
    buffer_load_dwordx4 v[64:67], v2, s[4:7], s16 offen offset:0
    buffer_load_dwordx4 v[68:71], v2, s[4:7], s16 offen offset:1024
    buffer_load_dwordx4 v[72:75], v2, s[4:7], s16 offen offset:2048
    buffer_load_dwordx4 v[76:79], v2, s[4:7], s16 offen offset:3072
    s_add_u32 s16, s13, 524288
    buffer_load_dwordx4 v[80:83], v2, s[4:7], s16 offen offset:0
    buffer_load_dwordx4 v[84:87], v2, s[4:7], s16 offen offset:1024
    buffer_load_dwordx4 v[88:91], v2, s[4:7], s16 offen offset:2048
    buffer_load_dwordx4 v[92:95], v2, s[4:7], s16 offen offset:3072
    s_add_u32 s16, s14, 1048576
    buffer_load_dwordx4 v[96:99], v2, s[4:7], s16 offen offset:0
    buffer_load_dwordx4 v[100:103], v2, s[4:7], s16 offen offset:1024
    buffer_load_dwordx4 v[104:107], v2, s[4:7], s16 offen offset:2048
    buffer_load_dwordx4 v[108:111], v2, s[4:7], s16 offen offset:3072
    s_add_u32 s16, s14, 1572864
    buffer_load_dwordx4 v[112:115], v2, s[4:7], s16 offen offset:0
    buffer_load_dwordx4 v[116:119], v2, s[4:7], s16 offen offset:1024
    buffer_load_dwordx4 v[120:123], v2, s[4:7], s16 offen offset:2048
    buffer_load_dwordx4 v[124:127], v2, s[4:7], s16 offen offset:3072
    s_add_u32 s16, s13, 2097152
    buffer_load_dwordx4 v[128:131], v2, s[4:7], s16 offen offset:0
    buffer_load_dwordx4 v[132:135], v2, s[4:7], s16 offen offset:1024
    buffer_load_dwordx4 v[136:139], v2, s[4:7], s16 offen offset:2048
    buffer_load_dwordx4 v[140:143], v2, s[4:7], s16 offen offset:3072
    s_add_u32 s16, s13, 2621440
    buffer_load_dwordx4 v[144:147], v2, s[4:7], s16 offen offset:0
    buffer_load_dwordx4 v[148:151], v2, s[4:7], s16 offen offset:1024
    buffer_load_dwordx4 v[152:155], v2, s[4:7], s16 offen offset:2048
    buffer_load_dwordx4 v[156:159], v2, s[4:7], s16 offen offset:3072
    s_add_u32 s16, s14, 3145728
    buffer_load_dwordx4 v[160:163], v2, s[4:7], s16 offen offset:0
    buffer_load_dwordx4 v[164:167], v2, s[4:7], s16 offen offset:1024
    buffer_load_dwordx4 v[168:171], v2, s[4:7], s16 offen offset:2048
    buffer_load_dwordx4 v[172:175], v2, s[4:7], s16 offen offset:3072
    s_add_u32 s16, s14, 3670016
    buffer_load_dwordx4 v[176:179], v2, s[4:7], s16 offen offset:0
    buffer_load_dwordx4 v[180:183], v2, s[4:7], s16 offen offset:1024
    buffer_load_dwordx4 v[184:187], v2, s[4:7], s16 offen offset:2048
    buffer_load_dwordx4 v[188:191], v2, s[4:7], s16 offen offset:3072
    s_waitcnt vmcnt(28)
    v_mfma_f32_16x16x32_bf16 v[16:19], a[0:3], v[64:67], 0
    v_mfma_f32_16x16x32_bf16 v[20:23], a[128:131], v[64:67], 0
    v_mfma_f32_16x16x32_bf16 v[16:19], a[4:7], v[68:71], v[16:19]
    v_mfma_f32_16x16x32_bf16 v[20:23], a[132:135], v[68:71], v[20:23]
    v_mfma_f32_16x16x32_bf16 v[16:19], a[8:11], v[72:75], v[16:19]
    v_mfma_f32_16x16x32_bf16 v[20:23], a[136:139], v[72:75], v[20:23]
    v_mfma_f32_16x16x32_bf16 v[16:19], a[12:15], v[76:79], v[16:19]
    v_mfma_f32_16x16x32_bf16 v[20:23], a[140:143], v[76:79], v[20:23]
    s_waitcnt vmcnt(24)
    v_mfma_f32_16x16x32_bf16 v[16:19], a[16:19], v[80:83], v[16:19]
    v_mfma_f32_16x16x32_bf16 v[20:23], a[144:147], v[80:83], v[20:23]
    v_mfma_f32_16x16x32_bf16 v[16:19], a[20:23], v[84:87], v[16:19]
    v_mfma_f32_16x16x32_bf16 v[20:23], a[148:151], v[84:87], v[20:23]
    v_mfma_f32_16x16x32_bf16 v[16:19], a[24:27], v[88:91], v[16:19]
    v_mfma_f32_16x16x32_bf16 v[20:23], a[152:155], v[88:91], v[20:23]
    v_mfma_f32_16x16x32_bf16 v[16:19], a[28:31], v[92:95], v[16:19]
    v_mfma_f32_16x16x32_bf16 v[20:23], a[156:159], v[92:95], v[20:23]
    s_waitcnt vmcnt(20)
    v_mfma_f32_16x16x32_bf16 v[16:19], a[32:35], v[96:99], v[16:19]
    v_mfma_f32_16x16x32_bf16 v[20:23], a[160:163], v[96:99], v[20:23]
    v_mfma_f32_16x16x32_bf16 v[16:19], a[36:39], v[100:103], v[16:19]
    v_mfma_f32_16x16x32_bf16 v[20:23], a[164:167], v[100:103], v[20:23]
    v_mfma_f32_16x16x32_bf16 v[16:19], a[40:43], v[104:107], v[16:19]
    v_mfma_f32_16x16x32_bf16 v[20:23], a[168:171], v[104:107], v[20:23]
    v_mfma_f32_16x16x32_bf16 v[16:19], a[44:47], v[108:111], v[16:19]
    v_mfma_f32_16x16x32_bf16 v[20:23], a[172:175], v[108:111], v[20:23]
    s_waitcnt vmcnt(16)
    v_mfma_f32_16x16x32_bf16 v[16:19], a[48:51], v[112:115], v[16:19]
    v_mfma_f32_16x16x32_bf16 v[20:23], a[176:179], v[112:115], v[20:23]
    v_mfma_f32_16x16x32_bf16 v[16:19], a[52:55], v[116:119], v[16:19]
    v_mfma_f32_16x16x32_bf16 v[20:23], a[180:183], v[116:119], v[20:23]
    v_mfma_f32_16x16x32_bf16 v[16:19], a[56:59], v[120:123], v[16:19]
    v_mfma_f32_16x16x32_bf16 v[20:23], a[184:187], v[120:123], v[20:23]
    v_mfma_f32_16x16x32_bf16 v[16:19], a[60:63], v[124:127], v[16:19]
    v_mfma_f32_16x16x32_bf16 v[20:23], a[188:191], v[124:127], v[20:23]
    s_waitcnt vmcnt(12)
    v_mfma_f32_16x16x32_bf16 v[16:19], a[64:67], v[128:131], v[16:19]
    v_mfma_f32_16x16x32_bf16 v[20:23], a[192:195], v[128:131], v[20:23]
    v_mfma_f32_16x16x32_bf16 v[16:19], a[68:71], v[132:135], v[16:19]
    v_mfma_f32_16x16x32_bf16 v[20:23], a[196:199], v[132:135], v[20:23]
    v_mfma_f32_16x16x32_bf16 v[16:19], a[72:75], v[136:139], v[16:19]
    v_mfma_f32_16x16x32_bf16 v[20:23], a[200:203], v[136:139], v[20:23]
    v_mfma_f32_16x16x32_bf16 v[16:19], a[76:79], v[140:143], v[16:19]
    v_mfma_f32_16x16x32_bf16 v[20:23], a[204:207], v[140:143], v[20:23]
    s_waitcnt vmcnt(8)
    v_mfma_f32_16x16x32_bf16 v[16:19], a[80:83], v[144:147], v[16:19]
    v_mfma_f32_16x16x32_bf16 v[20:23], a[208:211], v[144:147], v[20:23]
    v_mfma_f32_16x16x32_bf16 v[16:19], a[84:87], v[148:151], v[16:19]
    v_mfma_f32_16x16x32_bf16 v[20:23], a[212:215], v[148:151], v[20:23]
    v_mfma_f32_16x16x32_bf16 v[16:19], a[88:91], v[152:155], v[16:19]
    v_mfma_f32_16x16x32_bf16 v[20:23], a[216:219], v[152:155], v[20:23]
    v_mfma_f32_16x16x32_bf16 v[16:19], a[92:95], v[156:159], v[16:19]
    v_mfma_f32_16x16x32_bf16 v[20:23], a[220:223], v[156:159], v[20:23]
    s_waitcnt vmcnt(4)
    v_mfma_f32_16x16x32_bf16 v[16:19], a[96:99], v[160:163], v[16:19]
    v_mfma_f32_16x16x32_bf16 v[20:23], a[224:227], v[160:163], v[20:23]
    v_mfma_f32_16x16x32_bf16 v[16:19], a[100:103], v[164:167], v[16:19]
    v_mfma_f32_16x16x32_bf16 v[20:23], a[228:231], v[164:167], v[20:23]
    v_mfma_f32_16x16x32_bf16 v[16:19], a[104:107], v[168:171], v[16:19]
    v_mfma_f32_16x16x32_bf16 v[20:23], a[232:235], v[168:171], v[20:23]
    v_mfma_f32_16x16x32_bf16 v[16:19], a[108:111], v[172:175], v[16:19]
    v_mfma_f32_16x16x32_bf16 v[20:23], a[236:239], v[172:175], v[20:23]
    s_waitcnt vmcnt(0)
    v_mfma_f32_16x16x32_bf16 v[16:19], a[112:115], v[176:179], v[16:19]
    v_mfma_f32_16x16x32_bf16 v[20:23], a[240:243], v[176:179], v[20:23]
    v_mfma_f32_16x16x32_bf16 v[16:19], a[116:119], v[180:183], v[16:19]
    v_mfma_f32_16x16x32_bf16 v[20:23], a[244:247], v[180:183], v[20:23]
    v_mfma_f32_16x16x32_bf16 v[16:19], a[120:123], v[184:187], v[16:19]
    v_mfma_f32_16x16x32_bf16 v[20:23], a[248:251], v[184:187], v[20:23]
    v_mfma_f32_16x16x32_bf16 v[16:19], a[124:127], v[188:191], v[16:19]
    v_mfma_f32_16x16x32_bf16 v[20:23], a[252:255], v[188:191], v[20:23]
    s_nop 7
    s_lshl_b32 s16, s8, 11
    v_add_u32 v3, s16, v2
    ds_write_b128 v3, v[16:19]
    ds_write_b128 v3, v[20:23] offset:1024
    s_waitcnt lgkmcnt(0)
    s_barrier
    s_cmp_ge_u32 s8, 2
    s_cbranch_scc1 CH_os148
    s_lshl_b32 s16, s8, 10
    v_add_u32 v3, s16, v2
    ds_read_b128 v[16:19], v3
    ds_read_b128 v[20:23], v3 offset:2048
    ds_read_b128 v[24:27], v3 offset:4096
    ds_read_b128 v[28:31], v3 offset:6144
    v_and_b32 v5, 15, v1
    v_mul_u32_u24 v5, 2560, v5
    v_lshrrev_b32 v6, 4, v1
    v_lshlrev_b32 v6, 3, v6
    v_add_u32 v5, v5, v6
    s_lshl_b32 s15, s9, 5
    s_lshl_b32 s16, s10, 4
    s_add_u32 s15, s15, s16
    s_mul_i32 s15, s15, 2560
    s_lshl_b32 s16, s11, 6
    s_add_u32 s15, s15, s16
    s_lshl_b32 s16, s8, 5
    s_add_u32 s15, s15, s16
    s_add_u32 s15, s15, 1280
    s_waitcnt lgkmcnt(0)
    v_add_f32 v16, v16, v20
    v_add_f32 v24, v24, v28
    v_add_f32 v17, v17, v21
    v_add_f32 v25, v25, v29
    v_add_f32 v18, v18, v22
    v_add_f32 v26, v26, v30
    v_add_f32 v19, v19, v23
    v_add_f32 v27, v27, v31
    v_add_f32 v16, v16, v24
    v_add_f32 v17, v17, v25
    v_add_f32 v18, v18, v26
    v_add_f32 v19, v19, v27
    v_cvt_pk_bf16_f32 v16, v16, v17
    v_cvt_pk_bf16_f32 v17, v18, v19
    buffer_store_dwordx2 v[16:17], v5, s[20:23], s15 offen
CH_os148:
    s_barrier
    s_branch CH_wtop86
CH_wmed125:
    s_sub_u32 s45, s9, 29
    s_cmp_lg_u32 s8, 0
    s_cbranch_scc1 CH_cl_nw149
    s_mov_b64 exec, 1
    s_and_b32 s47, s101, 3
    s_mov_b32 s49, 0
CH_cl_lp150:
    s_lshl_b32 s46, s45, 4
    s_lshl_b32 s50, s47, 2
    s_add_u32 s46, s46, s50
    s_add_u32 s46, s46, 85997824
    v_mov_b32 v2, s46
    v_mov_b32 v3, 1
    buffer_atomic_add v3, v2, s[4:7], 0 offen sc0
    s_waitcnt vmcnt(0)
    s_nop 0
    v_readfirstlane_b32 s46, v3
    s_nop 3
    s_cmp_lt_u32 s46, 5
    s_cbranch_scc1 CH_cl_ok151
    s_add_u32 s47, s47, 1
    s_and_b32 s47, s47, 3
    s_add_u32 s49, s49, 1
    s_cmp_lt_u32 s49, 4
    s_cbranch_scc1 CH_cl_lp150
    s_mov_b32 s46, 0
CH_cl_ok151:
    s_mul_i32 s47, s47, 5
    s_add_u32 s46, s46, s47
    v_mov_b32 v2, 143300
    v_mov_b32 v3, s46
    ds_write_b32 v2, v3
    s_waitcnt lgkmcnt(0)
    s_mov_b64 exec, -1
CH_cl_nw149:
    s_barrier
    v_mov_b32 v2, 143300
    ds_read_b32 v3, v2
    s_waitcnt lgkmcnt(0)
    s_nop 0
    v_readfirstlane_b32 s46, v3
    s_nop 3
    s_barrier
    s_mov_b32 s11, s46
    v_mov_b32 v2, 85997568
    v_mov_b32 v3, 32
    s_mov_b64 exec, 1
    s_mov_b32 s40, 0
CH_wf152:
    buffer_load_dword v9, v2, s[4:7], 0 offen sc1
    s_waitcnt vmcnt(0)
    v_cmp_lt_u32 vcc, v9, v3
    s_cbranch_vccz CH_wfok153
    s_sleep 16
    s_add_u32 s40, s40, 1
    s_cmp_lt_u32 s40, 174762
    s_cbranch_scc1 CH_wf152
    s_endpgm
CH_wfok153:
    s_mov_b64 exec, -1
    s_load_dwordx2 s[28:29], s[0:1], 128
    v_lshlrev_b32 v2, 4, v1
    s_lshl_b32 s12, s11, 18
    s_lshl_b32 s13, s8, 15
    s_add_u32 s12, s12, s13
    s_add_u32 s12, s12, 88080384
    s_waitcnt lgkmcnt(0)
    s_mov_b32 s20, s28
    s_and_b32 s21, s29, 0xffff
    s_mov_b32 s22, 5242880
    s_mov_b32 s23, 0x20000
    s_add_u32 s16, s12, 0
    buffer_load_dwordx4 a[0:3], v2, s[4:7], s16 offen offset:0
    buffer_load_dwordx4 a[4:7], v2, s[4:7], s16 offen offset:1024
    buffer_load_dwordx4 a[8:11], v2, s[4:7], s16 offen offset:2048
    buffer_load_dwordx4 a[12:15], v2, s[4:7], s16 offen offset:3072
    s_add_u32 s16, s12, 4096
    buffer_load_dwordx4 a[16:19], v2, s[4:7], s16 offen offset:0
    buffer_load_dwordx4 a[20:23], v2, s[4:7], s16 offen offset:1024
    buffer_load_dwordx4 a[24:27], v2, s[4:7], s16 offen offset:2048
    buffer_load_dwordx4 a[28:31], v2, s[4:7], s16 offen offset:3072
    s_add_u32 s16, s12, 8192
    buffer_load_dwordx4 a[32:35], v2, s[4:7], s16 offen offset:0
    buffer_load_dwordx4 a[36:39], v2, s[4:7], s16 offen offset:1024
    buffer_load_dwordx4 a[40:43], v2, s[4:7], s16 offen offset:2048
    buffer_load_dwordx4 a[44:47], v2, s[4:7], s16 offen offset:3072
    s_add_u32 s16, s12, 12288
    buffer_load_dwordx4 a[48:51], v2, s[4:7], s16 offen offset:0
    buffer_load_dwordx4 a[52:55], v2, s[4:7], s16 offen offset:1024
    buffer_load_dwordx4 a[56:59], v2, s[4:7], s16 offen offset:2048
    buffer_load_dwordx4 a[60:63], v2, s[4:7], s16 offen offset:3072
    s_add_u32 s16, s12, 16384
    buffer_load_dwordx4 a[64:67], v2, s[4:7], s16 offen offset:0
    buffer_load_dwordx4 a[68:71], v2, s[4:7], s16 offen offset:1024
    buffer_load_dwordx4 a[72:75], v2, s[4:7], s16 offen offset:2048
    buffer_load_dwordx4 a[76:79], v2, s[4:7], s16 offen offset:3072
    s_add_u32 s16, s12, 20480
    buffer_load_dwordx4 a[80:83], v2, s[4:7], s16 offen offset:0
    buffer_load_dwordx4 a[84:87], v2, s[4:7], s16 offen offset:1024
    buffer_load_dwordx4 a[88:91], v2, s[4:7], s16 offen offset:2048
    buffer_load_dwordx4 a[92:95], v2, s[4:7], s16 offen offset:3072
    s_add_u32 s16, s12, 24576
    buffer_load_dwordx4 a[96:99], v2, s[4:7], s16 offen offset:0
    buffer_load_dwordx4 a[100:103], v2, s[4:7], s16 offen offset:1024
    buffer_load_dwordx4 a[104:107], v2, s[4:7], s16 offen offset:2048
    buffer_load_dwordx4 a[108:111], v2, s[4:7], s16 offen offset:3072
    s_add_u32 s16, s12, 28672
    buffer_load_dwordx4 a[112:115], v2, s[4:7], s16 offen offset:0
    buffer_load_dwordx4 a[116:119], v2, s[4:7], s16 offen offset:1024
    buffer_load_dwordx4 a[120:123], v2, s[4:7], s16 offen offset:2048
    buffer_load_dwordx4 a[124:127], v2, s[4:7], s16 offen offset:3072
    s_waitcnt vmcnt(16)
    s_add_u32 s16, s12, 131072
    buffer_load_dwordx4 a[128:131], v2, s[4:7], s16 offen offset:0
    buffer_load_dwordx4 a[132:135], v2, s[4:7], s16 offen offset:1024
    buffer_load_dwordx4 a[136:139], v2, s[4:7], s16 offen offset:2048
    buffer_load_dwordx4 a[140:143], v2, s[4:7], s16 offen offset:3072
    s_add_u32 s16, s12, 135168
    buffer_load_dwordx4 a[144:147], v2, s[4:7], s16 offen offset:0
    buffer_load_dwordx4 a[148:151], v2, s[4:7], s16 offen offset:1024
    buffer_load_dwordx4 a[152:155], v2, s[4:7], s16 offen offset:2048
    buffer_load_dwordx4 a[156:159], v2, s[4:7], s16 offen offset:3072
    s_add_u32 s16, s12, 139264
    buffer_load_dwordx4 a[160:163], v2, s[4:7], s16 offen offset:0
    buffer_load_dwordx4 a[164:167], v2, s[4:7], s16 offen offset:1024
    buffer_load_dwordx4 a[168:171], v2, s[4:7], s16 offen offset:2048
    buffer_load_dwordx4 a[172:175], v2, s[4:7], s16 offen offset:3072
    s_add_u32 s16, s12, 143360
    buffer_load_dwordx4 a[176:179], v2, s[4:7], s16 offen offset:0
    buffer_load_dwordx4 a[180:183], v2, s[4:7], s16 offen offset:1024
    buffer_load_dwordx4 a[184:187], v2, s[4:7], s16 offen offset:2048
    buffer_load_dwordx4 a[188:191], v2, s[4:7], s16 offen offset:3072
    s_add_u32 s16, s12, 147456
    buffer_load_dwordx4 a[192:195], v2, s[4:7], s16 offen offset:0
    buffer_load_dwordx4 a[196:199], v2, s[4:7], s16 offen offset:1024
    buffer_load_dwordx4 a[200:203], v2, s[4:7], s16 offen offset:2048
    buffer_load_dwordx4 a[204:207], v2, s[4:7], s16 offen offset:3072
    s_add_u32 s16, s12, 151552
    buffer_load_dwordx4 a[208:211], v2, s[4:7], s16 offen offset:0
    buffer_load_dwordx4 a[212:215], v2, s[4:7], s16 offen offset:1024
    buffer_load_dwordx4 a[216:219], v2, s[4:7], s16 offen offset:2048
    buffer_load_dwordx4 a[220:223], v2, s[4:7], s16 offen offset:3072
    s_add_u32 s16, s12, 155648
    buffer_load_dwordx4 a[224:227], v2, s[4:7], s16 offen offset:0
    buffer_load_dwordx4 a[228:231], v2, s[4:7], s16 offen offset:1024
    buffer_load_dwordx4 a[232:235], v2, s[4:7], s16 offen offset:2048
    buffer_load_dwordx4 a[236:239], v2, s[4:7], s16 offen offset:3072
    s_add_u32 s16, s12, 159744
    buffer_load_dwordx4 a[240:243], v2, s[4:7], s16 offen offset:0
    buffer_load_dwordx4 a[244:247], v2, s[4:7], s16 offen offset:1024
    buffer_load_dwordx4 a[248:251], v2, s[4:7], s16 offen offset:2048
    buffer_load_dwordx4 a[252:255], v2, s[4:7], s16 offen offset:3072
    s_lshl_b32 s16, s9, 5
    s_add_u32 s16, s16, 85995520
    v_mov_b32 v4, s16
    v_mov_b32 v6, 85997568
    v_cmp_eq_u32 vcc, 1, v1
    s_nop 1
    v_cndmask_b32 v4, v4, v6, vcc
    v_mov_b32 v5, 8
    s_mov_b64 exec, 1
    s_mov_b32 s40, 0
CH_wf154:
    buffer_load_dword v7, v4, s[4:7], 0 offen sc1
    s_waitcnt vmcnt(0)
    v_cmp_lt_u32 vcc, v7, v5
    s_cbranch_vccz CH_wfok155
    s_cmp_ge_u32 s9, 63
    s_cbranch_scc1 CH_wf154_f
    s_sleep 8
CH_wf154_f:
    s_sleep 2
    s_add_u32 s40, s40, 1
    s_cmp_lt_u32 s40, 262144
    s_cbranch_scc1 CH_wf154
    s_endpgm
CH_wfok155:
    s_mov_b64 exec, -1
    s_mov_b32 s10, 0
    s_lshl_b32 s13, s8, 22
    s_lshl_b32 s16, s9, 13
    s_add_u32 s13, s13, s16
    s_lshl_b32 s16, s10, 12
    s_add_u32 s13, s13, s16
    s_add_u32 s13, s13, 50331648
    s_mov_b32 s14, s13
    s_add_u32 s16, s13, 0
    buffer_load_dwordx4 v[64:67], v2, s[4:7], s16 offen offset:0
    buffer_load_dwordx4 v[68:71], v2, s[4:7], s16 offen offset:1024
    buffer_load_dwordx4 v[72:75], v2, s[4:7], s16 offen offset:2048
    buffer_load_dwordx4 v[76:79], v2, s[4:7], s16 offen offset:3072
    s_add_u32 s16, s13, 524288
    buffer_load_dwordx4 v[80:83], v2, s[4:7], s16 offen offset:0
    buffer_load_dwordx4 v[84:87], v2, s[4:7], s16 offen offset:1024
    buffer_load_dwordx4 v[88:91], v2, s[4:7], s16 offen offset:2048
    buffer_load_dwordx4 v[92:95], v2, s[4:7], s16 offen offset:3072
    s_add_u32 s16, s14, 1048576
    buffer_load_dwordx4 v[96:99], v2, s[4:7], s16 offen offset:0
    buffer_load_dwordx4 v[100:103], v2, s[4:7], s16 offen offset:1024
    buffer_load_dwordx4 v[104:107], v2, s[4:7], s16 offen offset:2048
    buffer_load_dwordx4 v[108:111], v2, s[4:7], s16 offen offset:3072
    s_add_u32 s16, s14, 1572864
    buffer_load_dwordx4 v[112:115], v2, s[4:7], s16 offen offset:0
    buffer_load_dwordx4 v[116:119], v2, s[4:7], s16 offen offset:1024
    buffer_load_dwordx4 v[120:123], v2, s[4:7], s16 offen offset:2048
    buffer_load_dwordx4 v[124:127], v2, s[4:7], s16 offen offset:3072
    s_add_u32 s16, s13, 2097152
    buffer_load_dwordx4 v[128:131], v2, s[4:7], s16 offen offset:0
    buffer_load_dwordx4 v[132:135], v2, s[4:7], s16 offen offset:1024
    buffer_load_dwordx4 v[136:139], v2, s[4:7], s16 offen offset:2048
    buffer_load_dwordx4 v[140:143], v2, s[4:7], s16 offen offset:3072
    s_add_u32 s16, s13, 2621440
    buffer_load_dwordx4 v[144:147], v2, s[4:7], s16 offen offset:0
    buffer_load_dwordx4 v[148:151], v2, s[4:7], s16 offen offset:1024
    buffer_load_dwordx4 v[152:155], v2, s[4:7], s16 offen offset:2048
    buffer_load_dwordx4 v[156:159], v2, s[4:7], s16 offen offset:3072
    s_add_u32 s16, s14, 3145728
    buffer_load_dwordx4 v[160:163], v2, s[4:7], s16 offen offset:0
    buffer_load_dwordx4 v[164:167], v2, s[4:7], s16 offen offset:1024
    buffer_load_dwordx4 v[168:171], v2, s[4:7], s16 offen offset:2048
    buffer_load_dwordx4 v[172:175], v2, s[4:7], s16 offen offset:3072
    s_add_u32 s16, s14, 3670016
    buffer_load_dwordx4 v[176:179], v2, s[4:7], s16 offen offset:0
    buffer_load_dwordx4 v[180:183], v2, s[4:7], s16 offen offset:1024
    buffer_load_dwordx4 v[184:187], v2, s[4:7], s16 offen offset:2048
    buffer_load_dwordx4 v[188:191], v2, s[4:7], s16 offen offset:3072
    s_waitcnt vmcnt(28)
    v_mfma_f32_16x16x32_bf16 v[16:19], a[0:3], v[64:67], 0
    v_mfma_f32_16x16x32_bf16 v[20:23], a[128:131], v[64:67], 0
    v_mfma_f32_16x16x32_bf16 v[16:19], a[4:7], v[68:71], v[16:19]
    v_mfma_f32_16x16x32_bf16 v[20:23], a[132:135], v[68:71], v[20:23]
    v_mfma_f32_16x16x32_bf16 v[16:19], a[8:11], v[72:75], v[16:19]
    v_mfma_f32_16x16x32_bf16 v[20:23], a[136:139], v[72:75], v[20:23]
    v_mfma_f32_16x16x32_bf16 v[16:19], a[12:15], v[76:79], v[16:19]
    v_mfma_f32_16x16x32_bf16 v[20:23], a[140:143], v[76:79], v[20:23]
    s_waitcnt vmcnt(24)
    v_mfma_f32_16x16x32_bf16 v[16:19], a[16:19], v[80:83], v[16:19]
    v_mfma_f32_16x16x32_bf16 v[20:23], a[144:147], v[80:83], v[20:23]
    v_mfma_f32_16x16x32_bf16 v[16:19], a[20:23], v[84:87], v[16:19]
    v_mfma_f32_16x16x32_bf16 v[20:23], a[148:151], v[84:87], v[20:23]
    v_mfma_f32_16x16x32_bf16 v[16:19], a[24:27], v[88:91], v[16:19]
    v_mfma_f32_16x16x32_bf16 v[20:23], a[152:155], v[88:91], v[20:23]
    v_mfma_f32_16x16x32_bf16 v[16:19], a[28:31], v[92:95], v[16:19]
    v_mfma_f32_16x16x32_bf16 v[20:23], a[156:159], v[92:95], v[20:23]
    s_waitcnt vmcnt(20)
    v_mfma_f32_16x16x32_bf16 v[16:19], a[32:35], v[96:99], v[16:19]
    v_mfma_f32_16x16x32_bf16 v[20:23], a[160:163], v[96:99], v[20:23]
    v_mfma_f32_16x16x32_bf16 v[16:19], a[36:39], v[100:103], v[16:19]
    v_mfma_f32_16x16x32_bf16 v[20:23], a[164:167], v[100:103], v[20:23]
    v_mfma_f32_16x16x32_bf16 v[16:19], a[40:43], v[104:107], v[16:19]
    v_mfma_f32_16x16x32_bf16 v[20:23], a[168:171], v[104:107], v[20:23]
    v_mfma_f32_16x16x32_bf16 v[16:19], a[44:47], v[108:111], v[16:19]
    v_mfma_f32_16x16x32_bf16 v[20:23], a[172:175], v[108:111], v[20:23]
    s_waitcnt vmcnt(16)
    v_mfma_f32_16x16x32_bf16 v[16:19], a[48:51], v[112:115], v[16:19]
    v_mfma_f32_16x16x32_bf16 v[20:23], a[176:179], v[112:115], v[20:23]
    v_mfma_f32_16x16x32_bf16 v[16:19], a[52:55], v[116:119], v[16:19]
    v_mfma_f32_16x16x32_bf16 v[20:23], a[180:183], v[116:119], v[20:23]
    v_mfma_f32_16x16x32_bf16 v[16:19], a[56:59], v[120:123], v[16:19]
    v_mfma_f32_16x16x32_bf16 v[20:23], a[184:187], v[120:123], v[20:23]
    v_mfma_f32_16x16x32_bf16 v[16:19], a[60:63], v[124:127], v[16:19]
    v_mfma_f32_16x16x32_bf16 v[20:23], a[188:191], v[124:127], v[20:23]
    s_waitcnt vmcnt(12)
    v_mfma_f32_16x16x32_bf16 v[16:19], a[64:67], v[128:131], v[16:19]
    v_mfma_f32_16x16x32_bf16 v[20:23], a[192:195], v[128:131], v[20:23]
    v_mfma_f32_16x16x32_bf16 v[16:19], a[68:71], v[132:135], v[16:19]
    v_mfma_f32_16x16x32_bf16 v[20:23], a[196:199], v[132:135], v[20:23]
    v_mfma_f32_16x16x32_bf16 v[16:19], a[72:75], v[136:139], v[16:19]
    v_mfma_f32_16x16x32_bf16 v[20:23], a[200:203], v[136:139], v[20:23]
    v_mfma_f32_16x16x32_bf16 v[16:19], a[76:79], v[140:143], v[16:19]
    v_mfma_f32_16x16x32_bf16 v[20:23], a[204:207], v[140:143], v[20:23]
    s_waitcnt vmcnt(8)
    v_mfma_f32_16x16x32_bf16 v[16:19], a[80:83], v[144:147], v[16:19]
    v_mfma_f32_16x16x32_bf16 v[20:23], a[208:211], v[144:147], v[20:23]
    v_mfma_f32_16x16x32_bf16 v[16:19], a[84:87], v[148:151], v[16:19]
    v_mfma_f32_16x16x32_bf16 v[20:23], a[212:215], v[148:151], v[20:23]
    v_mfma_f32_16x16x32_bf16 v[16:19], a[88:91], v[152:155], v[16:19]
    v_mfma_f32_16x16x32_bf16 v[20:23], a[216:219], v[152:155], v[20:23]
    v_mfma_f32_16x16x32_bf16 v[16:19], a[92:95], v[156:159], v[16:19]
    v_mfma_f32_16x16x32_bf16 v[20:23], a[220:223], v[156:159], v[20:23]
    s_waitcnt vmcnt(4)
    v_mfma_f32_16x16x32_bf16 v[16:19], a[96:99], v[160:163], v[16:19]
    v_mfma_f32_16x16x32_bf16 v[20:23], a[224:227], v[160:163], v[20:23]
    v_mfma_f32_16x16x32_bf16 v[16:19], a[100:103], v[164:167], v[16:19]
    v_mfma_f32_16x16x32_bf16 v[20:23], a[228:231], v[164:167], v[20:23]
    v_mfma_f32_16x16x32_bf16 v[16:19], a[104:107], v[168:171], v[16:19]
    v_mfma_f32_16x16x32_bf16 v[20:23], a[232:235], v[168:171], v[20:23]
    v_mfma_f32_16x16x32_bf16 v[16:19], a[108:111], v[172:175], v[16:19]
    v_mfma_f32_16x16x32_bf16 v[20:23], a[236:239], v[172:175], v[20:23]
    s_waitcnt vmcnt(0)
    v_mfma_f32_16x16x32_bf16 v[16:19], a[112:115], v[176:179], v[16:19]
    v_mfma_f32_16x16x32_bf16 v[20:23], a[240:243], v[176:179], v[20:23]
    v_mfma_f32_16x16x32_bf16 v[16:19], a[116:119], v[180:183], v[16:19]
    v_mfma_f32_16x16x32_bf16 v[20:23], a[244:247], v[180:183], v[20:23]
    v_mfma_f32_16x16x32_bf16 v[16:19], a[120:123], v[184:187], v[16:19]
    v_mfma_f32_16x16x32_bf16 v[20:23], a[248:251], v[184:187], v[20:23]
    v_mfma_f32_16x16x32_bf16 v[16:19], a[124:127], v[188:191], v[16:19]
    v_mfma_f32_16x16x32_bf16 v[20:23], a[252:255], v[188:191], v[20:23]
    s_nop 7
    s_lshl_b32 s16, s8, 11
    v_add_u32 v3, s16, v2
    ds_write_b128 v3, v[16:19]
    ds_write_b128 v3, v[20:23] offset:1024
    s_waitcnt lgkmcnt(0)
    s_barrier
    s_cmp_ge_u32 s8, 2
    s_cbranch_scc1 CH_os156
    s_lshl_b32 s16, s8, 10
    v_add_u32 v3, s16, v2
    ds_read_b128 v[16:19], v3
    ds_read_b128 v[20:23], v3 offset:2048
    ds_read_b128 v[24:27], v3 offset:4096
    ds_read_b128 v[28:31], v3 offset:6144
    v_and_b32 v5, 15, v1
    v_mul_u32_u24 v5, 2560, v5
    v_lshrrev_b32 v6, 4, v1
    v_lshlrev_b32 v6, 3, v6
    v_add_u32 v5, v5, v6
    s_lshl_b32 s15, s9, 5
    s_lshl_b32 s16, s10, 4
    s_add_u32 s15, s15, s16
    s_mul_i32 s15, s15, 2560
    s_lshl_b32 s16, s11, 6
    s_add_u32 s15, s15, s16
    s_lshl_b32 s16, s8, 5
    s_add_u32 s15, s15, s16
    s_add_u32 s15, s15, 1280
    s_waitcnt lgkmcnt(0)
    v_add_f32 v16, v16, v20
    v_add_f32 v24, v24, v28
    v_add_f32 v17, v17, v21
    v_add_f32 v25, v25, v29
    v_add_f32 v18, v18, v22
    v_add_f32 v26, v26, v30
    v_add_f32 v19, v19, v23
    v_add_f32 v27, v27, v31
    v_add_f32 v16, v16, v24
    v_add_f32 v17, v17, v25
    v_add_f32 v18, v18, v26
    v_add_f32 v19, v19, v27
    v_cvt_pk_bf16_f32 v16, v16, v17
    v_cvt_pk_bf16_f32 v17, v18, v19
    buffer_store_dwordx2 v[16:17], v5, s[20:23], s15 offen
CH_os156:
    s_barrier
    s_mov_b32 s10, 1
    s_lshl_b32 s13, s8, 22
    s_lshl_b32 s16, s9, 13
    s_add_u32 s13, s13, s16
    s_lshl_b32 s16, s10, 12
    s_add_u32 s13, s13, s16
    s_add_u32 s13, s13, 50331648
    s_mov_b32 s14, s13
    s_add_u32 s16, s13, 0
    buffer_load_dwordx4 v[64:67], v2, s[4:7], s16 offen offset:0
    buffer_load_dwordx4 v[68:71], v2, s[4:7], s16 offen offset:1024
    buffer_load_dwordx4 v[72:75], v2, s[4:7], s16 offen offset:2048
    buffer_load_dwordx4 v[76:79], v2, s[4:7], s16 offen offset:3072
    s_add_u32 s16, s13, 524288
    buffer_load_dwordx4 v[80:83], v2, s[4:7], s16 offen offset:0
    buffer_load_dwordx4 v[84:87], v2, s[4:7], s16 offen offset:1024
    buffer_load_dwordx4 v[88:91], v2, s[4:7], s16 offen offset:2048
    buffer_load_dwordx4 v[92:95], v2, s[4:7], s16 offen offset:3072
    s_add_u32 s16, s14, 1048576
    buffer_load_dwordx4 v[96:99], v2, s[4:7], s16 offen offset:0
    buffer_load_dwordx4 v[100:103], v2, s[4:7], s16 offen offset:1024
    buffer_load_dwordx4 v[104:107], v2, s[4:7], s16 offen offset:2048
    buffer_load_dwordx4 v[108:111], v2, s[4:7], s16 offen offset:3072
    s_add_u32 s16, s14, 1572864
    buffer_load_dwordx4 v[112:115], v2, s[4:7], s16 offen offset:0
    buffer_load_dwordx4 v[116:119], v2, s[4:7], s16 offen offset:1024
    buffer_load_dwordx4 v[120:123], v2, s[4:7], s16 offen offset:2048
    buffer_load_dwordx4 v[124:127], v2, s[4:7], s16 offen offset:3072
    s_add_u32 s16, s13, 2097152
    buffer_load_dwordx4 v[128:131], v2, s[4:7], s16 offen offset:0
    buffer_load_dwordx4 v[132:135], v2, s[4:7], s16 offen offset:1024
    buffer_load_dwordx4 v[136:139], v2, s[4:7], s16 offen offset:2048
    buffer_load_dwordx4 v[140:143], v2, s[4:7], s16 offen offset:3072
    s_add_u32 s16, s13, 2621440
    buffer_load_dwordx4 v[144:147], v2, s[4:7], s16 offen offset:0
    buffer_load_dwordx4 v[148:151], v2, s[4:7], s16 offen offset:1024
    buffer_load_dwordx4 v[152:155], v2, s[4:7], s16 offen offset:2048
    buffer_load_dwordx4 v[156:159], v2, s[4:7], s16 offen offset:3072
    s_add_u32 s16, s14, 3145728
    buffer_load_dwordx4 v[160:163], v2, s[4:7], s16 offen offset:0
    buffer_load_dwordx4 v[164:167], v2, s[4:7], s16 offen offset:1024
    buffer_load_dwordx4 v[168:171], v2, s[4:7], s16 offen offset:2048
    buffer_load_dwordx4 v[172:175], v2, s[4:7], s16 offen offset:3072
    s_add_u32 s16, s14, 3670016
    buffer_load_dwordx4 v[176:179], v2, s[4:7], s16 offen offset:0
    buffer_load_dwordx4 v[180:183], v2, s[4:7], s16 offen offset:1024
    buffer_load_dwordx4 v[184:187], v2, s[4:7], s16 offen offset:2048
    buffer_load_dwordx4 v[188:191], v2, s[4:7], s16 offen offset:3072
    s_waitcnt vmcnt(28)
    v_mfma_f32_16x16x32_bf16 v[16:19], a[0:3], v[64:67], 0
    v_mfma_f32_16x16x32_bf16 v[20:23], a[128:131], v[64:67], 0
    v_mfma_f32_16x16x32_bf16 v[16:19], a[4:7], v[68:71], v[16:19]
    v_mfma_f32_16x16x32_bf16 v[20:23], a[132:135], v[68:71], v[20:23]
    v_mfma_f32_16x16x32_bf16 v[16:19], a[8:11], v[72:75], v[16:19]
    v_mfma_f32_16x16x32_bf16 v[20:23], a[136:139], v[72:75], v[20:23]
    v_mfma_f32_16x16x32_bf16 v[16:19], a[12:15], v[76:79], v[16:19]
    v_mfma_f32_16x16x32_bf16 v[20:23], a[140:143], v[76:79], v[20:23]
    s_waitcnt vmcnt(24)
    v_mfma_f32_16x16x32_bf16 v[16:19], a[16:19], v[80:83], v[16:19]
    v_mfma_f32_16x16x32_bf16 v[20:23], a[144:147], v[80:83], v[20:23]
    v_mfma_f32_16x16x32_bf16 v[16:19], a[20:23], v[84:87], v[16:19]
    v_mfma_f32_16x16x32_bf16 v[20:23], a[148:151], v[84:87], v[20:23]
    v_mfma_f32_16x16x32_bf16 v[16:19], a[24:27], v[88:91], v[16:19]
    v_mfma_f32_16x16x32_bf16 v[20:23], a[152:155], v[88:91], v[20:23]
    v_mfma_f32_16x16x32_bf16 v[16:19], a[28:31], v[92:95], v[16:19]
    v_mfma_f32_16x16x32_bf16 v[20:23], a[156:159], v[92:95], v[20:23]
    s_waitcnt vmcnt(20)
    v_mfma_f32_16x16x32_bf16 v[16:19], a[32:35], v[96:99], v[16:19]
    v_mfma_f32_16x16x32_bf16 v[20:23], a[160:163], v[96:99], v[20:23]
    v_mfma_f32_16x16x32_bf16 v[16:19], a[36:39], v[100:103], v[16:19]
    v_mfma_f32_16x16x32_bf16 v[20:23], a[164:167], v[100:103], v[20:23]
    v_mfma_f32_16x16x32_bf16 v[16:19], a[40:43], v[104:107], v[16:19]
    v_mfma_f32_16x16x32_bf16 v[20:23], a[168:171], v[104:107], v[20:23]
    v_mfma_f32_16x16x32_bf16 v[16:19], a[44:47], v[108:111], v[16:19]
    v_mfma_f32_16x16x32_bf16 v[20:23], a[172:175], v[108:111], v[20:23]
    s_waitcnt vmcnt(16)
    v_mfma_f32_16x16x32_bf16 v[16:19], a[48:51], v[112:115], v[16:19]
    v_mfma_f32_16x16x32_bf16 v[20:23], a[176:179], v[112:115], v[20:23]
    v_mfma_f32_16x16x32_bf16 v[16:19], a[52:55], v[116:119], v[16:19]
    v_mfma_f32_16x16x32_bf16 v[20:23], a[180:183], v[116:119], v[20:23]
    v_mfma_f32_16x16x32_bf16 v[16:19], a[56:59], v[120:123], v[16:19]
    v_mfma_f32_16x16x32_bf16 v[20:23], a[184:187], v[120:123], v[20:23]
    v_mfma_f32_16x16x32_bf16 v[16:19], a[60:63], v[124:127], v[16:19]
    v_mfma_f32_16x16x32_bf16 v[20:23], a[188:191], v[124:127], v[20:23]
    s_waitcnt vmcnt(12)
    v_mfma_f32_16x16x32_bf16 v[16:19], a[64:67], v[128:131], v[16:19]
    v_mfma_f32_16x16x32_bf16 v[20:23], a[192:195], v[128:131], v[20:23]
    v_mfma_f32_16x16x32_bf16 v[16:19], a[68:71], v[132:135], v[16:19]
    v_mfma_f32_16x16x32_bf16 v[20:23], a[196:199], v[132:135], v[20:23]
    v_mfma_f32_16x16x32_bf16 v[16:19], a[72:75], v[136:139], v[16:19]
    v_mfma_f32_16x16x32_bf16 v[20:23], a[200:203], v[136:139], v[20:23]
    v_mfma_f32_16x16x32_bf16 v[16:19], a[76:79], v[140:143], v[16:19]
    v_mfma_f32_16x16x32_bf16 v[20:23], a[204:207], v[140:143], v[20:23]
    s_waitcnt vmcnt(8)
    v_mfma_f32_16x16x32_bf16 v[16:19], a[80:83], v[144:147], v[16:19]
    v_mfma_f32_16x16x32_bf16 v[20:23], a[208:211], v[144:147], v[20:23]
    v_mfma_f32_16x16x32_bf16 v[16:19], a[84:87], v[148:151], v[16:19]
    v_mfma_f32_16x16x32_bf16 v[20:23], a[212:215], v[148:151], v[20:23]
    v_mfma_f32_16x16x32_bf16 v[16:19], a[88:91], v[152:155], v[16:19]
    v_mfma_f32_16x16x32_bf16 v[20:23], a[216:219], v[152:155], v[20:23]
    v_mfma_f32_16x16x32_bf16 v[16:19], a[92:95], v[156:159], v[16:19]
    v_mfma_f32_16x16x32_bf16 v[20:23], a[220:223], v[156:159], v[20:23]
    s_waitcnt vmcnt(4)
    v_mfma_f32_16x16x32_bf16 v[16:19], a[96:99], v[160:163], v[16:19]
    v_mfma_f32_16x16x32_bf16 v[20:23], a[224:227], v[160:163], v[20:23]
    v_mfma_f32_16x16x32_bf16 v[16:19], a[100:103], v[164:167], v[16:19]
    v_mfma_f32_16x16x32_bf16 v[20:23], a[228:231], v[164:167], v[20:23]
    v_mfma_f32_16x16x32_bf16 v[16:19], a[104:107], v[168:171], v[16:19]
    v_mfma_f32_16x16x32_bf16 v[20:23], a[232:235], v[168:171], v[20:23]
    v_mfma_f32_16x16x32_bf16 v[16:19], a[108:111], v[172:175], v[16:19]
    v_mfma_f32_16x16x32_bf16 v[20:23], a[236:239], v[172:175], v[20:23]
    s_waitcnt vmcnt(0)
    v_mfma_f32_16x16x32_bf16 v[16:19], a[112:115], v[176:179], v[16:19]
    v_mfma_f32_16x16x32_bf16 v[20:23], a[240:243], v[176:179], v[20:23]
    v_mfma_f32_16x16x32_bf16 v[16:19], a[116:119], v[180:183], v[16:19]
    v_mfma_f32_16x16x32_bf16 v[20:23], a[244:247], v[180:183], v[20:23]
    v_mfma_f32_16x16x32_bf16 v[16:19], a[120:123], v[184:187], v[16:19]
    v_mfma_f32_16x16x32_bf16 v[20:23], a[248:251], v[184:187], v[20:23]
    v_mfma_f32_16x16x32_bf16 v[16:19], a[124:127], v[188:191], v[16:19]
    v_mfma_f32_16x16x32_bf16 v[20:23], a[252:255], v[188:191], v[20:23]
    s_nop 7
    s_lshl_b32 s16, s8, 11
    v_add_u32 v3, s16, v2
    ds_write_b128 v3, v[16:19]
    ds_write_b128 v3, v[20:23] offset:1024
    s_waitcnt lgkmcnt(0)
    s_barrier
    s_cmp_ge_u32 s8, 2
    s_cbranch_scc1 CH_os157
    s_lshl_b32 s16, s8, 10
    v_add_u32 v3, s16, v2
    ds_read_b128 v[16:19], v3
    ds_read_b128 v[20:23], v3 offset:2048
    ds_read_b128 v[24:27], v3 offset:4096
    ds_read_b128 v[28:31], v3 offset:6144
    v_and_b32 v5, 15, v1
    v_mul_u32_u24 v5, 2560, v5
    v_lshrrev_b32 v6, 4, v1
    v_lshlrev_b32 v6, 3, v6
    v_add_u32 v5, v5, v6
    s_lshl_b32 s15, s9, 5
    s_lshl_b32 s16, s10, 4
    s_add_u32 s15, s15, s16
    s_mul_i32 s15, s15, 2560
    s_lshl_b32 s16, s11, 6
    s_add_u32 s15, s15, s16
    s_lshl_b32 s16, s8, 5
    s_add_u32 s15, s15, s16
    s_add_u32 s15, s15, 1280
    s_waitcnt lgkmcnt(0)
    v_add_f32 v16, v16, v20
    v_add_f32 v24, v24, v28
    v_add_f32 v17, v17, v21
    v_add_f32 v25, v25, v29
    v_add_f32 v18, v18, v22
    v_add_f32 v26, v26, v30
    v_add_f32 v19, v19, v23
    v_add_f32 v27, v27, v31
    v_add_f32 v16, v16, v24
    v_add_f32 v17, v17, v25
    v_add_f32 v18, v18, v26
    v_add_f32 v19, v19, v27
    v_cvt_pk_bf16_f32 v16, v16, v17
    v_cvt_pk_bf16_f32 v17, v18, v19
    buffer_store_dwordx2 v[16:17], v5, s[20:23], s15 offen
CH_os157:
    s_barrier
    s_branch CH_wtop86
CH_wout119:
    s_mov_b32 s45, s9
    s_cmp_lg_u32 s8, 0
    s_cbranch_scc1 CH_cl_nw158
    s_mov_b64 exec, 1
    s_and_b32 s47, s101, 3
    s_mov_b32 s49, 0
CH_cl_lp159:
    s_lshl_b32 s46, s45, 4
    s_lshl_b32 s50, s47, 2
    s_add_u32 s46, s46, s50
    s_add_u32 s46, s46, 85997824
    v_mov_b32 v2, s46
    v_mov_b32 v3, 1
    buffer_atomic_add v3, v2, s[4:7], 0 offen sc0
    s_waitcnt vmcnt(0)
    s_nop 0
    v_readfirstlane_b32 s46, v3
    s_nop 3
    s_cmp_lt_u32 s46, 2
    s_cbranch_scc1 CH_cl_ok160
    s_add_u32 s47, s47, 1
    s_and_b32 s47, s47, 3
    s_add_u32 s49, s49, 1
    s_cmp_lt_u32 s49, 4
    s_cbranch_scc1 CH_cl_lp159
    s_mov_b32 s46, 0
CH_cl_ok160:
    s_mul_i32 s47, s47, 2
    s_add_u32 s46, s46, s47
    v_mov_b32 v2, 143300
    v_mov_b32 v3, s46
    ds_write_b32 v2, v3
    s_waitcnt lgkmcnt(0)
    s_mov_b64 exec, -1
CH_cl_nw158:
    s_barrier
    v_mov_b32 v2, 143300
    ds_read_b32 v3, v2
    s_waitcnt lgkmcnt(0)
    s_nop 0
    v_readfirstlane_b32 s46, v3
    s_nop 3
    s_barrier
    s_mov_b32 s10, s46
    s_lshl_b32 s16, s9, 6
    s_add_u32 s16, s16, 85995520
    v_lshlrev_b32 v2, 5, v1
    v_add_u32 v2, s16, v2
    v_mov_b32 v4, 85997568
    v_cmp_eq_u32 vcc, 2, v1
    s_nop 1
    v_cndmask_b32 v2, v2, v4, vcc
    v_mov_b32 v3, 8
    v_mov_b32 v4, 32
    v_cndmask_b32 v3, v3, v4, vcc
    s_mov_b64 exec, 7
    s_mov_b32 s40, 0
CH_wf161:
    buffer_load_dword v9, v2, s[4:7], 0 offen sc1
    s_waitcnt vmcnt(0)
    v_cmp_lt_u32 vcc, v9, v3
    s_cbranch_vccz CH_wfok162
    s_sleep 16
    s_add_u32 s40, s40, 1
    s_cmp_lt_u32 s40, 174762
    s_cbranch_scc1 CH_wf161
    s_endpgm
CH_wfok162:
    s_mov_b64 exec, -1
    s_load_dwordx2 s[28:29], s[0:1], 128
    s_waitcnt lgkmcnt(0)
    s_mov_b32 s20, s28
    s_and_b32 s21, s29, 0xffff
    s_mov_b32 s22, 5242880
    s_mov_b32 s23, 0x20000
    v_lshlrev_b32 v2, 4, v1
    s_mul_i32 s11, s10, 655360
    s_lshl_b32 s12, s8, 15
    s_add_u32 s11, s11, s12
    s_add_u32 s11, s11, 88080384
    s_lshl_b32 s12, s8, 22
    s_lshl_b32 s13, s9, 14
    s_add_u32 s12, s12, s13
    s_add_u32 s12, s12, 50331648
    s_mov_b32 s14, s12
    s_add_u32 s16, s11, 0
    buffer_load_dwordx4 a[0:3], v2, s[4:7], s16 offen
    s_add_u32 s16, s11, 131072
    buffer_load_dwordx4 a[4:7], v2, s[4:7], s16 offen
    s_add_u32 s16, s11, 262144
    buffer_load_dwordx4 a[8:11], v2, s[4:7], s16 offen
    s_add_u32 s16, s11, 393216
    buffer_load_dwordx4 a[12:15], v2, s[4:7], s16 offen
    s_add_u32 s16, s11, 524288
    buffer_load_dwordx4 a[16:19], v2, s[4:7], s16 offen
    s_add_u32 s16, s12, 0
    buffer_load_dwordx4 a[20:23], v2, s[4:7], s16 offen
    s_add_u32 s16, s12, 4096
    buffer_load_dwordx4 a[24:27], v2, s[4:7], s16 offen
    s_add_u32 s16, s12, 8192
    buffer_load_dwordx4 a[28:31], v2, s[4:7], s16 offen
    s_add_u32 s16, s12, 12288
    buffer_load_dwordx4 a[32:35], v2, s[4:7], s16 offen
    s_add_u32 s16, s11, 1024
    buffer_load_dwordx4 a[36:39], v2, s[4:7], s16 offen
    s_add_u32 s16, s11, 132096
    buffer_load_dwordx4 a[40:43], v2, s[4:7], s16 offen
    s_add_u32 s16, s11, 263168
    buffer_load_dwordx4 a[44:47], v2, s[4:7], s16 offen
    s_add_u32 s16, s11, 394240
    buffer_load_dwordx4 a[48:51], v2, s[4:7], s16 offen
    s_add_u32 s16, s11, 525312
    buffer_load_dwordx4 a[52:55], v2, s[4:7], s16 offen
    s_add_u32 s16, s12, 1024
    buffer_load_dwordx4 a[56:59], v2, s[4:7], s16 offen
    s_add_u32 s16, s12, 5120
    buffer_load_dwordx4 a[60:63], v2, s[4:7], s16 offen
    s_add_u32 s16, s12, 9216
    buffer_load_dwordx4 a[64:67], v2, s[4:7], s16 offen
    s_add_u32 s16, s12, 13312
    buffer_load_dwordx4 a[68:71], v2, s[4:7], s16 offen
    s_add_u32 s16, s11, 2048
    buffer_load_dwordx4 a[72:75], v2, s[4:7], s16 offen
    s_add_u32 s16, s11, 133120
    buffer_load_dwordx4 a[76:79], v2, s[4:7], s16 offen
    s_add_u32 s16, s11, 264192
    buffer_load_dwordx4 a[80:83], v2, s[4:7], s16 offen
    s_add_u32 s16, s11, 395264
    buffer_load_dwordx4 a[84:87], v2, s[4:7], s16 offen
    s_add_u32 s16, s11, 526336
    buffer_load_dwordx4 a[88:91], v2, s[4:7], s16 offen
    s_add_u32 s16, s12, 2048
    buffer_load_dwordx4 a[92:95], v2, s[4:7], s16 offen
    s_add_u32 s16, s12, 6144
    buffer_load_dwordx4 a[96:99], v2, s[4:7], s16 offen
    s_add_u32 s16, s12, 10240
    buffer_load_dwordx4 a[100:103], v2, s[4:7], s16 offen
    s_add_u32 s16, s12, 14336
    buffer_load_dwordx4 a[104:107], v2, s[4:7], s16 offen
    s_add_u32 s16, s11, 3072
    buffer_load_dwordx4 a[108:111], v2, s[4:7], s16 offen
    s_add_u32 s16, s11, 134144
    buffer_load_dwordx4 a[112:115], v2, s[4:7], s16 offen
    s_add_u32 s16, s11, 265216
    buffer_load_dwordx4 a[116:119], v2, s[4:7], s16 offen
    s_add_u32 s16, s11, 396288
    buffer_load_dwordx4 a[120:123], v2, s[4:7], s16 offen
    s_add_u32 s16, s11, 527360
    buffer_load_dwordx4 a[124:127], v2, s[4:7], s16 offen
    s_add_u32 s16, s12, 3072
    buffer_load_dwordx4 a[128:131], v2, s[4:7], s16 offen
    s_add_u32 s16, s12, 7168
    buffer_load_dwordx4 a[132:135], v2, s[4:7], s16 offen
    s_add_u32 s16, s12, 11264
    buffer_load_dwordx4 a[136:139], v2, s[4:7], s16 offen
    s_add_u32 s16, s12, 15360
    buffer_load_dwordx4 a[140:143], v2, s[4:7], s16 offen
    s_add_u32 s16, s11, 4096
    buffer_load_dwordx4 a[144:147], v2, s[4:7], s16 offen
    s_add_u32 s16, s11, 135168
    buffer_load_dwordx4 a[148:151], v2, s[4:7], s16 offen
    s_add_u32 s16, s11, 266240
    buffer_load_dwordx4 a[152:155], v2, s[4:7], s16 offen
    s_add_u32 s16, s11, 397312
    buffer_load_dwordx4 a[156:159], v2, s[4:7], s16 offen
    s_add_u32 s16, s11, 528384
    buffer_load_dwordx4 a[160:163], v2, s[4:7], s16 offen
    s_add_u32 s16, s12, 524288
    buffer_load_dwordx4 a[164:167], v2, s[4:7], s16 offen
    s_add_u32 s16, s12, 528384
    buffer_load_dwordx4 a[168:171], v2, s[4:7], s16 offen
    s_add_u32 s16, s12, 532480
    buffer_load_dwordx4 a[172:175], v2, s[4:7], s16 offen
    s_add_u32 s16, s12, 536576
    buffer_load_dwordx4 a[176:179], v2, s[4:7], s16 offen
    s_add_u32 s16, s11, 5120
    buffer_load_dwordx4 a[180:183], v2, s[4:7], s16 offen
    s_add_u32 s16, s11, 136192
    buffer_load_dwordx4 a[184:187], v2, s[4:7], s16 offen
    s_add_u32 s16, s11, 267264
    buffer_load_dwordx4 a[188:191], v2, s[4:7], s16 offen
    s_add_u32 s16, s11, 398336
    buffer_load_dwordx4 a[192:195], v2, s[4:7], s16 offen
    s_add_u32 s16, s11, 529408
    buffer_load_dwordx4 a[196:199], v2, s[4:7], s16 offen
    s_add_u32 s16, s12, 525312
    buffer_load_dwordx4 a[200:203], v2, s[4:7], s16 offen
    s_add_u32 s16, s12, 529408
    buffer_load_dwordx4 a[204:207], v2, s[4:7], s16 offen
    s_add_u32 s16, s12, 533504
    buffer_load_dwordx4 a[208:211], v2, s[4:7], s16 offen
    s_add_u32 s16, s12, 537600
    buffer_load_dwordx4 a[212:215], v2, s[4:7], s16 offen
    s_waitcnt vmcnt(45)
    v_mfma_f32_16x16x32_bf16 v[96:99], a[0:3], a[20:23], 0
    v_mfma_f32_16x16x32_bf16 v[100:103], a[0:3], a[24:27], 0
    v_mfma_f32_16x16x32_bf16 v[104:107], a[0:3], a[28:31], 0
    v_mfma_f32_16x16x32_bf16 v[108:111], a[0:3], a[32:35], 0
    v_mfma_f32_16x16x32_bf16 v[112:115], a[4:7], a[20:23], 0
    v_mfma_f32_16x16x32_bf16 v[116:119], a[4:7], a[24:27], 0
    v_mfma_f32_16x16x32_bf16 v[120:123], a[4:7], a[28:31], 0
    v_mfma_f32_16x16x32_bf16 v[124:127], a[4:7], a[32:35], 0
    v_mfma_f32_16x16x32_bf16 v[128:131], a[8:11], a[20:23], 0
    v_mfma_f32_16x16x32_bf16 v[132:135], a[8:11], a[24:27], 0
    v_mfma_f32_16x16x32_bf16 v[136:139], a[8:11], a[28:31], 0
    v_mfma_f32_16x16x32_bf16 v[140:143], a[8:11], a[32:35], 0
    v_mfma_f32_16x16x32_bf16 v[144:147], a[12:15], a[20:23], 0
    v_mfma_f32_16x16x32_bf16 v[148:151], a[12:15], a[24:27], 0
    v_mfma_f32_16x16x32_bf16 v[152:155], a[12:15], a[28:31], 0
    v_mfma_f32_16x16x32_bf16 v[156:159], a[12:15], a[32:35], 0
    v_mfma_f32_16x16x32_bf16 v[160:163], a[16:19], a[20:23], 0
    v_mfma_f32_16x16x32_bf16 v[164:167], a[16:19], a[24:27], 0
    v_mfma_f32_16x16x32_bf16 v[168:171], a[16:19], a[28:31], 0
    v_mfma_f32_16x16x32_bf16 v[172:175], a[16:19], a[32:35], 0
    s_add_u32 s16, s11, 6144
    buffer_load_dwordx4 a[0:3], v2, s[4:7], s16 offen
    s_add_u32 s16, s11, 137216
    buffer_load_dwordx4 a[4:7], v2, s[4:7], s16 offen
    s_add_u32 s16, s11, 268288
    buffer_load_dwordx4 a[8:11], v2, s[4:7], s16 offen
    s_add_u32 s16, s11, 399360
    buffer_load_dwordx4 a[12:15], v2, s[4:7], s16 offen
    s_add_u32 s16, s11, 530432
    buffer_load_dwordx4 a[16:19], v2, s[4:7], s16 offen
    s_add_u32 s16, s12, 526336
    buffer_load_dwordx4 a[20:23], v2, s[4:7], s16 offen
    s_add_u32 s16, s12, 530432
    buffer_load_dwordx4 a[24:27], v2, s[4:7], s16 offen
    s_add_u32 s16, s12, 534528
    buffer_load_dwordx4 a[28:31], v2, s[4:7], s16 offen
    s_add_u32 s16, s12, 538624
    buffer_load_dwordx4 a[32:35], v2, s[4:7], s16 offen
    s_waitcnt vmcnt(45)
    v_mfma_f32_16x16x32_bf16 v[96:99], a[36:39], a[56:59], v[96:99]
    v_mfma_f32_16x16x32_bf16 v[100:103], a[36:39], a[60:63], v[100:103]
    v_mfma_f32_16x16x32_bf16 v[104:107], a[36:39], a[64:67], v[104:107]
    v_mfma_f32_16x16x32_bf16 v[108:111], a[36:39], a[68:71], v[108:111]
    v_mfma_f32_16x16x32_bf16 v[112:115], a[40:43], a[56:59], v[112:115]
    v_mfma_f32_16x16x32_bf16 v[116:119], a[40:43], a[60:63], v[116:119]
    v_mfma_f32_16x16x32_bf16 v[120:123], a[40:43], a[64:67], v[120:123]
    v_mfma_f32_16x16x32_bf16 v[124:127], a[40:43], a[68:71], v[124:127]
    v_mfma_f32_16x16x32_bf16 v[128:131], a[44:47], a[56:59], v[128:131]
    v_mfma_f32_16x16x32_bf16 v[132:135], a[44:47], a[60:63], v[132:135]
    v_mfma_f32_16x16x32_bf16 v[136:139], a[44:47], a[64:67], v[136:139]
    v_mfma_f32_16x16x32_bf16 v[140:143], a[44:47], a[68:71], v[140:143]
    v_mfma_f32_16x16x32_bf16 v[144:147], a[48:51], a[56:59], v[144:147]
    v_mfma_f32_16x16x32_bf16 v[148:151], a[48:51], a[60:63], v[148:151]
    v_mfma_f32_16x16x32_bf16 v[152:155], a[48:51], a[64:67], v[152:155]
    v_mfma_f32_16x16x32_bf16 v[156:159], a[48:51], a[68:71], v[156:159]
    v_mfma_f32_16x16x32_bf16 v[160:163], a[52:55], a[56:59], v[160:163]
    v_mfma_f32_16x16x32_bf16 v[164:167], a[52:55], a[60:63], v[164:167]
    v_mfma_f32_16x16x32_bf16 v[168:171], a[52:55], a[64:67], v[168:171]
    v_mfma_f32_16x16x32_bf16 v[172:175], a[52:55], a[68:71], v[172:175]
    s_add_u32 s16, s11, 7168
    buffer_load_dwordx4 a[36:39], v2, s[4:7], s16 offen
    s_add_u32 s16, s11, 138240
    buffer_load_dwordx4 a[40:43], v2, s[4:7], s16 offen
    s_add_u32 s16, s11, 269312
    buffer_load_dwordx4 a[44:47], v2, s[4:7], s16 offen
    s_add_u32 s16, s11, 400384
    buffer_load_dwordx4 a[48:51], v2, s[4:7], s16 offen
    s_add_u32 s16, s11, 531456
    buffer_load_dwordx4 a[52:55], v2, s[4:7], s16 offen
    s_add_u32 s16, s12, 527360
    buffer_load_dwordx4 a[56:59], v2, s[4:7], s16 offen
    s_add_u32 s16, s12, 531456
    buffer_load_dwordx4 a[60:63], v2, s[4:7], s16 offen
    s_add_u32 s16, s12, 535552
    buffer_load_dwordx4 a[64:67], v2, s[4:7], s16 offen
    s_add_u32 s16, s12, 539648
    buffer_load_dwordx4 a[68:71], v2, s[4:7], s16 offen
    s_waitcnt vmcnt(45)
    v_mfma_f32_16x16x32_bf16 v[96:99], a[72:75], a[92:95], v[96:99]
    v_mfma_f32_16x16x32_bf16 v[100:103], a[72:75], a[96:99], v[100:103]
    v_mfma_f32_16x16x32_bf16 v[104:107], a[72:75], a[100:103], v[104:107]
    v_mfma_f32_16x16x32_bf16 v[108:111], a[72:75], a[104:107], v[108:111]
    v_mfma_f32_16x16x32_bf16 v[112:115], a[76:79], a[92:95], v[112:115]
    v_mfma_f32_16x16x32_bf16 v[116:119], a[76:79], a[96:99], v[116:119]
    v_mfma_f32_16x16x32_bf16 v[120:123], a[76:79], a[100:103], v[120:123]
    v_mfma_f32_16x16x32_bf16 v[124:127], a[76:79], a[104:107], v[124:127]
    v_mfma_f32_16x16x32_bf16 v[128:131], a[80:83], a[92:95], v[128:131]
    v_mfma_f32_16x16x32_bf16 v[132:135], a[80:83], a[96:99], v[132:135]
    v_mfma_f32_16x16x32_bf16 v[136:139], a[80:83], a[100:103], v[136:139]
    v_mfma_f32_16x16x32_bf16 v[140:143], a[80:83], a[104:107], v[140:143]
    v_mfma_f32_16x16x32_bf16 v[144:147], a[84:87], a[92:95], v[144:147]
    v_mfma_f32_16x16x32_bf16 v[148:151], a[84:87], a[96:99], v[148:151]
    v_mfma_f32_16x16x32_bf16 v[152:155], a[84:87], a[100:103], v[152:155]
    v_mfma_f32_16x16x32_bf16 v[156:159], a[84:87], a[104:107], v[156:159]
    v_mfma_f32_16x16x32_bf16 v[160:163], a[88:91], a[92:95], v[160:163]
    v_mfma_f32_16x16x32_bf16 v[164:167], a[88:91], a[96:99], v[164:167]
    v_mfma_f32_16x16x32_bf16 v[168:171], a[88:91], a[100:103], v[168:171]
    v_mfma_f32_16x16x32_bf16 v[172:175], a[88:91], a[104:107], v[172:175]
    s_add_u32 s16, s11, 8192
    buffer_load_dwordx4 a[72:75], v2, s[4:7], s16 offen
    s_add_u32 s16, s11, 139264
    buffer_load_dwordx4 a[76:79], v2, s[4:7], s16 offen
    s_add_u32 s16, s11, 270336
    buffer_load_dwordx4 a[80:83], v2, s[4:7], s16 offen
    s_add_u32 s16, s11, 401408
    buffer_load_dwordx4 a[84:87], v2, s[4:7], s16 offen
    s_add_u32 s16, s11, 532480
    buffer_load_dwordx4 a[88:91], v2, s[4:7], s16 offen
    s_add_u32 s16, s14, 1048576
    buffer_load_dwordx4 a[92:95], v2, s[4:7], s16 offen
    s_add_u32 s16, s14, 1052672
    buffer_load_dwordx4 a[96:99], v2, s[4:7], s16 offen
    s_add_u32 s16, s14, 1056768
    buffer_load_dwordx4 a[100:103], v2, s[4:7], s16 offen
    s_add_u32 s16, s14, 1060864
    buffer_load_dwordx4 a[104:107], v2, s[4:7], s16 offen
    s_waitcnt vmcnt(45)
    v_mfma_f32_16x16x32_bf16 v[96:99], a[108:111], a[128:131], v[96:99]
    v_mfma_f32_16x16x32_bf16 v[100:103], a[108:111], a[132:135], v[100:103]
    v_mfma_f32_16x16x32_bf16 v[104:107], a[108:111], a[136:139], v[104:107]
    v_mfma_f32_16x16x32_bf16 v[108:111], a[108:111], a[140:143], v[108:111]
    v_mfma_f32_16x16x32_bf16 v[112:115], a[112:115], a[128:131], v[112:115]
    v_mfma_f32_16x16x32_bf16 v[116:119], a[112:115], a[132:135], v[116:119]
    v_mfma_f32_16x16x32_bf16 v[120:123], a[112:115], a[136:139], v[120:123]
    v_mfma_f32_16x16x32_bf16 v[124:127], a[112:115], a[140:143], v[124:127]
    v_mfma_f32_16x16x32_bf16 v[128:131], a[116:119], a[128:131], v[128:131]
    v_mfma_f32_16x16x32_bf16 v[132:135], a[116:119], a[132:135], v[132:135]
    v_mfma_f32_16x16x32_bf16 v[136:139], a[116:119], a[136:139], v[136:139]
    v_mfma_f32_16x16x32_bf16 v[140:143], a[116:119], a[140:143], v[140:143]
    v_mfma_f32_16x16x32_bf16 v[144:147], a[120:123], a[128:131], v[144:147]
    v_mfma_f32_16x16x32_bf16 v[148:151], a[120:123], a[132:135], v[148:151]
    v_mfma_f32_16x16x32_bf16 v[152:155], a[120:123], a[136:139], v[152:155]
    v_mfma_f32_16x16x32_bf16 v[156:159], a[120:123], a[140:143], v[156:159]
    v_mfma_f32_16x16x32_bf16 v[160:163], a[124:127], a[128:131], v[160:163]
    v_mfma_f32_16x16x32_bf16 v[164:167], a[124:127], a[132:135], v[164:167]
    v_mfma_f32_16x16x32_bf16 v[168:171], a[124:127], a[136:139], v[168:171]
    v_mfma_f32_16x16x32_bf16 v[172:175], a[124:127], a[140:143], v[172:175]
    s_add_u32 s16, s11, 9216
    buffer_load_dwordx4 a[108:111], v2, s[4:7], s16 offen
    s_add_u32 s16, s11, 140288
    buffer_load_dwordx4 a[112:115], v2, s[4:7], s16 offen
    s_add_u32 s16, s11, 271360
    buffer_load_dwordx4 a[116:119], v2, s[4:7], s16 offen
    s_add_u32 s16, s11, 402432
    buffer_load_dwordx4 a[120:123], v2, s[4:7], s16 offen
    s_add_u32 s16, s11, 533504
    buffer_load_dwordx4 a[124:127], v2, s[4:7], s16 offen
    s_add_u32 s16, s14, 1049600
    buffer_load_dwordx4 a[128:131], v2, s[4:7], s16 offen
    s_add_u32 s16, s14, 1053696
    buffer_load_dwordx4 a[132:135], v2, s[4:7], s16 offen
    s_add_u32 s16, s14, 1057792
    buffer_load_dwordx4 a[136:139], v2, s[4:7], s16 offen
    s_add_u32 s16, s14, 1061888
    buffer_load_dwordx4 a[140:143], v2, s[4:7], s16 offen
    s_waitcnt vmcnt(45)
    v_mfma_f32_16x16x32_bf16 v[96:99], a[144:147], a[164:167], v[96:99]
    v_mfma_f32_16x16x32_bf16 v[100:103], a[144:147], a[168:171], v[100:103]
    v_mfma_f32_16x16x32_bf16 v[104:107], a[144:147], a[172:175], v[104:107]
    v_mfma_f32_16x16x32_bf16 v[108:111], a[144:147], a[176:179], v[108:111]
    v_mfma_f32_16x16x32_bf16 v[112:115], a[148:151], a[164:167], v[112:115]
    v_mfma_f32_16x16x32_bf16 v[116:119], a[148:151], a[168:171], v[116:119]
    v_mfma_f32_16x16x32_bf16 v[120:123], a[148:151], a[172:175], v[120:123]
    v_mfma_f32_16x16x32_bf16 v[124:127], a[148:151], a[176:179], v[124:127]
    v_mfma_f32_16x16x32_bf16 v[128:131], a[152:155], a[164:167], v[128:131]
    v_mfma_f32_16x16x32_bf16 v[132:135], a[152:155], a[168:171], v[132:135]
    v_mfma_f32_16x16x32_bf16 v[136:139], a[152:155], a[172:175], v[136:139]
    v_mfma_f32_16x16x32_bf16 v[140:143], a[152:155], a[176:179], v[140:143]
    v_mfma_f32_16x16x32_bf16 v[144:147], a[156:159], a[164:167], v[144:147]
    v_mfma_f32_16x16x32_bf16 v[148:151], a[156:159], a[168:171], v[148:151]
    v_mfma_f32_16x16x32_bf16 v[152:155], a[156:159], a[172:175], v[152:155]
    v_mfma_f32_16x16x32_bf16 v[156:159], a[156:159], a[176:179], v[156:159]
    v_mfma_f32_16x16x32_bf16 v[160:163], a[160:163], a[164:167], v[160:163]
    v_mfma_f32_16x16x32_bf16 v[164:167], a[160:163], a[168:171], v[164:167]
    v_mfma_f32_16x16x32_bf16 v[168:171], a[160:163], a[172:175], v[168:171]
    v_mfma_f32_16x16x32_bf16 v[172:175], a[160:163], a[176:179], v[172:175]
    s_add_u32 s16, s11, 10240
    buffer_load_dwordx4 a[144:147], v2, s[4:7], s16 offen
    s_add_u32 s16, s11, 141312
    buffer_load_dwordx4 a[148:151], v2, s[4:7], s16 offen
    s_add_u32 s16, s11, 272384
    buffer_load_dwordx4 a[152:155], v2, s[4:7], s16 offen
    s_add_u32 s16, s11, 403456
    buffer_load_dwordx4 a[156:159], v2, s[4:7], s16 offen
    s_add_u32 s16, s11, 534528
    buffer_load_dwordx4 a[160:163], v2, s[4:7], s16 offen
    s_add_u32 s16, s14, 1050624
    buffer_load_dwordx4 a[164:167], v2, s[4:7], s16 offen
    s_add_u32 s16, s14, 1054720
    buffer_load_dwordx4 a[168:171], v2, s[4:7], s16 offen
    s_add_u32 s16, s14, 1058816
    buffer_load_dwordx4 a[172:175], v2, s[4:7], s16 offen
    s_add_u32 s16, s14, 1062912
    buffer_load_dwordx4 a[176:179], v2, s[4:7], s16 offen
    s_waitcnt vmcnt(45)
    v_mfma_f32_16x16x32_bf16 v[96:99], a[180:183], a[200:203], v[96:99]
    v_mfma_f32_16x16x32_bf16 v[100:103], a[180:183], a[204:207], v[100:103]
    v_mfma_f32_16x16x32_bf16 v[104:107], a[180:183], a[208:211], v[104:107]
    v_mfma_f32_16x16x32_bf16 v[108:111], a[180:183], a[212:215], v[108:111]
    v_mfma_f32_16x16x32_bf16 v[112:115], a[184:187], a[200:203], v[112:115]
    v_mfma_f32_16x16x32_bf16 v[116:119], a[184:187], a[204:207], v[116:119]
    v_mfma_f32_16x16x32_bf16 v[120:123], a[184:187], a[208:211], v[120:123]
    v_mfma_f32_16x16x32_bf16 v[124:127], a[184:187], a[212:215], v[124:127]
    v_mfma_f32_16x16x32_bf16 v[128:131], a[188:191], a[200:203], v[128:131]
    v_mfma_f32_16x16x32_bf16 v[132:135], a[188:191], a[204:207], v[132:135]
    v_mfma_f32_16x16x32_bf16 v[136:139], a[188:191], a[208:211], v[136:139]
    v_mfma_f32_16x16x32_bf16 v[140:143], a[188:191], a[212:215], v[140:143]
    v_mfma_f32_16x16x32_bf16 v[144:147], a[192:195], a[200:203], v[144:147]
    v_mfma_f32_16x16x32_bf16 v[148:151], a[192:195], a[204:207], v[148:151]
    v_mfma_f32_16x16x32_bf16 v[152:155], a[192:195], a[208:211], v[152:155]
    v_mfma_f32_16x16x32_bf16 v[156:159], a[192:195], a[212:215], v[156:159]
    v_mfma_f32_16x16x32_bf16 v[160:163], a[196:199], a[200:203], v[160:163]
    v_mfma_f32_16x16x32_bf16 v[164:167], a[196:199], a[204:207], v[164:167]
    v_mfma_f32_16x16x32_bf16 v[168:171], a[196:199], a[208:211], v[168:171]
    v_mfma_f32_16x16x32_bf16 v[172:175], a[196:199], a[212:215], v[172:175]
    s_add_u32 s16, s11, 11264
    buffer_load_dwordx4 a[180:183], v2, s[4:7], s16 offen
    s_add_u32 s16, s11, 142336
    buffer_load_dwordx4 a[184:187], v2, s[4:7], s16 offen
    s_add_u32 s16, s11, 273408
    buffer_load_dwordx4 a[188:191], v2, s[4:7], s16 offen
    s_add_u32 s16, s11, 404480
    buffer_load_dwordx4 a[192:195], v2, s[4:7], s16 offen
    s_add_u32 s16, s11, 535552
    buffer_load_dwordx4 a[196:199], v2, s[4:7], s16 offen
    s_add_u32 s16, s14, 1051648
    buffer_load_dwordx4 a[200:203], v2, s[4:7], s16 offen
    s_add_u32 s16, s14, 1055744
    buffer_load_dwordx4 a[204:207], v2, s[4:7], s16 offen
    s_add_u32 s16, s14, 1059840
    buffer_load_dwordx4 a[208:211], v2, s[4:7], s16 offen
    s_add_u32 s16, s14, 1063936
    buffer_load_dwordx4 a[212:215], v2, s[4:7], s16 offen
    s_waitcnt vmcnt(45)
    v_mfma_f32_16x16x32_bf16 v[96:99], a[0:3], a[20:23], v[96:99]
    v_mfma_f32_16x16x32_bf16 v[100:103], a[0:3], a[24:27], v[100:103]
    v_mfma_f32_16x16x32_bf16 v[104:107], a[0:3], a[28:31], v[104:107]
    v_mfma_f32_16x16x32_bf16 v[108:111], a[0:3], a[32:35], v[108:111]
    v_mfma_f32_16x16x32_bf16 v[112:115], a[4:7], a[20:23], v[112:115]
    v_mfma_f32_16x16x32_bf16 v[116:119], a[4:7], a[24:27], v[116:119]
    v_mfma_f32_16x16x32_bf16 v[120:123], a[4:7], a[28:31], v[120:123]
    v_mfma_f32_16x16x32_bf16 v[124:127], a[4:7], a[32:35], v[124:127]
    v_mfma_f32_16x16x32_bf16 v[128:131], a[8:11], a[20:23], v[128:131]
    v_mfma_f32_16x16x32_bf16 v[132:135], a[8:11], a[24:27], v[132:135]
    v_mfma_f32_16x16x32_bf16 v[136:139], a[8:11], a[28:31], v[136:139]
    v_mfma_f32_16x16x32_bf16 v[140:143], a[8:11], a[32:35], v[140:143]
    v_mfma_f32_16x16x32_bf16 v[144:147], a[12:15], a[20:23], v[144:147]
    v_mfma_f32_16x16x32_bf16 v[148:151], a[12:15], a[24:27], v[148:151]
    v_mfma_f32_16x16x32_bf16 v[152:155], a[12:15], a[28:31], v[152:155]
    v_mfma_f32_16x16x32_bf16 v[156:159], a[12:15], a[32:35], v[156:159]
    v_mfma_f32_16x16x32_bf16 v[160:163], a[16:19], a[20:23], v[160:163]
    v_mfma_f32_16x16x32_bf16 v[164:167], a[16:19], a[24:27], v[164:167]
    v_mfma_f32_16x16x32_bf16 v[168:171], a[16:19], a[28:31], v[168:171]
    v_mfma_f32_16x16x32_bf16 v[172:175], a[16:19], a[32:35], v[172:175]
    s_add_u32 s16, s11, 12288
    buffer_load_dwordx4 a[0:3], v2, s[4:7], s16 offen
    s_add_u32 s16, s11, 143360
    buffer_load_dwordx4 a[4:7], v2, s[4:7], s16 offen
    s_add_u32 s16, s11, 274432
    buffer_load_dwordx4 a[8:11], v2, s[4:7], s16 offen
    s_add_u32 s16, s11, 405504
    buffer_load_dwordx4 a[12:15], v2, s[4:7], s16 offen
    s_add_u32 s16, s11, 536576
    buffer_load_dwordx4 a[16:19], v2, s[4:7], s16 offen
    s_add_u32 s16, s14, 1572864
    buffer_load_dwordx4 a[20:23], v2, s[4:7], s16 offen
    s_add_u32 s16, s14, 1576960
    buffer_load_dwordx4 a[24:27], v2, s[4:7], s16 offen
    s_add_u32 s16, s14, 1581056
    buffer_load_dwordx4 a[28:31], v2, s[4:7], s16 offen
    s_add_u32 s16, s14, 1585152
    buffer_load_dwordx4 a[32:35], v2, s[4:7], s16 offen
    s_waitcnt vmcnt(45)
    v_mfma_f32_16x16x32_bf16 v[96:99], a[36:39], a[56:59], v[96:99]
    v_mfma_f32_16x16x32_bf16 v[100:103], a[36:39], a[60:63], v[100:103]
    v_mfma_f32_16x16x32_bf16 v[104:107], a[36:39], a[64:67], v[104:107]
    v_mfma_f32_16x16x32_bf16 v[108:111], a[36:39], a[68:71], v[108:111]
    v_mfma_f32_16x16x32_bf16 v[112:115], a[40:43], a[56:59], v[112:115]
    v_mfma_f32_16x16x32_bf16 v[116:119], a[40:43], a[60:63], v[116:119]
    v_mfma_f32_16x16x32_bf16 v[120:123], a[40:43], a[64:67], v[120:123]
    v_mfma_f32_16x16x32_bf16 v[124:127], a[40:43], a[68:71], v[124:127]
    v_mfma_f32_16x16x32_bf16 v[128:131], a[44:47], a[56:59], v[128:131]
    v_mfma_f32_16x16x32_bf16 v[132:135], a[44:47], a[60:63], v[132:135]
    v_mfma_f32_16x16x32_bf16 v[136:139], a[44:47], a[64:67], v[136:139]
    v_mfma_f32_16x16x32_bf16 v[140:143], a[44:47], a[68:71], v[140:143]
    v_mfma_f32_16x16x32_bf16 v[144:147], a[48:51], a[56:59], v[144:147]
    v_mfma_f32_16x16x32_bf16 v[148:151], a[48:51], a[60:63], v[148:151]
    v_mfma_f32_16x16x32_bf16 v[152:155], a[48:51], a[64:67], v[152:155]
    v_mfma_f32_16x16x32_bf16 v[156:159], a[48:51], a[68:71], v[156:159]
    v_mfma_f32_16x16x32_bf16 v[160:163], a[52:55], a[56:59], v[160:163]
    v_mfma_f32_16x16x32_bf16 v[164:167], a[52:55], a[60:63], v[164:167]
    v_mfma_f32_16x16x32_bf16 v[168:171], a[52:55], a[64:67], v[168:171]
    v_mfma_f32_16x16x32_bf16 v[172:175], a[52:55], a[68:71], v[172:175]
    s_add_u32 s16, s11, 13312
    buffer_load_dwordx4 a[36:39], v2, s[4:7], s16 offen
    s_add_u32 s16, s11, 144384
    buffer_load_dwordx4 a[40:43], v2, s[4:7], s16 offen
    s_add_u32 s16, s11, 275456
    buffer_load_dwordx4 a[44:47], v2, s[4:7], s16 offen
    s_add_u32 s16, s11, 406528
    buffer_load_dwordx4 a[48:51], v2, s[4:7], s16 offen
    s_add_u32 s16, s11, 537600
    buffer_load_dwordx4 a[52:55], v2, s[4:7], s16 offen
    s_add_u32 s16, s14, 1573888
    buffer_load_dwordx4 a[56:59], v2, s[4:7], s16 offen
    s_add_u32 s16, s14, 1577984
    buffer_load_dwordx4 a[60:63], v2, s[4:7], s16 offen
    s_add_u32 s16, s14, 1582080
    buffer_load_dwordx4 a[64:67], v2, s[4:7], s16 offen
    s_add_u32 s16, s14, 1586176
    buffer_load_dwordx4 a[68:71], v2, s[4:7], s16 offen
    s_waitcnt vmcnt(45)
    v_mfma_f32_16x16x32_bf16 v[96:99], a[72:75], a[92:95], v[96:99]
    v_mfma_f32_16x16x32_bf16 v[100:103], a[72:75], a[96:99], v[100:103]
    v_mfma_f32_16x16x32_bf16 v[104:107], a[72:75], a[100:103], v[104:107]
    v_mfma_f32_16x16x32_bf16 v[108:111], a[72:75], a[104:107], v[108:111]
    v_mfma_f32_16x16x32_bf16 v[112:115], a[76:79], a[92:95], v[112:115]
    v_mfma_f32_16x16x32_bf16 v[116:119], a[76:79], a[96:99], v[116:119]
    v_mfma_f32_16x16x32_bf16 v[120:123], a[76:79], a[100:103], v[120:123]
    v_mfma_f32_16x16x32_bf16 v[124:127], a[76:79], a[104:107], v[124:127]
    v_mfma_f32_16x16x32_bf16 v[128:131], a[80:83], a[92:95], v[128:131]
    v_mfma_f32_16x16x32_bf16 v[132:135], a[80:83], a[96:99], v[132:135]
    v_mfma_f32_16x16x32_bf16 v[136:139], a[80:83], a[100:103], v[136:139]
    v_mfma_f32_16x16x32_bf16 v[140:143], a[80:83], a[104:107], v[140:143]
    v_mfma_f32_16x16x32_bf16 v[144:147], a[84:87], a[92:95], v[144:147]
    v_mfma_f32_16x16x32_bf16 v[148:151], a[84:87], a[96:99], v[148:151]
    v_mfma_f32_16x16x32_bf16 v[152:155], a[84:87], a[100:103], v[152:155]
    v_mfma_f32_16x16x32_bf16 v[156:159], a[84:87], a[104:107], v[156:159]
    v_mfma_f32_16x16x32_bf16 v[160:163], a[88:91], a[92:95], v[160:163]
    v_mfma_f32_16x16x32_bf16 v[164:167], a[88:91], a[96:99], v[164:167]
    v_mfma_f32_16x16x32_bf16 v[168:171], a[88:91], a[100:103], v[168:171]
    v_mfma_f32_16x16x32_bf16 v[172:175], a[88:91], a[104:107], v[172:175]
    s_add_u32 s16, s11, 14336
    buffer_load_dwordx4 a[72:75], v2, s[4:7], s16 offen
    s_add_u32 s16, s11, 145408
    buffer_load_dwordx4 a[76:79], v2, s[4:7], s16 offen
    s_add_u32 s16, s11, 276480
    buffer_load_dwordx4 a[80:83], v2, s[4:7], s16 offen
    s_add_u32 s16, s11, 407552
    buffer_load_dwordx4 a[84:87], v2, s[4:7], s16 offen
    s_add_u32 s16, s11, 538624
    buffer_load_dwordx4 a[88:91], v2, s[4:7], s16 offen
    s_add_u32 s16, s14, 1574912
    buffer_load_dwordx4 a[92:95], v2, s[4:7], s16 offen
    s_add_u32 s16, s14, 1579008
    buffer_load_dwordx4 a[96:99], v2, s[4:7], s16 offen
    s_add_u32 s16, s14, 1583104
    buffer_load_dwordx4 a[100:103], v2, s[4:7], s16 offen
    s_add_u32 s16, s14, 1587200
    buffer_load_dwordx4 a[104:107], v2, s[4:7], s16 offen
    s_waitcnt vmcnt(45)
    v_mfma_f32_16x16x32_bf16 v[96:99], a[108:111], a[128:131], v[96:99]
    v_mfma_f32_16x16x32_bf16 v[100:103], a[108:111], a[132:135], v[100:103]
    v_mfma_f32_16x16x32_bf16 v[104:107], a[108:111], a[136:139], v[104:107]
    v_mfma_f32_16x16x32_bf16 v[108:111], a[108:111], a[140:143], v[108:111]
    v_mfma_f32_16x16x32_bf16 v[112:115], a[112:115], a[128:131], v[112:115]
    v_mfma_f32_16x16x32_bf16 v[116:119], a[112:115], a[132:135], v[116:119]
    v_mfma_f32_16x16x32_bf16 v[120:123], a[112:115], a[136:139], v[120:123]
    v_mfma_f32_16x16x32_bf16 v[124:127], a[112:115], a[140:143], v[124:127]
    v_mfma_f32_16x16x32_bf16 v[128:131], a[116:119], a[128:131], v[128:131]
    v_mfma_f32_16x16x32_bf16 v[132:135], a[116:119], a[132:135], v[132:135]
    v_mfma_f32_16x16x32_bf16 v[136:139], a[116:119], a[136:139], v[136:139]
    v_mfma_f32_16x16x32_bf16 v[140:143], a[116:119], a[140:143], v[140:143]
    v_mfma_f32_16x16x32_bf16 v[144:147], a[120:123], a[128:131], v[144:147]
    v_mfma_f32_16x16x32_bf16 v[148:151], a[120:123], a[132:135], v[148:151]
    v_mfma_f32_16x16x32_bf16 v[152:155], a[120:123], a[136:139], v[152:155]
    v_mfma_f32_16x16x32_bf16 v[156:159], a[120:123], a[140:143], v[156:159]
    v_mfma_f32_16x16x32_bf16 v[160:163], a[124:127], a[128:131], v[160:163]
    v_mfma_f32_16x16x32_bf16 v[164:167], a[124:127], a[132:135], v[164:167]
    v_mfma_f32_16x16x32_bf16 v[168:171], a[124:127], a[136:139], v[168:171]
    v_mfma_f32_16x16x32_bf16 v[172:175], a[124:127], a[140:143], v[172:175]
    s_add_u32 s16, s11, 15360
    buffer_load_dwordx4 a[108:111], v2, s[4:7], s16 offen
    s_add_u32 s16, s11, 146432
    buffer_load_dwordx4 a[112:115], v2, s[4:7], s16 offen
    s_add_u32 s16, s11, 277504
    buffer_load_dwordx4 a[116:119], v2, s[4:7], s16 offen
    s_add_u32 s16, s11, 408576
    buffer_load_dwordx4 a[120:123], v2, s[4:7], s16 offen
    s_add_u32 s16, s11, 539648
    buffer_load_dwordx4 a[124:127], v2, s[4:7], s16 offen
    s_add_u32 s16, s14, 1575936
    buffer_load_dwordx4 a[128:131], v2, s[4:7], s16 offen
    s_add_u32 s16, s14, 1580032
    buffer_load_dwordx4 a[132:135], v2, s[4:7], s16 offen
    s_add_u32 s16, s14, 1584128
    buffer_load_dwordx4 a[136:139], v2, s[4:7], s16 offen
    s_add_u32 s16, s14, 1588224
    buffer_load_dwordx4 a[140:143], v2, s[4:7], s16 offen
    s_waitcnt vmcnt(45)
    v_mfma_f32_16x16x32_bf16 v[96:99], a[144:147], a[164:167], v[96:99]
    v_mfma_f32_16x16x32_bf16 v[100:103], a[144:147], a[168:171], v[100:103]
    v_mfma_f32_16x16x32_bf16 v[104:107], a[144:147], a[172:175], v[104:107]
    v_mfma_f32_16x16x32_bf16 v[108:111], a[144:147], a[176:179], v[108:111]
    v_mfma_f32_16x16x32_bf16 v[112:115], a[148:151], a[164:167], v[112:115]
    v_mfma_f32_16x16x32_bf16 v[116:119], a[148:151], a[168:171], v[116:119]
    v_mfma_f32_16x16x32_bf16 v[120:123], a[148:151], a[172:175], v[120:123]
    v_mfma_f32_16x16x32_bf16 v[124:127], a[148:151], a[176:179], v[124:127]
    v_mfma_f32_16x16x32_bf16 v[128:131], a[152:155], a[164:167], v[128:131]
    v_mfma_f32_16x16x32_bf16 v[132:135], a[152:155], a[168:171], v[132:135]
    v_mfma_f32_16x16x32_bf16 v[136:139], a[152:155], a[172:175], v[136:139]
    v_mfma_f32_16x16x32_bf16 v[140:143], a[152:155], a[176:179], v[140:143]
    v_mfma_f32_16x16x32_bf16 v[144:147], a[156:159], a[164:167], v[144:147]
    v_mfma_f32_16x16x32_bf16 v[148:151], a[156:159], a[168:171], v[148:151]
    v_mfma_f32_16x16x32_bf16 v[152:155], a[156:159], a[172:175], v[152:155]
    v_mfma_f32_16x16x32_bf16 v[156:159], a[156:159], a[176:179], v[156:159]
    v_mfma_f32_16x16x32_bf16 v[160:163], a[160:163], a[164:167], v[160:163]
    v_mfma_f32_16x16x32_bf16 v[164:167], a[160:163], a[168:171], v[164:167]
    v_mfma_f32_16x16x32_bf16 v[168:171], a[160:163], a[172:175], v[168:171]
    v_mfma_f32_16x16x32_bf16 v[172:175], a[160:163], a[176:179], v[172:175]
    s_add_u32 s16, s11, 16384
    buffer_load_dwordx4 a[144:147], v2, s[4:7], s16 offen
    s_add_u32 s16, s11, 147456
    buffer_load_dwordx4 a[148:151], v2, s[4:7], s16 offen
    s_add_u32 s16, s11, 278528
    buffer_load_dwordx4 a[152:155], v2, s[4:7], s16 offen
    s_add_u32 s16, s11, 409600
    buffer_load_dwordx4 a[156:159], v2, s[4:7], s16 offen
    s_add_u32 s16, s11, 540672
    buffer_load_dwordx4 a[160:163], v2, s[4:7], s16 offen
    s_add_u32 s16, s12, 2097152
    buffer_load_dwordx4 a[164:167], v2, s[4:7], s16 offen
    s_add_u32 s16, s12, 2101248
    buffer_load_dwordx4 a[168:171], v2, s[4:7], s16 offen
    s_add_u32 s16, s12, 2105344
    buffer_load_dwordx4 a[172:175], v2, s[4:7], s16 offen
    s_add_u32 s16, s12, 2109440
    buffer_load_dwordx4 a[176:179], v2, s[4:7], s16 offen
    s_waitcnt vmcnt(45)
    v_mfma_f32_16x16x32_bf16 v[96:99], a[180:183], a[200:203], v[96:99]
    v_mfma_f32_16x16x32_bf16 v[100:103], a[180:183], a[204:207], v[100:103]
    v_mfma_f32_16x16x32_bf16 v[104:107], a[180:183], a[208:211], v[104:107]
    v_mfma_f32_16x16x32_bf16 v[108:111], a[180:183], a[212:215], v[108:111]
    v_mfma_f32_16x16x32_bf16 v[112:115], a[184:187], a[200:203], v[112:115]
    v_mfma_f32_16x16x32_bf16 v[116:119], a[184:187], a[204:207], v[116:119]
    v_mfma_f32_16x16x32_bf16 v[120:123], a[184:187], a[208:211], v[120:123]
    v_mfma_f32_16x16x32_bf16 v[124:127], a[184:187], a[212:215], v[124:127]
    v_mfma_f32_16x16x32_bf16 v[128:131], a[188:191], a[200:203], v[128:131]
    v_mfma_f32_16x16x32_bf16 v[132:135], a[188:191], a[204:207], v[132:135]
    v_mfma_f32_16x16x32_bf16 v[136:139], a[188:191], a[208:211], v[136:139]
    v_mfma_f32_16x16x32_bf16 v[140:143], a[188:191], a[212:215], v[140:143]
    v_mfma_f32_16x16x32_bf16 v[144:147], a[192:195], a[200:203], v[144:147]
    v_mfma_f32_16x16x32_bf16 v[148:151], a[192:195], a[204:207], v[148:151]
    v_mfma_f32_16x16x32_bf16 v[152:155], a[192:195], a[208:211], v[152:155]
    v_mfma_f32_16x16x32_bf16 v[156:159], a[192:195], a[212:215], v[156:159]
    v_mfma_f32_16x16x32_bf16 v[160:163], a[196:199], a[200:203], v[160:163]
    v_mfma_f32_16x16x32_bf16 v[164:167], a[196:199], a[204:207], v[164:167]
    v_mfma_f32_16x16x32_bf16 v[168:171], a[196:199], a[208:211], v[168:171]
    v_mfma_f32_16x16x32_bf16 v[172:175], a[196:199], a[212:215], v[172:175]
    s_add_u32 s16, s11, 17408
    buffer_load_dwordx4 a[180:183], v2, s[4:7], s16 offen
    s_add_u32 s16, s11, 148480
    buffer_load_dwordx4 a[184:187], v2, s[4:7], s16 offen
    s_add_u32 s16, s11, 279552
    buffer_load_dwordx4 a[188:191], v2, s[4:7], s16 offen
    s_add_u32 s16, s11, 410624
    buffer_load_dwordx4 a[192:195], v2, s[4:7], s16 offen
    s_add_u32 s16, s11, 541696
    buffer_load_dwordx4 a[196:199], v2, s[4:7], s16 offen
    s_add_u32 s16, s12, 2098176
    buffer_load_dwordx4 a[200:203], v2, s[4:7], s16 offen
    s_add_u32 s16, s12, 2102272
    buffer_load_dwordx4 a[204:207], v2, s[4:7], s16 offen
    s_add_u32 s16, s12, 2106368
    buffer_load_dwordx4 a[208:211], v2, s[4:7], s16 offen
    s_add_u32 s16, s12, 2110464
    buffer_load_dwordx4 a[212:215], v2, s[4:7], s16 offen
    s_waitcnt vmcnt(45)
    v_mfma_f32_16x16x32_bf16 v[96:99], a[0:3], a[20:23], v[96:99]
    v_mfma_f32_16x16x32_bf16 v[100:103], a[0:3], a[24:27], v[100:103]
    v_mfma_f32_16x16x32_bf16 v[104:107], a[0:3], a[28:31], v[104:107]
    v_mfma_f32_16x16x32_bf16 v[108:111], a[0:3], a[32:35], v[108:111]
    v_mfma_f32_16x16x32_bf16 v[112:115], a[4:7], a[20:23], v[112:115]
    v_mfma_f32_16x16x32_bf16 v[116:119], a[4:7], a[24:27], v[116:119]
    v_mfma_f32_16x16x32_bf16 v[120:123], a[4:7], a[28:31], v[120:123]
    v_mfma_f32_16x16x32_bf16 v[124:127], a[4:7], a[32:35], v[124:127]
    v_mfma_f32_16x16x32_bf16 v[128:131], a[8:11], a[20:23], v[128:131]
    v_mfma_f32_16x16x32_bf16 v[132:135], a[8:11], a[24:27], v[132:135]
    v_mfma_f32_16x16x32_bf16 v[136:139], a[8:11], a[28:31], v[136:139]
    v_mfma_f32_16x16x32_bf16 v[140:143], a[8:11], a[32:35], v[140:143]
    v_mfma_f32_16x16x32_bf16 v[144:147], a[12:15], a[20:23], v[144:147]
    v_mfma_f32_16x16x32_bf16 v[148:151], a[12:15], a[24:27], v[148:151]
    v_mfma_f32_16x16x32_bf16 v[152:155], a[12:15], a[28:31], v[152:155]
    v_mfma_f32_16x16x32_bf16 v[156:159], a[12:15], a[32:35], v[156:159]
    v_mfma_f32_16x16x32_bf16 v[160:163], a[16:19], a[20:23], v[160:163]
    v_mfma_f32_16x16x32_bf16 v[164:167], a[16:19], a[24:27], v[164:167]
    v_mfma_f32_16x16x32_bf16 v[168:171], a[16:19], a[28:31], v[168:171]
    v_mfma_f32_16x16x32_bf16 v[172:175], a[16:19], a[32:35], v[172:175]
    s_add_u32 s16, s11, 18432
    buffer_load_dwordx4 a[0:3], v2, s[4:7], s16 offen
    s_add_u32 s16, s11, 149504
    buffer_load_dwordx4 a[4:7], v2, s[4:7], s16 offen
    s_add_u32 s16, s11, 280576
    buffer_load_dwordx4 a[8:11], v2, s[4:7], s16 offen
    s_add_u32 s16, s11, 411648
    buffer_load_dwordx4 a[12:15], v2, s[4:7], s16 offen
    s_add_u32 s16, s11, 542720
    buffer_load_dwordx4 a[16:19], v2, s[4:7], s16 offen
    s_add_u32 s16, s12, 2099200
    buffer_load_dwordx4 a[20:23], v2, s[4:7], s16 offen
    s_add_u32 s16, s12, 2103296
    buffer_load_dwordx4 a[24:27], v2, s[4:7], s16 offen
    s_add_u32 s16, s12, 2107392
    buffer_load_dwordx4 a[28:31], v2, s[4:7], s16 offen
    s_add_u32 s16, s12, 2111488
    buffer_load_dwordx4 a[32:35], v2, s[4:7], s16 offen
    s_waitcnt vmcnt(45)
    v_mfma_f32_16x16x32_bf16 v[96:99], a[36:39], a[56:59], v[96:99]
    v_mfma_f32_16x16x32_bf16 v[100:103], a[36:39], a[60:63], v[100:103]
    v_mfma_f32_16x16x32_bf16 v[104:107], a[36:39], a[64:67], v[104:107]
    v_mfma_f32_16x16x32_bf16 v[108:111], a[36:39], a[68:71], v[108:111]
    v_mfma_f32_16x16x32_bf16 v[112:115], a[40:43], a[56:59], v[112:115]
    v_mfma_f32_16x16x32_bf16 v[116:119], a[40:43], a[60:63], v[116:119]
    v_mfma_f32_16x16x32_bf16 v[120:123], a[40:43], a[64:67], v[120:123]
    v_mfma_f32_16x16x32_bf16 v[124:127], a[40:43], a[68:71], v[124:127]
    v_mfma_f32_16x16x32_bf16 v[128:131], a[44:47], a[56:59], v[128:131]
    v_mfma_f32_16x16x32_bf16 v[132:135], a[44:47], a[60:63], v[132:135]
    v_mfma_f32_16x16x32_bf16 v[136:139], a[44:47], a[64:67], v[136:139]
    v_mfma_f32_16x16x32_bf16 v[140:143], a[44:47], a[68:71], v[140:143]
    v_mfma_f32_16x16x32_bf16 v[144:147], a[48:51], a[56:59], v[144:147]
    v_mfma_f32_16x16x32_bf16 v[148:151], a[48:51], a[60:63], v[148:151]
    v_mfma_f32_16x16x32_bf16 v[152:155], a[48:51], a[64:67], v[152:155]
    v_mfma_f32_16x16x32_bf16 v[156:159], a[48:51], a[68:71], v[156:159]
    v_mfma_f32_16x16x32_bf16 v[160:163], a[52:55], a[56:59], v[160:163]
    v_mfma_f32_16x16x32_bf16 v[164:167], a[52:55], a[60:63], v[164:167]
    v_mfma_f32_16x16x32_bf16 v[168:171], a[52:55], a[64:67], v[168:171]
    v_mfma_f32_16x16x32_bf16 v[172:175], a[52:55], a[68:71], v[172:175]
    s_add_u32 s16, s11, 19456
    buffer_load_dwordx4 a[36:39], v2, s[4:7], s16 offen
    s_add_u32 s16, s11, 150528
    buffer_load_dwordx4 a[40:43], v2, s[4:7], s16 offen
    s_add_u32 s16, s11, 281600
    buffer_load_dwordx4 a[44:47], v2, s[4:7], s16 offen
    s_add_u32 s16, s11, 412672
    buffer_load_dwordx4 a[48:51], v2, s[4:7], s16 offen
    s_add_u32 s16, s11, 543744
    buffer_load_dwordx4 a[52:55], v2, s[4:7], s16 offen
    s_add_u32 s16, s12, 2100224
    buffer_load_dwordx4 a[56:59], v2, s[4:7], s16 offen
    s_add_u32 s16, s12, 2104320
    buffer_load_dwordx4 a[60:63], v2, s[4:7], s16 offen
    s_add_u32 s16, s12, 2108416
    buffer_load_dwordx4 a[64:67], v2, s[4:7], s16 offen
    s_add_u32 s16, s12, 2112512
    buffer_load_dwordx4 a[68:71], v2, s[4:7], s16 offen
    s_waitcnt vmcnt(45)
    v_mfma_f32_16x16x32_bf16 v[96:99], a[72:75], a[92:95], v[96:99]
    v_mfma_f32_16x16x32_bf16 v[100:103], a[72:75], a[96:99], v[100:103]
    v_mfma_f32_16x16x32_bf16 v[104:107], a[72:75], a[100:103], v[104:107]
    v_mfma_f32_16x16x32_bf16 v[108:111], a[72:75], a[104:107], v[108:111]
    v_mfma_f32_16x16x32_bf16 v[112:115], a[76:79], a[92:95], v[112:115]
    v_mfma_f32_16x16x32_bf16 v[116:119], a[76:79], a[96:99], v[116:119]
    v_mfma_f32_16x16x32_bf16 v[120:123], a[76:79], a[100:103], v[120:123]
    v_mfma_f32_16x16x32_bf16 v[124:127], a[76:79], a[104:107], v[124:127]
    v_mfma_f32_16x16x32_bf16 v[128:131], a[80:83], a[92:95], v[128:131]
    v_mfma_f32_16x16x32_bf16 v[132:135], a[80:83], a[96:99], v[132:135]
    v_mfma_f32_16x16x32_bf16 v[136:139], a[80:83], a[100:103], v[136:139]
    v_mfma_f32_16x16x32_bf16 v[140:143], a[80:83], a[104:107], v[140:143]
    v_mfma_f32_16x16x32_bf16 v[144:147], a[84:87], a[92:95], v[144:147]
    v_mfma_f32_16x16x32_bf16 v[148:151], a[84:87], a[96:99], v[148:151]
    v_mfma_f32_16x16x32_bf16 v[152:155], a[84:87], a[100:103], v[152:155]
    v_mfma_f32_16x16x32_bf16 v[156:159], a[84:87], a[104:107], v[156:159]
    v_mfma_f32_16x16x32_bf16 v[160:163], a[88:91], a[92:95], v[160:163]
    v_mfma_f32_16x16x32_bf16 v[164:167], a[88:91], a[96:99], v[164:167]
    v_mfma_f32_16x16x32_bf16 v[168:171], a[88:91], a[100:103], v[168:171]
    v_mfma_f32_16x16x32_bf16 v[172:175], a[88:91], a[104:107], v[172:175]
    s_add_u32 s16, s11, 20480
    buffer_load_dwordx4 a[72:75], v2, s[4:7], s16 offen
    s_add_u32 s16, s11, 151552
    buffer_load_dwordx4 a[76:79], v2, s[4:7], s16 offen
    s_add_u32 s16, s11, 282624
    buffer_load_dwordx4 a[80:83], v2, s[4:7], s16 offen
    s_add_u32 s16, s11, 413696
    buffer_load_dwordx4 a[84:87], v2, s[4:7], s16 offen
    s_add_u32 s16, s11, 544768
    buffer_load_dwordx4 a[88:91], v2, s[4:7], s16 offen
    s_add_u32 s16, s12, 2621440
    buffer_load_dwordx4 a[92:95], v2, s[4:7], s16 offen
    s_add_u32 s16, s12, 2625536
    buffer_load_dwordx4 a[96:99], v2, s[4:7], s16 offen
    s_add_u32 s16, s12, 2629632
    buffer_load_dwordx4 a[100:103], v2, s[4:7], s16 offen
    s_add_u32 s16, s12, 2633728
    buffer_load_dwordx4 a[104:107], v2, s[4:7], s16 offen
    s_waitcnt vmcnt(45)
    v_mfma_f32_16x16x32_bf16 v[96:99], a[108:111], a[128:131], v[96:99]
    v_mfma_f32_16x16x32_bf16 v[100:103], a[108:111], a[132:135], v[100:103]
    v_mfma_f32_16x16x32_bf16 v[104:107], a[108:111], a[136:139], v[104:107]
    v_mfma_f32_16x16x32_bf16 v[108:111], a[108:111], a[140:143], v[108:111]
    v_mfma_f32_16x16x32_bf16 v[112:115], a[112:115], a[128:131], v[112:115]
    v_mfma_f32_16x16x32_bf16 v[116:119], a[112:115], a[132:135], v[116:119]
    v_mfma_f32_16x16x32_bf16 v[120:123], a[112:115], a[136:139], v[120:123]
    v_mfma_f32_16x16x32_bf16 v[124:127], a[112:115], a[140:143], v[124:127]
    v_mfma_f32_16x16x32_bf16 v[128:131], a[116:119], a[128:131], v[128:131]
    v_mfma_f32_16x16x32_bf16 v[132:135], a[116:119], a[132:135], v[132:135]
    v_mfma_f32_16x16x32_bf16 v[136:139], a[116:119], a[136:139], v[136:139]
    v_mfma_f32_16x16x32_bf16 v[140:143], a[116:119], a[140:143], v[140:143]
    v_mfma_f32_16x16x32_bf16 v[144:147], a[120:123], a[128:131], v[144:147]
    v_mfma_f32_16x16x32_bf16 v[148:151], a[120:123], a[132:135], v[148:151]
    v_mfma_f32_16x16x32_bf16 v[152:155], a[120:123], a[136:139], v[152:155]
    v_mfma_f32_16x16x32_bf16 v[156:159], a[120:123], a[140:143], v[156:159]
    v_mfma_f32_16x16x32_bf16 v[160:163], a[124:127], a[128:131], v[160:163]
    v_mfma_f32_16x16x32_bf16 v[164:167], a[124:127], a[132:135], v[164:167]
    v_mfma_f32_16x16x32_bf16 v[168:171], a[124:127], a[136:139], v[168:171]
    v_mfma_f32_16x16x32_bf16 v[172:175], a[124:127], a[140:143], v[172:175]
    s_add_u32 s16, s11, 21504
    buffer_load_dwordx4 a[108:111], v2, s[4:7], s16 offen
    s_add_u32 s16, s11, 152576
    buffer_load_dwordx4 a[112:115], v2, s[4:7], s16 offen
    s_add_u32 s16, s11, 283648
    buffer_load_dwordx4 a[116:119], v2, s[4:7], s16 offen
    s_add_u32 s16, s11, 414720
    buffer_load_dwordx4 a[120:123], v2, s[4:7], s16 offen
    s_add_u32 s16, s11, 545792
    buffer_load_dwordx4 a[124:127], v2, s[4:7], s16 offen
    s_add_u32 s16, s12, 2622464
    buffer_load_dwordx4 a[128:131], v2, s[4:7], s16 offen
    s_add_u32 s16, s12, 2626560
    buffer_load_dwordx4 a[132:135], v2, s[4:7], s16 offen
    s_add_u32 s16, s12, 2630656
    buffer_load_dwordx4 a[136:139], v2, s[4:7], s16 offen
    s_add_u32 s16, s12, 2634752
    buffer_load_dwordx4 a[140:143], v2, s[4:7], s16 offen
    s_waitcnt vmcnt(45)
    v_mfma_f32_16x16x32_bf16 v[96:99], a[144:147], a[164:167], v[96:99]
    v_mfma_f32_16x16x32_bf16 v[100:103], a[144:147], a[168:171], v[100:103]
    v_mfma_f32_16x16x32_bf16 v[104:107], a[144:147], a[172:175], v[104:107]
    v_mfma_f32_16x16x32_bf16 v[108:111], a[144:147], a[176:179], v[108:111]
    v_mfma_f32_16x16x32_bf16 v[112:115], a[148:151], a[164:167], v[112:115]
    v_mfma_f32_16x16x32_bf16 v[116:119], a[148:151], a[168:171], v[116:119]
    v_mfma_f32_16x16x32_bf16 v[120:123], a[148:151], a[172:175], v[120:123]
    v_mfma_f32_16x16x32_bf16 v[124:127], a[148:151], a[176:179], v[124:127]
    v_mfma_f32_16x16x32_bf16 v[128:131], a[152:155], a[164:167], v[128:131]
    v_mfma_f32_16x16x32_bf16 v[132:135], a[152:155], a[168:171], v[132:135]
    v_mfma_f32_16x16x32_bf16 v[136:139], a[152:155], a[172:175], v[136:139]
    v_mfma_f32_16x16x32_bf16 v[140:143], a[152:155], a[176:179], v[140:143]
    v_mfma_f32_16x16x32_bf16 v[144:147], a[156:159], a[164:167], v[144:147]
    v_mfma_f32_16x16x32_bf16 v[148:151], a[156:159], a[168:171], v[148:151]
    v_mfma_f32_16x16x32_bf16 v[152:155], a[156:159], a[172:175], v[152:155]
    v_mfma_f32_16x16x32_bf16 v[156:159], a[156:159], a[176:179], v[156:159]
    v_mfma_f32_16x16x32_bf16 v[160:163], a[160:163], a[164:167], v[160:163]
    v_mfma_f32_16x16x32_bf16 v[164:167], a[160:163], a[168:171], v[164:167]
    v_mfma_f32_16x16x32_bf16 v[168:171], a[160:163], a[172:175], v[168:171]
    v_mfma_f32_16x16x32_bf16 v[172:175], a[160:163], a[176:179], v[172:175]
    s_add_u32 s16, s11, 22528
    buffer_load_dwordx4 a[144:147], v2, s[4:7], s16 offen
    s_add_u32 s16, s11, 153600
    buffer_load_dwordx4 a[148:151], v2, s[4:7], s16 offen
    s_add_u32 s16, s11, 284672
    buffer_load_dwordx4 a[152:155], v2, s[4:7], s16 offen
    s_add_u32 s16, s11, 415744
    buffer_load_dwordx4 a[156:159], v2, s[4:7], s16 offen
    s_add_u32 s16, s11, 546816
    buffer_load_dwordx4 a[160:163], v2, s[4:7], s16 offen
    s_add_u32 s16, s12, 2623488
    buffer_load_dwordx4 a[164:167], v2, s[4:7], s16 offen
    s_add_u32 s16, s12, 2627584
    buffer_load_dwordx4 a[168:171], v2, s[4:7], s16 offen
    s_add_u32 s16, s12, 2631680
    buffer_load_dwordx4 a[172:175], v2, s[4:7], s16 offen
    s_add_u32 s16, s12, 2635776
    buffer_load_dwordx4 a[176:179], v2, s[4:7], s16 offen
    s_waitcnt vmcnt(45)
    v_mfma_f32_16x16x32_bf16 v[96:99], a[180:183], a[200:203], v[96:99]
    v_mfma_f32_16x16x32_bf16 v[100:103], a[180:183], a[204:207], v[100:103]
    v_mfma_f32_16x16x32_bf16 v[104:107], a[180:183], a[208:211], v[104:107]
    v_mfma_f32_16x16x32_bf16 v[108:111], a[180:183], a[212:215], v[108:111]
    v_mfma_f32_16x16x32_bf16 v[112:115], a[184:187], a[200:203], v[112:115]
    v_mfma_f32_16x16x32_bf16 v[116:119], a[184:187], a[204:207], v[116:119]
    v_mfma_f32_16x16x32_bf16 v[120:123], a[184:187], a[208:211], v[120:123]
    v_mfma_f32_16x16x32_bf16 v[124:127], a[184:187], a[212:215], v[124:127]
    v_mfma_f32_16x16x32_bf16 v[128:131], a[188:191], a[200:203], v[128:131]
    v_mfma_f32_16x16x32_bf16 v[132:135], a[188:191], a[204:207], v[132:135]
    v_mfma_f32_16x16x32_bf16 v[136:139], a[188:191], a[208:211], v[136:139]
    v_mfma_f32_16x16x32_bf16 v[140:143], a[188:191], a[212:215], v[140:143]
    v_mfma_f32_16x16x32_bf16 v[144:147], a[192:195], a[200:203], v[144:147]
    v_mfma_f32_16x16x32_bf16 v[148:151], a[192:195], a[204:207], v[148:151]
    v_mfma_f32_16x16x32_bf16 v[152:155], a[192:195], a[208:211], v[152:155]
    v_mfma_f32_16x16x32_bf16 v[156:159], a[192:195], a[212:215], v[156:159]
    v_mfma_f32_16x16x32_bf16 v[160:163], a[196:199], a[200:203], v[160:163]
    v_mfma_f32_16x16x32_bf16 v[164:167], a[196:199], a[204:207], v[164:167]
    v_mfma_f32_16x16x32_bf16 v[168:171], a[196:199], a[208:211], v[168:171]
    v_mfma_f32_16x16x32_bf16 v[172:175], a[196:199], a[212:215], v[172:175]
    s_add_u32 s16, s11, 23552
    buffer_load_dwordx4 a[180:183], v2, s[4:7], s16 offen
    s_add_u32 s16, s11, 154624
    buffer_load_dwordx4 a[184:187], v2, s[4:7], s16 offen
    s_add_u32 s16, s11, 285696
    buffer_load_dwordx4 a[188:191], v2, s[4:7], s16 offen
    s_add_u32 s16, s11, 416768
    buffer_load_dwordx4 a[192:195], v2, s[4:7], s16 offen
    s_add_u32 s16, s11, 547840
    buffer_load_dwordx4 a[196:199], v2, s[4:7], s16 offen
    s_add_u32 s16, s12, 2624512
    buffer_load_dwordx4 a[200:203], v2, s[4:7], s16 offen
    s_add_u32 s16, s12, 2628608
    buffer_load_dwordx4 a[204:207], v2, s[4:7], s16 offen
    s_add_u32 s16, s12, 2632704
    buffer_load_dwordx4 a[208:211], v2, s[4:7], s16 offen
    s_add_u32 s16, s12, 2636800
    buffer_load_dwordx4 a[212:215], v2, s[4:7], s16 offen
    s_waitcnt vmcnt(45)
    v_mfma_f32_16x16x32_bf16 v[96:99], a[0:3], a[20:23], v[96:99]
    v_mfma_f32_16x16x32_bf16 v[100:103], a[0:3], a[24:27], v[100:103]
    v_mfma_f32_16x16x32_bf16 v[104:107], a[0:3], a[28:31], v[104:107]
    v_mfma_f32_16x16x32_bf16 v[108:111], a[0:3], a[32:35], v[108:111]
    v_mfma_f32_16x16x32_bf16 v[112:115], a[4:7], a[20:23], v[112:115]
    v_mfma_f32_16x16x32_bf16 v[116:119], a[4:7], a[24:27], v[116:119]
    v_mfma_f32_16x16x32_bf16 v[120:123], a[4:7], a[28:31], v[120:123]
    v_mfma_f32_16x16x32_bf16 v[124:127], a[4:7], a[32:35], v[124:127]
    v_mfma_f32_16x16x32_bf16 v[128:131], a[8:11], a[20:23], v[128:131]
    v_mfma_f32_16x16x32_bf16 v[132:135], a[8:11], a[24:27], v[132:135]
    v_mfma_f32_16x16x32_bf16 v[136:139], a[8:11], a[28:31], v[136:139]
    v_mfma_f32_16x16x32_bf16 v[140:143], a[8:11], a[32:35], v[140:143]
    v_mfma_f32_16x16x32_bf16 v[144:147], a[12:15], a[20:23], v[144:147]
    v_mfma_f32_16x16x32_bf16 v[148:151], a[12:15], a[24:27], v[148:151]
    v_mfma_f32_16x16x32_bf16 v[152:155], a[12:15], a[28:31], v[152:155]
    v_mfma_f32_16x16x32_bf16 v[156:159], a[12:15], a[32:35], v[156:159]
    v_mfma_f32_16x16x32_bf16 v[160:163], a[16:19], a[20:23], v[160:163]
    v_mfma_f32_16x16x32_bf16 v[164:167], a[16:19], a[24:27], v[164:167]
    v_mfma_f32_16x16x32_bf16 v[168:171], a[16:19], a[28:31], v[168:171]
    v_mfma_f32_16x16x32_bf16 v[172:175], a[16:19], a[32:35], v[172:175]
    s_add_u32 s16, s11, 24576
    buffer_load_dwordx4 a[0:3], v2, s[4:7], s16 offen
    s_add_u32 s16, s11, 155648
    buffer_load_dwordx4 a[4:7], v2, s[4:7], s16 offen
    s_add_u32 s16, s11, 286720
    buffer_load_dwordx4 a[8:11], v2, s[4:7], s16 offen
    s_add_u32 s16, s11, 417792
    buffer_load_dwordx4 a[12:15], v2, s[4:7], s16 offen
    s_add_u32 s16, s11, 548864
    buffer_load_dwordx4 a[16:19], v2, s[4:7], s16 offen
    s_add_u32 s16, s14, 3145728
    buffer_load_dwordx4 a[20:23], v2, s[4:7], s16 offen
    s_add_u32 s16, s14, 3149824
    buffer_load_dwordx4 a[24:27], v2, s[4:7], s16 offen
    s_add_u32 s16, s14, 3153920
    buffer_load_dwordx4 a[28:31], v2, s[4:7], s16 offen
    s_add_u32 s16, s14, 3158016
    buffer_load_dwordx4 a[32:35], v2, s[4:7], s16 offen
    s_waitcnt vmcnt(45)
    v_mfma_f32_16x16x32_bf16 v[96:99], a[36:39], a[56:59], v[96:99]
    v_mfma_f32_16x16x32_bf16 v[100:103], a[36:39], a[60:63], v[100:103]
    v_mfma_f32_16x16x32_bf16 v[104:107], a[36:39], a[64:67], v[104:107]
    v_mfma_f32_16x16x32_bf16 v[108:111], a[36:39], a[68:71], v[108:111]
    v_mfma_f32_16x16x32_bf16 v[112:115], a[40:43], a[56:59], v[112:115]
    v_mfma_f32_16x16x32_bf16 v[116:119], a[40:43], a[60:63], v[116:119]
    v_mfma_f32_16x16x32_bf16 v[120:123], a[40:43], a[64:67], v[120:123]
    v_mfma_f32_16x16x32_bf16 v[124:127], a[40:43], a[68:71], v[124:127]
    v_mfma_f32_16x16x32_bf16 v[128:131], a[44:47], a[56:59], v[128:131]
    v_mfma_f32_16x16x32_bf16 v[132:135], a[44:47], a[60:63], v[132:135]
    v_mfma_f32_16x16x32_bf16 v[136:139], a[44:47], a[64:67], v[136:139]
    v_mfma_f32_16x16x32_bf16 v[140:143], a[44:47], a[68:71], v[140:143]
    v_mfma_f32_16x16x32_bf16 v[144:147], a[48:51], a[56:59], v[144:147]
    v_mfma_f32_16x16x32_bf16 v[148:151], a[48:51], a[60:63], v[148:151]
    v_mfma_f32_16x16x32_bf16 v[152:155], a[48:51], a[64:67], v[152:155]
    v_mfma_f32_16x16x32_bf16 v[156:159], a[48:51], a[68:71], v[156:159]
    v_mfma_f32_16x16x32_bf16 v[160:163], a[52:55], a[56:59], v[160:163]
    v_mfma_f32_16x16x32_bf16 v[164:167], a[52:55], a[60:63], v[164:167]
    v_mfma_f32_16x16x32_bf16 v[168:171], a[52:55], a[64:67], v[168:171]
    v_mfma_f32_16x16x32_bf16 v[172:175], a[52:55], a[68:71], v[172:175]
    s_add_u32 s16, s11, 25600
    buffer_load_dwordx4 a[36:39], v2, s[4:7], s16 offen
    s_add_u32 s16, s11, 156672
    buffer_load_dwordx4 a[40:43], v2, s[4:7], s16 offen
    s_add_u32 s16, s11, 287744
    buffer_load_dwordx4 a[44:47], v2, s[4:7], s16 offen
    s_add_u32 s16, s11, 418816
    buffer_load_dwordx4 a[48:51], v2, s[4:7], s16 offen
    s_add_u32 s16, s11, 549888
    buffer_load_dwordx4 a[52:55], v2, s[4:7], s16 offen
    s_add_u32 s16, s14, 3146752
    buffer_load_dwordx4 a[56:59], v2, s[4:7], s16 offen
    s_add_u32 s16, s14, 3150848
    buffer_load_dwordx4 a[60:63], v2, s[4:7], s16 offen
    s_add_u32 s16, s14, 3154944
    buffer_load_dwordx4 a[64:67], v2, s[4:7], s16 offen
    s_add_u32 s16, s14, 3159040
    buffer_load_dwordx4 a[68:71], v2, s[4:7], s16 offen
    s_waitcnt vmcnt(45)
    v_mfma_f32_16x16x32_bf16 v[96:99], a[72:75], a[92:95], v[96:99]
    v_mfma_f32_16x16x32_bf16 v[100:103], a[72:75], a[96:99], v[100:103]
    v_mfma_f32_16x16x32_bf16 v[104:107], a[72:75], a[100:103], v[104:107]
    v_mfma_f32_16x16x32_bf16 v[108:111], a[72:75], a[104:107], v[108:111]
    v_mfma_f32_16x16x32_bf16 v[112:115], a[76:79], a[92:95], v[112:115]
    v_mfma_f32_16x16x32_bf16 v[116:119], a[76:79], a[96:99], v[116:119]
    v_mfma_f32_16x16x32_bf16 v[120:123], a[76:79], a[100:103], v[120:123]
    v_mfma_f32_16x16x32_bf16 v[124:127], a[76:79], a[104:107], v[124:127]
    v_mfma_f32_16x16x32_bf16 v[128:131], a[80:83], a[92:95], v[128:131]
    v_mfma_f32_16x16x32_bf16 v[132:135], a[80:83], a[96:99], v[132:135]
    v_mfma_f32_16x16x32_bf16 v[136:139], a[80:83], a[100:103], v[136:139]
    v_mfma_f32_16x16x32_bf16 v[140:143], a[80:83], a[104:107], v[140:143]
    v_mfma_f32_16x16x32_bf16 v[144:147], a[84:87], a[92:95], v[144:147]
    v_mfma_f32_16x16x32_bf16 v[148:151], a[84:87], a[96:99], v[148:151]
    v_mfma_f32_16x16x32_bf16 v[152:155], a[84:87], a[100:103], v[152:155]
    v_mfma_f32_16x16x32_bf16 v[156:159], a[84:87], a[104:107], v[156:159]
    v_mfma_f32_16x16x32_bf16 v[160:163], a[88:91], a[92:95], v[160:163]
    v_mfma_f32_16x16x32_bf16 v[164:167], a[88:91], a[96:99], v[164:167]
    v_mfma_f32_16x16x32_bf16 v[168:171], a[88:91], a[100:103], v[168:171]
    v_mfma_f32_16x16x32_bf16 v[172:175], a[88:91], a[104:107], v[172:175]
    s_add_u32 s16, s11, 26624
    buffer_load_dwordx4 a[72:75], v2, s[4:7], s16 offen
    s_add_u32 s16, s11, 157696
    buffer_load_dwordx4 a[76:79], v2, s[4:7], s16 offen
    s_add_u32 s16, s11, 288768
    buffer_load_dwordx4 a[80:83], v2, s[4:7], s16 offen
    s_add_u32 s16, s11, 419840
    buffer_load_dwordx4 a[84:87], v2, s[4:7], s16 offen
    s_add_u32 s16, s11, 550912
    buffer_load_dwordx4 a[88:91], v2, s[4:7], s16 offen
    s_add_u32 s16, s14, 3147776
    buffer_load_dwordx4 a[92:95], v2, s[4:7], s16 offen
    s_add_u32 s16, s14, 3151872
    buffer_load_dwordx4 a[96:99], v2, s[4:7], s16 offen
    s_add_u32 s16, s14, 3155968
    buffer_load_dwordx4 a[100:103], v2, s[4:7], s16 offen
    s_add_u32 s16, s14, 3160064
    buffer_load_dwordx4 a[104:107], v2, s[4:7], s16 offen
    s_waitcnt vmcnt(45)
    v_mfma_f32_16x16x32_bf16 v[96:99], a[108:111], a[128:131], v[96:99]
    v_mfma_f32_16x16x32_bf16 v[100:103], a[108:111], a[132:135], v[100:103]
    v_mfma_f32_16x16x32_bf16 v[104:107], a[108:111], a[136:139], v[104:107]
    v_mfma_f32_16x16x32_bf16 v[108:111], a[108:111], a[140:143], v[108:111]
    v_mfma_f32_16x16x32_bf16 v[112:115], a[112:115], a[128:131], v[112:115]
    v_mfma_f32_16x16x32_bf16 v[116:119], a[112:115], a[132:135], v[116:119]
    v_mfma_f32_16x16x32_bf16 v[120:123], a[112:115], a[136:139], v[120:123]
    v_mfma_f32_16x16x32_bf16 v[124:127], a[112:115], a[140:143], v[124:127]
    v_mfma_f32_16x16x32_bf16 v[128:131], a[116:119], a[128:131], v[128:131]
    v_mfma_f32_16x16x32_bf16 v[132:135], a[116:119], a[132:135], v[132:135]
    v_mfma_f32_16x16x32_bf16 v[136:139], a[116:119], a[136:139], v[136:139]
    v_mfma_f32_16x16x32_bf16 v[140:143], a[116:119], a[140:143], v[140:143]
    v_mfma_f32_16x16x32_bf16 v[144:147], a[120:123], a[128:131], v[144:147]
    v_mfma_f32_16x16x32_bf16 v[148:151], a[120:123], a[132:135], v[148:151]
    v_mfma_f32_16x16x32_bf16 v[152:155], a[120:123], a[136:139], v[152:155]
    v_mfma_f32_16x16x32_bf16 v[156:159], a[120:123], a[140:143], v[156:159]
    v_mfma_f32_16x16x32_bf16 v[160:163], a[124:127], a[128:131], v[160:163]
    v_mfma_f32_16x16x32_bf16 v[164:167], a[124:127], a[132:135], v[164:167]
    v_mfma_f32_16x16x32_bf16 v[168:171], a[124:127], a[136:139], v[168:171]
    v_mfma_f32_16x16x32_bf16 v[172:175], a[124:127], a[140:143], v[172:175]
    s_add_u32 s16, s11, 27648
    buffer_load_dwordx4 a[108:111], v2, s[4:7], s16 offen
    s_add_u32 s16, s11, 158720
    buffer_load_dwordx4 a[112:115], v2, s[4:7], s16 offen
    s_add_u32 s16, s11, 289792
    buffer_load_dwordx4 a[116:119], v2, s[4:7], s16 offen
    s_add_u32 s16, s11, 420864
    buffer_load_dwordx4 a[120:123], v2, s[4:7], s16 offen
    s_add_u32 s16, s11, 551936
    buffer_load_dwordx4 a[124:127], v2, s[4:7], s16 offen
    s_add_u32 s16, s14, 3148800
    buffer_load_dwordx4 a[128:131], v2, s[4:7], s16 offen
    s_add_u32 s16, s14, 3152896
    buffer_load_dwordx4 a[132:135], v2, s[4:7], s16 offen
    s_add_u32 s16, s14, 3156992
    buffer_load_dwordx4 a[136:139], v2, s[4:7], s16 offen
    s_add_u32 s16, s14, 3161088
    buffer_load_dwordx4 a[140:143], v2, s[4:7], s16 offen
    s_waitcnt vmcnt(45)
    v_mfma_f32_16x16x32_bf16 v[96:99], a[144:147], a[164:167], v[96:99]
    v_mfma_f32_16x16x32_bf16 v[100:103], a[144:147], a[168:171], v[100:103]
    v_mfma_f32_16x16x32_bf16 v[104:107], a[144:147], a[172:175], v[104:107]
    v_mfma_f32_16x16x32_bf16 v[108:111], a[144:147], a[176:179], v[108:111]
    v_mfma_f32_16x16x32_bf16 v[112:115], a[148:151], a[164:167], v[112:115]
    v_mfma_f32_16x16x32_bf16 v[116:119], a[148:151], a[168:171], v[116:119]
    v_mfma_f32_16x16x32_bf16 v[120:123], a[148:151], a[172:175], v[120:123]
    v_mfma_f32_16x16x32_bf16 v[124:127], a[148:151], a[176:179], v[124:127]
    v_mfma_f32_16x16x32_bf16 v[128:131], a[152:155], a[164:167], v[128:131]
    v_mfma_f32_16x16x32_bf16 v[132:135], a[152:155], a[168:171], v[132:135]
    v_mfma_f32_16x16x32_bf16 v[136:139], a[152:155], a[172:175], v[136:139]
    v_mfma_f32_16x16x32_bf16 v[140:143], a[152:155], a[176:179], v[140:143]
    v_mfma_f32_16x16x32_bf16 v[144:147], a[156:159], a[164:167], v[144:147]
    v_mfma_f32_16x16x32_bf16 v[148:151], a[156:159], a[168:171], v[148:151]
    v_mfma_f32_16x16x32_bf16 v[152:155], a[156:159], a[172:175], v[152:155]
    v_mfma_f32_16x16x32_bf16 v[156:159], a[156:159], a[176:179], v[156:159]
    v_mfma_f32_16x16x32_bf16 v[160:163], a[160:163], a[164:167], v[160:163]
    v_mfma_f32_16x16x32_bf16 v[164:167], a[160:163], a[168:171], v[164:167]
    v_mfma_f32_16x16x32_bf16 v[168:171], a[160:163], a[172:175], v[168:171]
    v_mfma_f32_16x16x32_bf16 v[172:175], a[160:163], a[176:179], v[172:175]
    s_add_u32 s16, s11, 28672
    buffer_load_dwordx4 a[144:147], v2, s[4:7], s16 offen
    s_add_u32 s16, s11, 159744
    buffer_load_dwordx4 a[148:151], v2, s[4:7], s16 offen
    s_add_u32 s16, s11, 290816
    buffer_load_dwordx4 a[152:155], v2, s[4:7], s16 offen
    s_add_u32 s16, s11, 421888
    buffer_load_dwordx4 a[156:159], v2, s[4:7], s16 offen
    s_add_u32 s16, s11, 552960
    buffer_load_dwordx4 a[160:163], v2, s[4:7], s16 offen
    s_add_u32 s16, s14, 3670016
    buffer_load_dwordx4 a[164:167], v2, s[4:7], s16 offen
    s_add_u32 s16, s14, 3674112
    buffer_load_dwordx4 a[168:171], v2, s[4:7], s16 offen
    s_add_u32 s16, s14, 3678208
    buffer_load_dwordx4 a[172:175], v2, s[4:7], s16 offen
    s_add_u32 s16, s14, 3682304
    buffer_load_dwordx4 a[176:179], v2, s[4:7], s16 offen
    s_waitcnt vmcnt(45)
    v_mfma_f32_16x16x32_bf16 v[96:99], a[180:183], a[200:203], v[96:99]
    v_mfma_f32_16x16x32_bf16 v[100:103], a[180:183], a[204:207], v[100:103]
    v_mfma_f32_16x16x32_bf16 v[104:107], a[180:183], a[208:211], v[104:107]
    v_mfma_f32_16x16x32_bf16 v[108:111], a[180:183], a[212:215], v[108:111]
    v_mfma_f32_16x16x32_bf16 v[112:115], a[184:187], a[200:203], v[112:115]
    v_mfma_f32_16x16x32_bf16 v[116:119], a[184:187], a[204:207], v[116:119]
    v_mfma_f32_16x16x32_bf16 v[120:123], a[184:187], a[208:211], v[120:123]
    v_mfma_f32_16x16x32_bf16 v[124:127], a[184:187], a[212:215], v[124:127]
    v_mfma_f32_16x16x32_bf16 v[128:131], a[188:191], a[200:203], v[128:131]
    v_mfma_f32_16x16x32_bf16 v[132:135], a[188:191], a[204:207], v[132:135]
    v_mfma_f32_16x16x32_bf16 v[136:139], a[188:191], a[208:211], v[136:139]
    v_mfma_f32_16x16x32_bf16 v[140:143], a[188:191], a[212:215], v[140:143]
    v_mfma_f32_16x16x32_bf16 v[144:147], a[192:195], a[200:203], v[144:147]
    v_mfma_f32_16x16x32_bf16 v[148:151], a[192:195], a[204:207], v[148:151]
    v_mfma_f32_16x16x32_bf16 v[152:155], a[192:195], a[208:211], v[152:155]
    v_mfma_f32_16x16x32_bf16 v[156:159], a[192:195], a[212:215], v[156:159]
    v_mfma_f32_16x16x32_bf16 v[160:163], a[196:199], a[200:203], v[160:163]
    v_mfma_f32_16x16x32_bf16 v[164:167], a[196:199], a[204:207], v[164:167]
    v_mfma_f32_16x16x32_bf16 v[168:171], a[196:199], a[208:211], v[168:171]
    v_mfma_f32_16x16x32_bf16 v[172:175], a[196:199], a[212:215], v[172:175]
    s_add_u32 s16, s11, 29696
    buffer_load_dwordx4 a[180:183], v2, s[4:7], s16 offen
    s_add_u32 s16, s11, 160768
    buffer_load_dwordx4 a[184:187], v2, s[4:7], s16 offen
    s_add_u32 s16, s11, 291840
    buffer_load_dwordx4 a[188:191], v2, s[4:7], s16 offen
    s_add_u32 s16, s11, 422912
    buffer_load_dwordx4 a[192:195], v2, s[4:7], s16 offen
    s_add_u32 s16, s11, 553984
    buffer_load_dwordx4 a[196:199], v2, s[4:7], s16 offen
    s_add_u32 s16, s14, 3671040
    buffer_load_dwordx4 a[200:203], v2, s[4:7], s16 offen
    s_add_u32 s16, s14, 3675136
    buffer_load_dwordx4 a[204:207], v2, s[4:7], s16 offen
    s_add_u32 s16, s14, 3679232
    buffer_load_dwordx4 a[208:211], v2, s[4:7], s16 offen
    s_add_u32 s16, s14, 3683328
    buffer_load_dwordx4 a[212:215], v2, s[4:7], s16 offen
    s_waitcnt vmcnt(45)
    v_mfma_f32_16x16x32_bf16 v[96:99], a[0:3], a[20:23], v[96:99]
    v_mfma_f32_16x16x32_bf16 v[100:103], a[0:3], a[24:27], v[100:103]
    v_mfma_f32_16x16x32_bf16 v[104:107], a[0:3], a[28:31], v[104:107]
    v_mfma_f32_16x16x32_bf16 v[108:111], a[0:3], a[32:35], v[108:111]
    v_mfma_f32_16x16x32_bf16 v[112:115], a[4:7], a[20:23], v[112:115]
    v_mfma_f32_16x16x32_bf16 v[116:119], a[4:7], a[24:27], v[116:119]
    v_mfma_f32_16x16x32_bf16 v[120:123], a[4:7], a[28:31], v[120:123]
    v_mfma_f32_16x16x32_bf16 v[124:127], a[4:7], a[32:35], v[124:127]
    v_mfma_f32_16x16x32_bf16 v[128:131], a[8:11], a[20:23], v[128:131]
    v_mfma_f32_16x16x32_bf16 v[132:135], a[8:11], a[24:27], v[132:135]
    v_mfma_f32_16x16x32_bf16 v[136:139], a[8:11], a[28:31], v[136:139]
    v_mfma_f32_16x16x32_bf16 v[140:143], a[8:11], a[32:35], v[140:143]
    v_mfma_f32_16x16x32_bf16 v[144:147], a[12:15], a[20:23], v[144:147]
    v_mfma_f32_16x16x32_bf16 v[148:151], a[12:15], a[24:27], v[148:151]
    v_mfma_f32_16x16x32_bf16 v[152:155], a[12:15], a[28:31], v[152:155]
    v_mfma_f32_16x16x32_bf16 v[156:159], a[12:15], a[32:35], v[156:159]
    v_mfma_f32_16x16x32_bf16 v[160:163], a[16:19], a[20:23], v[160:163]
    v_mfma_f32_16x16x32_bf16 v[164:167], a[16:19], a[24:27], v[164:167]
    v_mfma_f32_16x16x32_bf16 v[168:171], a[16:19], a[28:31], v[168:171]
    v_mfma_f32_16x16x32_bf16 v[172:175], a[16:19], a[32:35], v[172:175]
    s_add_u32 s16, s11, 30720
    buffer_load_dwordx4 a[0:3], v2, s[4:7], s16 offen
    s_add_u32 s16, s11, 161792
    buffer_load_dwordx4 a[4:7], v2, s[4:7], s16 offen
    s_add_u32 s16, s11, 292864
    buffer_load_dwordx4 a[8:11], v2, s[4:7], s16 offen
    s_add_u32 s16, s11, 423936
    buffer_load_dwordx4 a[12:15], v2, s[4:7], s16 offen
    s_add_u32 s16, s11, 555008
    buffer_load_dwordx4 a[16:19], v2, s[4:7], s16 offen
    s_add_u32 s16, s14, 3672064
    buffer_load_dwordx4 a[20:23], v2, s[4:7], s16 offen
    s_add_u32 s16, s14, 3676160
    buffer_load_dwordx4 a[24:27], v2, s[4:7], s16 offen
    s_add_u32 s16, s14, 3680256
    buffer_load_dwordx4 a[28:31], v2, s[4:7], s16 offen
    s_add_u32 s16, s14, 3684352
    buffer_load_dwordx4 a[32:35], v2, s[4:7], s16 offen
    s_waitcnt vmcnt(45)
    v_mfma_f32_16x16x32_bf16 v[96:99], a[36:39], a[56:59], v[96:99]
    v_mfma_f32_16x16x32_bf16 v[100:103], a[36:39], a[60:63], v[100:103]
    v_mfma_f32_16x16x32_bf16 v[104:107], a[36:39], a[64:67], v[104:107]
    v_mfma_f32_16x16x32_bf16 v[108:111], a[36:39], a[68:71], v[108:111]
    v_mfma_f32_16x16x32_bf16 v[112:115], a[40:43], a[56:59], v[112:115]
    v_mfma_f32_16x16x32_bf16 v[116:119], a[40:43], a[60:63], v[116:119]
    v_mfma_f32_16x16x32_bf16 v[120:123], a[40:43], a[64:67], v[120:123]
    v_mfma_f32_16x16x32_bf16 v[124:127], a[40:43], a[68:71], v[124:127]
    v_mfma_f32_16x16x32_bf16 v[128:131], a[44:47], a[56:59], v[128:131]
    v_mfma_f32_16x16x32_bf16 v[132:135], a[44:47], a[60:63], v[132:135]
    v_mfma_f32_16x16x32_bf16 v[136:139], a[44:47], a[64:67], v[136:139]
    v_mfma_f32_16x16x32_bf16 v[140:143], a[44:47], a[68:71], v[140:143]
    v_mfma_f32_16x16x32_bf16 v[144:147], a[48:51], a[56:59], v[144:147]
    v_mfma_f32_16x16x32_bf16 v[148:151], a[48:51], a[60:63], v[148:151]
    v_mfma_f32_16x16x32_bf16 v[152:155], a[48:51], a[64:67], v[152:155]
    v_mfma_f32_16x16x32_bf16 v[156:159], a[48:51], a[68:71], v[156:159]
    v_mfma_f32_16x16x32_bf16 v[160:163], a[52:55], a[56:59], v[160:163]
    v_mfma_f32_16x16x32_bf16 v[164:167], a[52:55], a[60:63], v[164:167]
    v_mfma_f32_16x16x32_bf16 v[168:171], a[52:55], a[64:67], v[168:171]
    v_mfma_f32_16x16x32_bf16 v[172:175], a[52:55], a[68:71], v[172:175]
    s_add_u32 s16, s11, 31744
    buffer_load_dwordx4 a[36:39], v2, s[4:7], s16 offen
    s_add_u32 s16, s11, 162816
    buffer_load_dwordx4 a[40:43], v2, s[4:7], s16 offen
    s_add_u32 s16, s11, 293888
    buffer_load_dwordx4 a[44:47], v2, s[4:7], s16 offen
    s_add_u32 s16, s11, 424960
    buffer_load_dwordx4 a[48:51], v2, s[4:7], s16 offen
    s_add_u32 s16, s11, 556032
    buffer_load_dwordx4 a[52:55], v2, s[4:7], s16 offen
    s_add_u32 s16, s14, 3673088
    buffer_load_dwordx4 a[56:59], v2, s[4:7], s16 offen
    s_add_u32 s16, s14, 3677184
    buffer_load_dwordx4 a[60:63], v2, s[4:7], s16 offen
    s_add_u32 s16, s14, 3681280
    buffer_load_dwordx4 a[64:67], v2, s[4:7], s16 offen
    s_add_u32 s16, s14, 3685376
    buffer_load_dwordx4 a[68:71], v2, s[4:7], s16 offen
    s_waitcnt vmcnt(45)
    v_mfma_f32_16x16x32_bf16 v[96:99], a[72:75], a[92:95], v[96:99]
    v_mfma_f32_16x16x32_bf16 v[100:103], a[72:75], a[96:99], v[100:103]
    v_mfma_f32_16x16x32_bf16 v[104:107], a[72:75], a[100:103], v[104:107]
    v_mfma_f32_16x16x32_bf16 v[108:111], a[72:75], a[104:107], v[108:111]
    v_mfma_f32_16x16x32_bf16 v[112:115], a[76:79], a[92:95], v[112:115]
    v_mfma_f32_16x16x32_bf16 v[116:119], a[76:79], a[96:99], v[116:119]
    v_mfma_f32_16x16x32_bf16 v[120:123], a[76:79], a[100:103], v[120:123]
    v_mfma_f32_16x16x32_bf16 v[124:127], a[76:79], a[104:107], v[124:127]
    v_mfma_f32_16x16x32_bf16 v[128:131], a[80:83], a[92:95], v[128:131]
    v_mfma_f32_16x16x32_bf16 v[132:135], a[80:83], a[96:99], v[132:135]
    v_mfma_f32_16x16x32_bf16 v[136:139], a[80:83], a[100:103], v[136:139]
    v_mfma_f32_16x16x32_bf16 v[140:143], a[80:83], a[104:107], v[140:143]
    v_mfma_f32_16x16x32_bf16 v[144:147], a[84:87], a[92:95], v[144:147]
    v_mfma_f32_16x16x32_bf16 v[148:151], a[84:87], a[96:99], v[148:151]
    v_mfma_f32_16x16x32_bf16 v[152:155], a[84:87], a[100:103], v[152:155]
    v_mfma_f32_16x16x32_bf16 v[156:159], a[84:87], a[104:107], v[156:159]
    v_mfma_f32_16x16x32_bf16 v[160:163], a[88:91], a[92:95], v[160:163]
    v_mfma_f32_16x16x32_bf16 v[164:167], a[88:91], a[96:99], v[164:167]
    v_mfma_f32_16x16x32_bf16 v[168:171], a[88:91], a[100:103], v[168:171]
    v_mfma_f32_16x16x32_bf16 v[172:175], a[88:91], a[104:107], v[172:175]
    s_waitcnt vmcnt(36)
    v_mfma_f32_16x16x32_bf16 v[96:99], a[108:111], a[128:131], v[96:99]
    v_mfma_f32_16x16x32_bf16 v[100:103], a[108:111], a[132:135], v[100:103]
    v_mfma_f32_16x16x32_bf16 v[104:107], a[108:111], a[136:139], v[104:107]
    v_mfma_f32_16x16x32_bf16 v[108:111], a[108:111], a[140:143], v[108:111]
    v_mfma_f32_16x16x32_bf16 v[112:115], a[112:115], a[128:131], v[112:115]
    v_mfma_f32_16x16x32_bf16 v[116:119], a[112:115], a[132:135], v[116:119]
    v_mfma_f32_16x16x32_bf16 v[120:123], a[112:115], a[136:139], v[120:123]
    v_mfma_f32_16x16x32_bf16 v[124:127], a[112:115], a[140:143], v[124:127]
    v_mfma_f32_16x16x32_bf16 v[128:131], a[116:119], a[128:131], v[128:131]
    v_mfma_f32_16x16x32_bf16 v[132:135], a[116:119], a[132:135], v[132:135]
    v_mfma_f32_16x16x32_bf16 v[136:139], a[116:119], a[136:139], v[136:139]
    v_mfma_f32_16x16x32_bf16 v[140:143], a[116:119], a[140:143], v[140:143]
    v_mfma_f32_16x16x32_bf16 v[144:147], a[120:123], a[128:131], v[144:147]
    v_mfma_f32_16x16x32_bf16 v[148:151], a[120:123], a[132:135], v[148:151]
    v_mfma_f32_16x16x32_bf16 v[152:155], a[120:123], a[136:139], v[152:155]
    v_mfma_f32_16x16x32_bf16 v[156:159], a[120:123], a[140:143], v[156:159]
    v_mfma_f32_16x16x32_bf16 v[160:163], a[124:127], a[128:131], v[160:163]
    v_mfma_f32_16x16x32_bf16 v[164:167], a[124:127], a[132:135], v[164:167]
    v_mfma_f32_16x16x32_bf16 v[168:171], a[124:127], a[136:139], v[168:171]
    v_mfma_f32_16x16x32_bf16 v[172:175], a[124:127], a[140:143], v[172:175]
    s_waitcnt vmcnt(27)
    v_mfma_f32_16x16x32_bf16 v[96:99], a[144:147], a[164:167], v[96:99]
    v_mfma_f32_16x16x32_bf16 v[100:103], a[144:147], a[168:171], v[100:103]
    v_mfma_f32_16x16x32_bf16 v[104:107], a[144:147], a[172:175], v[104:107]
    v_mfma_f32_16x16x32_bf16 v[108:111], a[144:147], a[176:179], v[108:111]
    v_mfma_f32_16x16x32_bf16 v[112:115], a[148:151], a[164:167], v[112:115]
    v_mfma_f32_16x16x32_bf16 v[116:119], a[148:151], a[168:171], v[116:119]
    v_mfma_f32_16x16x32_bf16 v[120:123], a[148:151], a[172:175], v[120:123]
    v_mfma_f32_16x16x32_bf16 v[124:127], a[148:151], a[176:179], v[124:127]
    v_mfma_f32_16x16x32_bf16 v[128:131], a[152:155], a[164:167], v[128:131]
    v_mfma_f32_16x16x32_bf16 v[132:135], a[152:155], a[168:171], v[132:135]
    v_mfma_f32_16x16x32_bf16 v[136:139], a[152:155], a[172:175], v[136:139]
    v_mfma_f32_16x16x32_bf16 v[140:143], a[152:155], a[176:179], v[140:143]
    v_mfma_f32_16x16x32_bf16 v[144:147], a[156:159], a[164:167], v[144:147]
    v_mfma_f32_16x16x32_bf16 v[148:151], a[156:159], a[168:171], v[148:151]
    v_mfma_f32_16x16x32_bf16 v[152:155], a[156:159], a[172:175], v[152:155]
    v_mfma_f32_16x16x32_bf16 v[156:159], a[156:159], a[176:179], v[156:159]
    v_mfma_f32_16x16x32_bf16 v[160:163], a[160:163], a[164:167], v[160:163]
    v_mfma_f32_16x16x32_bf16 v[164:167], a[160:163], a[168:171], v[164:167]
    v_mfma_f32_16x16x32_bf16 v[168:171], a[160:163], a[172:175], v[168:171]
    v_mfma_f32_16x16x32_bf16 v[172:175], a[160:163], a[176:179], v[172:175]
    s_waitcnt vmcnt(18)
    v_mfma_f32_16x16x32_bf16 v[96:99], a[180:183], a[200:203], v[96:99]
    v_mfma_f32_16x16x32_bf16 v[100:103], a[180:183], a[204:207], v[100:103]
    v_mfma_f32_16x16x32_bf16 v[104:107], a[180:183], a[208:211], v[104:107]
    v_mfma_f32_16x16x32_bf16 v[108:111], a[180:183], a[212:215], v[108:111]
    v_mfma_f32_16x16x32_bf16 v[112:115], a[184:187], a[200:203], v[112:115]
    v_mfma_f32_16x16x32_bf16 v[116:119], a[184:187], a[204:207], v[116:119]
    v_mfma_f32_16x16x32_bf16 v[120:123], a[184:187], a[208:211], v[120:123]
    v_mfma_f32_16x16x32_bf16 v[124:127], a[184:187], a[212:215], v[124:127]
    v_mfma_f32_16x16x32_bf16 v[128:131], a[188:191], a[200:203], v[128:131]
    v_mfma_f32_16x16x32_bf16 v[132:135], a[188:191], a[204:207], v[132:135]
    v_mfma_f32_16x16x32_bf16 v[136:139], a[188:191], a[208:211], v[136:139]
    v_mfma_f32_16x16x32_bf16 v[140:143], a[188:191], a[212:215], v[140:143]
    v_mfma_f32_16x16x32_bf16 v[144:147], a[192:195], a[200:203], v[144:147]
    v_mfma_f32_16x16x32_bf16 v[148:151], a[192:195], a[204:207], v[148:151]
    v_mfma_f32_16x16x32_bf16 v[152:155], a[192:195], a[208:211], v[152:155]
    v_mfma_f32_16x16x32_bf16 v[156:159], a[192:195], a[212:215], v[156:159]
    v_mfma_f32_16x16x32_bf16 v[160:163], a[196:199], a[200:203], v[160:163]
    v_mfma_f32_16x16x32_bf16 v[164:167], a[196:199], a[204:207], v[164:167]
    v_mfma_f32_16x16x32_bf16 v[168:171], a[196:199], a[208:211], v[168:171]
    v_mfma_f32_16x16x32_bf16 v[172:175], a[196:199], a[212:215], v[172:175]
    s_waitcnt vmcnt(9)
    v_mfma_f32_16x16x32_bf16 v[96:99], a[0:3], a[20:23], v[96:99]
    v_mfma_f32_16x16x32_bf16 v[100:103], a[0:3], a[24:27], v[100:103]
    v_mfma_f32_16x16x32_bf16 v[104:107], a[0:3], a[28:31], v[104:107]
    v_mfma_f32_16x16x32_bf16 v[108:111], a[0:3], a[32:35], v[108:111]
    v_mfma_f32_16x16x32_bf16 v[112:115], a[4:7], a[20:23], v[112:115]
    v_mfma_f32_16x16x32_bf16 v[116:119], a[4:7], a[24:27], v[116:119]
    v_mfma_f32_16x16x32_bf16 v[120:123], a[4:7], a[28:31], v[120:123]
    v_mfma_f32_16x16x32_bf16 v[124:127], a[4:7], a[32:35], v[124:127]
    v_mfma_f32_16x16x32_bf16 v[128:131], a[8:11], a[20:23], v[128:131]
    v_mfma_f32_16x16x32_bf16 v[132:135], a[8:11], a[24:27], v[132:135]
    v_mfma_f32_16x16x32_bf16 v[136:139], a[8:11], a[28:31], v[136:139]
    v_mfma_f32_16x16x32_bf16 v[140:143], a[8:11], a[32:35], v[140:143]
    v_mfma_f32_16x16x32_bf16 v[144:147], a[12:15], a[20:23], v[144:147]
    v_mfma_f32_16x16x32_bf16 v[148:151], a[12:15], a[24:27], v[148:151]
    v_mfma_f32_16x16x32_bf16 v[152:155], a[12:15], a[28:31], v[152:155]
    v_mfma_f32_16x16x32_bf16 v[156:159], a[12:15], a[32:35], v[156:159]
    v_mfma_f32_16x16x32_bf16 v[160:163], a[16:19], a[20:23], v[160:163]
    v_mfma_f32_16x16x32_bf16 v[164:167], a[16:19], a[24:27], v[164:167]
    v_mfma_f32_16x16x32_bf16 v[168:171], a[16:19], a[28:31], v[168:171]
    v_mfma_f32_16x16x32_bf16 v[172:175], a[16:19], a[32:35], v[172:175]
    s_waitcnt vmcnt(0)
    v_mfma_f32_16x16x32_bf16 v[96:99], a[36:39], a[56:59], v[96:99]
    v_mfma_f32_16x16x32_bf16 v[100:103], a[36:39], a[60:63], v[100:103]
    v_mfma_f32_16x16x32_bf16 v[104:107], a[36:39], a[64:67], v[104:107]
    v_mfma_f32_16x16x32_bf16 v[108:111], a[36:39], a[68:71], v[108:111]
    v_mfma_f32_16x16x32_bf16 v[112:115], a[40:43], a[56:59], v[112:115]
    v_mfma_f32_16x16x32_bf16 v[116:119], a[40:43], a[60:63], v[116:119]
    v_mfma_f32_16x16x32_bf16 v[120:123], a[40:43], a[64:67], v[120:123]
    v_mfma_f32_16x16x32_bf16 v[124:127], a[40:43], a[68:71], v[124:127]
    v_mfma_f32_16x16x32_bf16 v[128:131], a[44:47], a[56:59], v[128:131]
    v_mfma_f32_16x16x32_bf16 v[132:135], a[44:47], a[60:63], v[132:135]
    v_mfma_f32_16x16x32_bf16 v[136:139], a[44:47], a[64:67], v[136:139]
    v_mfma_f32_16x16x32_bf16 v[140:143], a[44:47], a[68:71], v[140:143]
    v_mfma_f32_16x16x32_bf16 v[144:147], a[48:51], a[56:59], v[144:147]
    v_mfma_f32_16x16x32_bf16 v[148:151], a[48:51], a[60:63], v[148:151]
    v_mfma_f32_16x16x32_bf16 v[152:155], a[48:51], a[64:67], v[152:155]
    v_mfma_f32_16x16x32_bf16 v[156:159], a[48:51], a[68:71], v[156:159]
    v_mfma_f32_16x16x32_bf16 v[160:163], a[52:55], a[56:59], v[160:163]
    v_mfma_f32_16x16x32_bf16 v[164:167], a[52:55], a[60:63], v[164:167]
    v_mfma_f32_16x16x32_bf16 v[168:171], a[52:55], a[64:67], v[168:171]
    v_mfma_f32_16x16x32_bf16 v[172:175], a[52:55], a[68:71], v[172:175]
    s_nop 7
    s_mul_i32 s16, s8, 20480
    v_add_u32 v3, s16, v2
    ds_write_b128 v3, v[96:99] offset:0
    ds_write_b128 v3, v[100:103] offset:1024
    ds_write_b128 v3, v[104:107] offset:2048
    ds_write_b128 v3, v[108:111] offset:3072
    ds_write_b128 v3, v[112:115] offset:4096
    ds_write_b128 v3, v[116:119] offset:5120
    ds_write_b128 v3, v[120:123] offset:6144
    ds_write_b128 v3, v[124:127] offset:7168
    ds_write_b128 v3, v[128:131] offset:8192
    ds_write_b128 v3, v[132:135] offset:9216
    ds_write_b128 v3, v[136:139] offset:10240
    ds_write_b128 v3, v[140:143] offset:11264
    ds_write_b128 v3, v[144:147] offset:12288
    ds_write_b128 v3, v[148:151] offset:13312
    ds_write_b128 v3, v[152:155] offset:14336
    ds_write_b128 v3, v[156:159] offset:15360
    ds_write_b128 v3, v[160:163] offset:16384
    ds_write_b128 v3, v[164:167] offset:17408
    ds_write_b128 v3, v[168:171] offset:18432
    ds_write_b128 v3, v[172:175] offset:19456
    s_waitcnt lgkmcnt(0)
    s_barrier
    s_mul_i32 s16, s8, 5120
    v_add_u32 v3, s16, v2
    v_add_u32 v4, 40960, v3
    ds_read_b128 v[16:19], v3 offset:0
    ds_read_b128 v[20:23], v3 offset:20480
    ds_read_b128 v[24:27], v4 offset:0
    ds_read_b128 v[28:31], v4 offset:20480
    ds_read_b128 v[32:35], v3 offset:1024
    ds_read_b128 v[36:39], v3 offset:21504
    ds_read_b128 v[40:43], v4 offset:1024
    ds_read_b128 v[44:47], v4 offset:21504
    s_waitcnt lgkmcnt(0)
    ds_read_b128 v[48:51], v3 offset:2048
    ds_read_b128 v[52:55], v3 offset:22528
    ds_read_b128 v[56:59], v4 offset:2048
    ds_read_b128 v[60:63], v4 offset:22528
    ds_read_b128 v[64:67], v3 offset:3072
    ds_read_b128 v[68:71], v3 offset:23552
    ds_read_b128 v[72:75], v4 offset:3072
    ds_read_b128 v[76:79], v4 offset:23552
    s_waitcnt lgkmcnt(0)
    ds_read_b128 v[80:83], v3 offset:4096
    ds_read_b128 v[84:87], v3 offset:24576
    ds_read_b128 v[88:91], v4 offset:4096
    ds_read_b128 v[92:95], v4 offset:24576
    s_waitcnt lgkmcnt(0)
    v_and_b32 v5, 15, v1
    v_mul_u32_u24 v5, 2560, v5
    v_lshrrev_b32 v6, 4, v1
    v_lshlrev_b32 v6, 3, v6
    v_add_u32 v5, v5, v6
    s_mul_i32 s15, s9, 163840
    s_mul_i32 s16, s10, 160
    s_add_u32 s15, s15, s16
    s_add_u32 s15, s15, 1280
    s_mul_i32 s17, s8, 5
    v_add_f32 v16, v16, v20
    v_add_f32 v24, v24, v28
    v_add_f32 v17, v17, v21
    v_add_f32 v25, v25, v29
    v_add_f32 v18, v18, v22
    v_add_f32 v26, v26, v30
    v_add_f32 v19, v19, v23
    v_add_f32 v27, v27, v31
    v_add_f32 v16, v16, v24
    v_add_f32 v17, v17, v25
    v_add_f32 v18, v18, v26
    v_add_f32 v19, v19, v27
    v_cvt_pk_bf16_f32 v16, v16, v17
    v_cvt_pk_bf16_f32 v17, v18, v19
    s_add_u32 s18, s17, 0
    s_lshr_b32 s19, s18, 2
    s_and_b32 s18, s18, 3
    s_mul_i32 s18, s18, 40960
    s_lshl_b32 s19, s19, 5
    s_add_u32 s18, s18, s19
    s_add_u32 s18, s18, s15
    buffer_store_dwordx2 v[16:17], v5, s[20:23], s18 offen
    v_add_f32 v32, v32, v36
    v_add_f32 v40, v40, v44
    v_add_f32 v33, v33, v37
    v_add_f32 v41, v41, v45
    v_add_f32 v34, v34, v38
    v_add_f32 v42, v42, v46
    v_add_f32 v35, v35, v39
    v_add_f32 v43, v43, v47
    v_add_f32 v32, v32, v40
    v_add_f32 v33, v33, v41
    v_add_f32 v34, v34, v42
    v_add_f32 v35, v35, v43
    v_cvt_pk_bf16_f32 v32, v32, v33
    v_cvt_pk_bf16_f32 v33, v34, v35
    s_add_u32 s18, s17, 1
    s_lshr_b32 s19, s18, 2
    s_and_b32 s18, s18, 3
    s_mul_i32 s18, s18, 40960
    s_lshl_b32 s19, s19, 5
    s_add_u32 s18, s18, s19
    s_add_u32 s18, s18, s15
    buffer_store_dwordx2 v[32:33], v5, s[20:23], s18 offen
    v_add_f32 v48, v48, v52
    v_add_f32 v56, v56, v60
    v_add_f32 v49, v49, v53
    v_add_f32 v57, v57, v61
    v_add_f32 v50, v50, v54
    v_add_f32 v58, v58, v62
    v_add_f32 v51, v51, v55
    v_add_f32 v59, v59, v63
    v_add_f32 v48, v48, v56
    v_add_f32 v49, v49, v57
    v_add_f32 v50, v50, v58
    v_add_f32 v51, v51, v59
    v_cvt_pk_bf16_f32 v48, v48, v49
    v_cvt_pk_bf16_f32 v49, v50, v51
    s_add_u32 s18, s17, 2
    s_lshr_b32 s19, s18, 2
    s_and_b32 s18, s18, 3
    s_mul_i32 s18, s18, 40960
    s_lshl_b32 s19, s19, 5
    s_add_u32 s18, s18, s19
    s_add_u32 s18, s18, s15
    buffer_store_dwordx2 v[48:49], v5, s[20:23], s18 offen
    v_add_f32 v64, v64, v68
    v_add_f32 v72, v72, v76
    v_add_f32 v65, v65, v69
    v_add_f32 v73, v73, v77
    v_add_f32 v66, v66, v70
    v_add_f32 v74, v74, v78
    v_add_f32 v67, v67, v71
    v_add_f32 v75, v75, v79
    v_add_f32 v64, v64, v72
    v_add_f32 v65, v65, v73
    v_add_f32 v66, v66, v74
    v_add_f32 v67, v67, v75
    v_cvt_pk_bf16_f32 v64, v64, v65
    v_cvt_pk_bf16_f32 v65, v66, v67
    s_add_u32 s18, s17, 3
    s_lshr_b32 s19, s18, 2
    s_and_b32 s18, s18, 3
    s_mul_i32 s18, s18, 40960
    s_lshl_b32 s19, s19, 5
    s_add_u32 s18, s18, s19
    s_add_u32 s18, s18, s15
    buffer_store_dwordx2 v[64:65], v5, s[20:23], s18 offen
    v_add_f32 v80, v80, v84
    v_add_f32 v88, v88, v92
    v_add_f32 v81, v81, v85
    v_add_f32 v89, v89, v93
    v_add_f32 v82, v82, v86
    v_add_f32 v90, v90, v94
    v_add_f32 v83, v83, v87
    v_add_f32 v91, v91, v95
    v_add_f32 v80, v80, v88
    v_add_f32 v81, v81, v89
    v_add_f32 v82, v82, v90
    v_add_f32 v83, v83, v91
    v_cvt_pk_bf16_f32 v80, v80, v81
    v_cvt_pk_bf16_f32 v81, v82, v83
    s_add_u32 s18, s17, 4
    s_lshr_b32 s19, s18, 2
    s_and_b32 s18, s18, 3
    s_mul_i32 s18, s18, 40960
    s_lshl_b32 s19, s19, 5
    s_add_u32 s18, s18, s19
    s_add_u32 s18, s18, s15
    buffer_store_dwordx2 v[80:81], v5, s[20:23], s18 offen
    s_barrier
    s_branch CH_wtop86
CH_watt121:
    s_lshl_b32 s9, s16, 1
    s_lshr_b32 s18, s17, 3
    s_add_u32 s9, s9, s18
    s_and_b32 s17, s17, 7
CH_wattseg124:
    s_lshl_b32 s10, s17, 2
    s_add_u32 s10, s10, s8
    s_lshl_b32 s44, s9, 5
    s_add_u32 s44, s44, 85995520
    s_lshl_b32 s18, s17, 8
    s_lshl_b32 s19, s9, 2
    s_add_u32 s18, s18, s19
    s_add_u32 s19, s18, 85993472
    v_mov_b32 v2, s19
    s_add_u32 s19, s18, 85991424
    v_mov_b32 v4, s19
    v_cmp_eq_u32 vcc, 1, v1
    s_nop 1
    v_cndmask_b32 v2, v2, v4, vcc
    v_mov_b32 v3, 2
    v_mov_b32 v4, 4
    v_cndmask_b32 v3, v3, v4, vcc
    s_mov_b64 exec, 3
    s_mov_b32 s40, 0
CH_wf163:
    buffer_load_dword v9, v2, s[4:7], 0 offen sc1
    s_waitcnt vmcnt(0)
    v_cmp_lt_u32 vcc, v9, v3
    s_cbranch_vccz CH_wfok164
    s_sleep 16
    s_add_u32 s40, s40, 1
    s_cmp_lt_u32 s40, 174762
    s_cbranch_scc1 CH_wf163
    s_endpgm
CH_wfok164:
    s_mov_b64 exec, -1
    v_lshlrev_b32 v2, 4, v1
    v_and_b32 v6, 15, v1
    v_lshrrev_b32 v7, 4, v1
    v_and_b32 v8, 7, v1
    v_lshlrev_b32 v9, 7, v7
    v_lshlrev_b32 v8, 4, v8
    v_add_u32 v3, v9, v8
    v_lshlrev_b32 v9, 8, v7
    v_add3_u32 v5, v9, v8, 64
    v_add_u32 v5, 64, v5
    v_lshrrev_b32 v9, 1, v7
    v_lshlrev_b32 v9, 8, v9
    v_lshlrev_b32 v10, 4, v6
    v_and_b32 v11, 1, v7
    v_lshlrev_b32 v11, 3, v11
    v_add3_u32 v4, v9, v10, v11
    v_cmp_gt_u32 vcc, 32, v1
    s_mov_b64 s[14:15], vcc
    v_mov_b32 v9, 0xff800000
    v_mov_b32 v10, 0
    v_cndmask_b32 v156, v10, v9, s[14:15]
    v_mov_b32 v157, v156
    v_mov_b32 v158, v156
    v_mov_b32 v159, v156
    v_lshlrev_b32 v11, 2, v7
    v_add_u32 v12, 0, v11
    v_cmp_le_u32 vcc, v12, v6
    s_nop 1
    v_cndmask_b32 v160, v9, v10, vcc
    v_add_u32 v12, 1, v11
    v_cmp_le_u32 vcc, v12, v6
    s_nop 1
    v_cndmask_b32 v161, v9, v10, vcc
    v_add_u32 v12, 2, v11
    v_cmp_le_u32 vcc, v12, v6
    s_nop 1
    v_cndmask_b32 v162, v9, v10, vcc
    v_add_u32 v12, 3, v11
    v_cmp_le_u32 vcc, v12, v6
    s_nop 1
    v_cndmask_b32 v163, v9, v10, vcc
    v_mov_b32 v152, 0x3f803f80
    v_mov_b32 v153, 0x3f803f80
    v_mov_b32 v154, 0x3f803f80
    v_mov_b32 v155, 0x3f803f80
    v_and_b32 v9, 1, v6
    v_lshlrev_b32 v9, 4, v9
    v_mov_b32 v10, 0x3f80
    v_lshlrev_b32 v10, v9, v10
    v_and_b32 v9, 7, v6
    v_lshrrev_b32 v9, 1, v9
    v_lshrrev_b32 v11, 3, v6
    v_add_u32 v12, 0, v11
    v_cmp_eq_u32 s[26:27], v12, v7
    v_cmp_eq_u32 vcc, 0, v9
    s_and_b64 vcc, vcc, s[26:27]
    s_nop 1
    v_cndmask_b32 v144, 0, v10, vcc
    v_cmp_eq_u32 vcc, 1, v9
    s_and_b64 vcc, vcc, s[26:27]
    s_nop 1
    v_cndmask_b32 v145, 0, v10, vcc
    v_cmp_eq_u32 vcc, 2, v9
    s_and_b64 vcc, vcc, s[26:27]
    s_nop 1
    v_cndmask_b32 v146, 0, v10, vcc
    v_cmp_eq_u32 vcc, 3, v9
    s_and_b64 vcc, vcc, s[26:27]
    s_nop 1
    v_cndmask_b32 v147, 0, v10, vcc
    v_add_u32 v12, 2, v11
    v_cmp_eq_u32 s[26:27], v12, v7
    v_cmp_eq_u32 vcc, 0, v9
    s_and_b64 vcc, vcc, s[26:27]
    s_nop 1
    v_cndmask_b32 v148, 0, v10, vcc
    v_cmp_eq_u32 vcc, 1, v9
    s_and_b64 vcc, vcc, s[26:27]
    s_nop 1
    v_cndmask_b32 v149, 0, v10, vcc
    v_cmp_eq_u32 vcc, 2, v9
    s_and_b64 vcc, vcc, s[26:27]
    s_nop 1
    v_cndmask_b32 v150, 0, v10, vcc
    v_cmp_eq_u32 vcc, 3, v9
    s_and_b64 vcc, vcc, s[26:27]
    s_nop 1
    v_cndmask_b32 v151, 0, v10, vcc
    s_mov_b32 s12, 0x3e0293ee
    s_lshl_b32 s11, s10, 19
    s_lshl_b32 s16, s9, 13
    s_add_u32 s11, s11, s16
    s_add_u32 s16, s11, 33554432
    s_add_u32 s17, s16, 4096
    s_add_u32 s18, s11, 0
    s_add_u32 s19, s18, 4096
    s_add_u32 s20, s11, 16777216
    s_add_u32 s21, s20, 4096
    s_lshl_b32 s22, s9, 5
    s_add_u32 s22, s22, s10
    s_lshl_b32 s23, s22, 12
    s_add_u32 s23, s23, 67108864
    s_lshl_b32 s24, s22, 11
    s_add_u32 s24, s24, 75497472
    s_add_u32 s25, s11, 50331648
    buffer_load_dwordx4 v[16:19], v2, s[4:7], s16 offen offset:0
    buffer_load_dwordx4 v[20:23], v2, s[4:7], s16 offen offset:1024
    buffer_load_dwordx4 v[24:27], v2, s[4:7], s16 offen offset:2048
    buffer_load_dwordx4 v[28:31], v2, s[4:7], s16 offen offset:3072
    buffer_load_dwordx4 v[32:35], v2, s[4:7], s17 offen offset:0
    buffer_load_dwordx4 v[36:39], v2, s[4:7], s17 offen offset:1024
    buffer_load_dwordx4 v[40:43], v2, s[4:7], s17 offen offset:2048
    buffer_load_dwordx4 v[44:47], v2, s[4:7], s17 offen offset:3072
    buffer_load_dwordx4 v[48:51], v2, s[4:7], s18 offen offset:0
    buffer_load_dwordx4 v[52:55], v2, s[4:7], s18 offen offset:1024
    buffer_load_dwordx4 v[56:59], v2, s[4:7], s18 offen offset:2048
    buffer_load_dwordx4 v[60:63], v2, s[4:7], s18 offen offset:3072
    buffer_load_dwordx4 v[64:67], v2, s[4:7], s19 offen offset:0
    buffer_load_dwordx4 v[68:71], v2, s[4:7], s19 offen offset:1024
    buffer_load_dwordx4 v[72:75], v2, s[4:7], s19 offen offset:2048
    buffer_load_dwordx4 v[76:79], v2, s[4:7], s19 offen offset:3072
    buffer_load_dwordx4 v[80:83], v2, s[4:7], s20 offen offset:0
    buffer_load_dwordx4 v[84:87], v2, s[4:7], s20 offen offset:1024
    buffer_load_dwordx4 v[88:91], v2, s[4:7], s20 offen offset:2048
    buffer_load_dwordx4 v[92:95], v2, s[4:7], s20 offen offset:3072
    buffer_load_dwordx4 v[96:99], v2, s[4:7], s21 offen offset:0
    buffer_load_dwordx4 v[100:103], v2, s[4:7], s21 offen offset:1024
    buffer_load_dwordx4 v[104:107], v2, s[4:7], s21 offen offset:2048
    buffer_load_dwordx4 v[108:111], v2, s[4:7], s21 offen offset:3072
    s_lshl_b32 s27, s9, 5
    s_add_u32 s27, s27, s10
    s_lshl_b32 s27, s27, 5
    s_add_u32 s27, s27, 85999616
    v_lshlrev_b32 v6, 2, v1
    v_add_u32 v6, s27, v6
    v_mov_b32 v7, 1
    s_mov_b64 exec, 255
    s_mov_b32 s40, 0
CH_wf165:
    buffer_load_dword v8, v6, s[4:7], 0 offen sc1
    s_waitcnt vmcnt(0)
    v_cmp_lt_u32 vcc, v8, v7
    s_cbranch_vccz CH_wfok166
    s_cmp_ge_u32 s9, 62
    s_cbranch_scc1 CH_wf165_f
    s_sleep 32
CH_wf165_f:
    s_sleep 3
    s_add_u32 s40, s40, 1
    s_cmp_lt_u32 s40, 104857
    s_cbranch_scc1 CH_wf165
    s_endpgm
CH_wfok166:
    s_mov_b64 exec, -1
    buffer_load_dwordx4 v[112:115], v5, s[4:7], s23 offen offset:0
    buffer_load_dwordx4 v[116:119], v5, s[4:7], s23 offen offset:1024
    buffer_load_dwordx4 v[120:123], v5, s[4:7], s23 offen offset:2048
    buffer_load_dwordx4 v[124:127], v5, s[4:7], s23 offen offset:3072
    buffer_load_dwordx4 v[128:131], v3, s[4:7], s24 offen offset:0
    buffer_load_dwordx4 v[132:135], v3, s[4:7], s24 offen offset:512
    buffer_load_dwordx4 v[136:139], v3, s[4:7], s24 offen offset:1024
    buffer_load_dwordx4 v[140:143], v3, s[4:7], s24 offen offset:1536
    s_waitcnt vmcnt(4)
    v_mfma_f32_16x16x32_bf16 v[164:167], v[112:115], v[16:19], v[156:159]
    v_mfma_f32_16x16x32_bf16 v[168:171], v[48:51], v[16:19], v[160:163]
    v_mfma_f32_16x16x32_bf16 v[164:167], v[116:119], v[20:23], v[164:167]
    v_mfma_f32_16x16x32_bf16 v[168:171], v[52:55], v[20:23], v[168:171]
    v_mfma_f32_16x16x32_bf16 v[164:167], v[120:123], v[24:27], v[164:167]
    v_mfma_f32_16x16x32_bf16 v[168:171], v[56:59], v[24:27], v[168:171]
    v_mfma_f32_16x16x32_bf16 v[164:167], v[124:127], v[28:31], v[164:167]
    v_mfma_f32_16x16x32_bf16 v[168:171], v[60:63], v[28:31], v[168:171]
    s_nop 7
    v_max3_f32 v244, v164, v165, v166
    v_max3_f32 v244, v244, v167, v168
    v_max3_f32 v244, v244, v169, v170
    v_max_f32 v244, v244, v171
    v_mov_b32 v245, v244
    s_nop 1
    v_permlane16_swap_b32 v244, v245
    v_max_f32 v244, v244, v245
    v_mov_b32 v245, v244
    s_nop 1
    v_permlane32_swap_b32 v244, v245
    v_max_f32 v244, v244, v245
    v_mul_f32 v244, s12, v244
    v_fma_f32 v164, v164, s12, -v244
    v_fma_f32 v165, v165, s12, -v244
    v_fma_f32 v166, v166, s12, -v244
    v_fma_f32 v167, v167, s12, -v244
    v_fma_f32 v168, v168, s12, -v244
    v_fma_f32 v169, v169, s12, -v244
    v_fma_f32 v170, v170, s12, -v244
    v_fma_f32 v171, v171, s12, -v244
    v_exp_f32 v164, v164
    v_exp_f32 v165, v165
    v_exp_f32 v166, v166
    v_exp_f32 v167, v167
    v_exp_f32 v168, v168
    v_exp_f32 v169, v169
    v_exp_f32 v170, v170
    v_exp_f32 v171, v171
    s_nop 0
    v_cvt_pk_bf16_f32 v176, v168, v169
    v_cvt_pk_bf16_f32 v177, v170, v171
    v_mov_b32 v178, 0
    v_mov_b32 v179, 0
    v_cvt_pk_bf16_f32 v184, v164, v165
    v_cvt_pk_bf16_f32 v185, v166, v167
    s_nop 1
    v_mfma_f32_16x16x32_bf16 v[188:191], v[152:155], v[176:179], 0
    v_mfma_f32_16x16x32_bf16 v[164:167], v[112:115], v[32:35], v[156:159]
    v_mfma_f32_16x16x32_bf16 v[168:171], v[48:51], v[32:35], 0
    v_mfma_f32_16x16x32_bf16 v[172:175], v[64:67], v[32:35], v[160:163]
    v_mfma_f32_16x16x32_bf16 v[164:167], v[116:119], v[36:39], v[164:167]
    v_mfma_f32_16x16x32_bf16 v[168:171], v[52:55], v[36:39], v[168:171]
    v_mfma_f32_16x16x32_bf16 v[172:175], v[68:71], v[36:39], v[172:175]
    v_mfma_f32_16x16x32_bf16 v[164:167], v[120:123], v[40:43], v[164:167]
    v_mfma_f32_16x16x32_bf16 v[168:171], v[56:59], v[40:43], v[168:171]
    v_mfma_f32_16x16x32_bf16 v[172:175], v[72:75], v[40:43], v[172:175]
    v_mfma_f32_16x16x32_bf16 v[164:167], v[124:127], v[44:47], v[164:167]
    v_mfma_f32_16x16x32_bf16 v[168:171], v[60:63], v[44:47], v[168:171]
    v_mfma_f32_16x16x32_bf16 v[172:175], v[76:79], v[44:47], v[172:175]
    s_nop 7
    v_max3_f32 v244, v164, v165, v166
    v_max3_f32 v244, v244, v167, v168
    v_max3_f32 v244, v244, v169, v170
    v_max3_f32 v244, v244, v171, v172
    v_max3_f32 v244, v244, v173, v174
    v_max_f32 v244, v244, v175
    v_mov_b32 v245, v244
    s_nop 1
    v_permlane16_swap_b32 v244, v245
    v_max_f32 v244, v244, v245
    v_mov_b32 v245, v244
    s_nop 1
    v_permlane32_swap_b32 v244, v245
    v_max_f32 v244, v244, v245
    v_mul_f32 v244, s12, v244
    v_fma_f32 v164, v164, s12, -v244
    v_fma_f32 v165, v165, s12, -v244
    v_fma_f32 v166, v166, s12, -v244
    v_fma_f32 v167, v167, s12, -v244
    v_fma_f32 v168, v168, s12, -v244
    v_fma_f32 v169, v169, s12, -v244
    v_fma_f32 v170, v170, s12, -v244
    v_fma_f32 v171, v171, s12, -v244
    v_fma_f32 v172, v172, s12, -v244
    v_fma_f32 v173, v173, s12, -v244
    v_fma_f32 v174, v174, s12, -v244
    v_fma_f32 v175, v175, s12, -v244
    v_exp_f32 v164, v164
    v_exp_f32 v165, v165
    v_exp_f32 v166, v166
    v_exp_f32 v167, v167
    v_exp_f32 v168, v168
    v_exp_f32 v169, v169
    v_exp_f32 v170, v170
    v_exp_f32 v171, v171
    v_exp_f32 v172, v172
    v_exp_f32 v173, v173
    v_exp_f32 v174, v174
    v_exp_f32 v175, v175
    s_nop 0
    v_cvt_pk_bf16_f32 v180, v168, v169
    v_cvt_pk_bf16_f32 v181, v170, v171
    v_cvt_pk_bf16_f32 v182, v172, v173
    v_cvt_pk_bf16_f32 v183, v174, v175
    v_cvt_pk_bf16_f32 v186, v164, v165
    v_cvt_pk_bf16_f32 v187, v166, v167
    s_nop 1
    v_mfma_f32_16x16x32_bf16 v[192:195], v[152:155], v[180:183], 0
    s_nop 7
    v_mfma_f32_16x16x16_bf16 v[188:191], v[152:153], v[184:185], v[188:191]
    v_mfma_f32_16x16x16_bf16 v[192:195], v[152:153], v[186:187], v[192:195]
    s_waitcnt vmcnt(0)
    v_mfma_f32_16x16x32_bf16 v[16:19], v[80:83], v[144:147], 0
    v_mfma_f32_16x16x32_bf16 v[20:23], v[96:99], v[144:147], 0
    v_mfma_f32_16x16x32_bf16 v[24:27], v[128:131], v[144:147], 0
    v_mfma_f32_16x16x32_bf16 v[28:31], v[80:83], v[148:151], 0
    v_mfma_f32_16x16x32_bf16 v[32:35], v[96:99], v[148:151], 0
    v_mfma_f32_16x16x32_bf16 v[36:39], v[128:131], v[148:151], 0
    s_nop 7
    v_cvt_pk_bf16_f32 v196, v16, v17
    v_cvt_pk_bf16_f32 v197, v18, v19
    v_cvt_pk_bf16_f32 v198, v20, v21
    v_cvt_pk_bf16_f32 v199, v22, v23
    v_cvt_pk_bf16_f32 v228, v24, v25
    v_cvt_pk_bf16_f32 v229, v26, v27
    v_cvt_pk_bf16_f32 v200, v28, v29
    v_cvt_pk_bf16_f32 v201, v30, v31
    v_cvt_pk_bf16_f32 v202, v32, v33
    v_cvt_pk_bf16_f32 v203, v34, v35
    v_cvt_pk_bf16_f32 v230, v36, v37
    v_cvt_pk_bf16_f32 v231, v38, v39
    s_nop 2
    v_mfma_f32_16x16x32_bf16 v[16:19], v[84:87], v[144:147], 0
    v_mfma_f32_16x16x32_bf16 v[20:23], v[100:103], v[144:147], 0
    v_mfma_f32_16x16x32_bf16 v[24:27], v[132:135], v[144:147], 0
    v_mfma_f32_16x16x32_bf16 v[28:31], v[84:87], v[148:151], 0
    v_mfma_f32_16x16x32_bf16 v[32:35], v[100:103], v[148:151], 0
    v_mfma_f32_16x16x32_bf16 v[36:39], v[132:135], v[148:151], 0
    s_nop 7
    v_cvt_pk_bf16_f32 v204, v16, v17
    v_cvt_pk_bf16_f32 v205, v18, v19
    v_cvt_pk_bf16_f32 v206, v20, v21
    v_cvt_pk_bf16_f32 v207, v22, v23
    v_cvt_pk_bf16_f32 v232, v24, v25
    v_cvt_pk_bf16_f32 v233, v26, v27
    v_cvt_pk_bf16_f32 v208, v28, v29
    v_cvt_pk_bf16_f32 v209, v30, v31
    v_cvt_pk_bf16_f32 v210, v32, v33
    v_cvt_pk_bf16_f32 v211, v34, v35
    v_cvt_pk_bf16_f32 v234, v36, v37
    v_cvt_pk_bf16_f32 v235, v38, v39
    s_nop 2
    v_mfma_f32_16x16x32_bf16 v[16:19], v[88:91], v[144:147], 0
    v_mfma_f32_16x16x32_bf16 v[20:23], v[104:107], v[144:147], 0
    v_mfma_f32_16x16x32_bf16 v[24:27], v[136:139], v[144:147], 0
    v_mfma_f32_16x16x32_bf16 v[28:31], v[88:91], v[148:151], 0
    v_mfma_f32_16x16x32_bf16 v[32:35], v[104:107], v[148:151], 0
    v_mfma_f32_16x16x32_bf16 v[36:39], v[136:139], v[148:151], 0
    s_nop 7
    v_cvt_pk_bf16_f32 v212, v16, v17
    v_cvt_pk_bf16_f32 v213, v18, v19
    v_cvt_pk_bf16_f32 v214, v20, v21
    v_cvt_pk_bf16_f32 v215, v22, v23
    v_cvt_pk_bf16_f32 v236, v24, v25
    v_cvt_pk_bf16_f32 v237, v26, v27
    v_cvt_pk_bf16_f32 v216, v28, v29
    v_cvt_pk_bf16_f32 v217, v30, v31
    v_cvt_pk_bf16_f32 v218, v32, v33
    v_cvt_pk_bf16_f32 v219, v34, v35
    v_cvt_pk_bf16_f32 v238, v36, v37
    v_cvt_pk_bf16_f32 v239, v38, v39
    s_nop 2
    v_mfma_f32_16x16x32_bf16 v[16:19], v[92:95], v[144:147], 0
    v_mfma_f32_16x16x32_bf16 v[20:23], v[108:111], v[144:147], 0
    v_mfma_f32_16x16x32_bf16 v[24:27], v[140:143], v[144:147], 0
    v_mfma_f32_16x16x32_bf16 v[28:31], v[92:95], v[148:151], 0
    v_mfma_f32_16x16x32_bf16 v[32:35], v[108:111], v[148:151], 0
    v_mfma_f32_16x16x32_bf16 v[36:39], v[140:143], v[148:151], 0
    s_nop 7
    v_cvt_pk_bf16_f32 v220, v16, v17
    v_cvt_pk_bf16_f32 v221, v18, v19
    v_cvt_pk_bf16_f32 v222, v20, v21
    v_cvt_pk_bf16_f32 v223, v22, v23
    v_cvt_pk_bf16_f32 v240, v24, v25
    v_cvt_pk_bf16_f32 v241, v26, v27
    v_cvt_pk_bf16_f32 v224, v28, v29
    v_cvt_pk_bf16_f32 v225, v30, v31
    v_cvt_pk_bf16_f32 v226, v32, v33
    v_cvt_pk_bf16_f32 v227, v34, v35
    v_cvt_pk_bf16_f32 v242, v36, v37
    v_cvt_pk_bf16_f32 v243, v38, v39
    s_nop 2
    v_mfma_f32_16x16x32_bf16 v[48:51], v[196:199], v[176:179], 0
    v_mfma_f32_16x16x32_bf16 v[52:55], v[200:203], v[176:179], 0
    v_mfma_f32_16x16x32_bf16 v[56:59], v[204:207], v[176:179], 0
    v_mfma_f32_16x16x32_bf16 v[60:63], v[208:211], v[176:179], 0
    v_mfma_f32_16x16x32_bf16 v[64:67], v[212:215], v[176:179], 0
    v_mfma_f32_16x16x32_bf16 v[68:71], v[216:219], v[176:179], 0
    v_mfma_f32_16x16x32_bf16 v[72:75], v[220:223], v[176:179], 0
    v_mfma_f32_16x16x32_bf16 v[76:79], v[224:227], v[176:179], 0
    v_mfma_f32_16x16x16_bf16 v[48:51], v[228:229], v[184:185], v[48:51]
    v_mfma_f32_16x16x16_bf16 v[52:55], v[230:231], v[184:185], v[52:55]
    v_mfma_f32_16x16x16_bf16 v[56:59], v[232:233], v[184:185], v[56:59]
    v_mfma_f32_16x16x16_bf16 v[60:63], v[234:235], v[184:185], v[60:63]
    v_mfma_f32_16x16x16_bf16 v[64:67], v[236:237], v[184:185], v[64:67]
    v_mfma_f32_16x16x16_bf16 v[68:71], v[238:239], v[184:185], v[68:71]
    v_mfma_f32_16x16x16_bf16 v[72:75], v[240:241], v[184:185], v[72:75]
    v_mfma_f32_16x16x16_bf16 v[76:79], v[242:243], v[184:185], v[76:79]
    v_rcp_f32 v244, v188
    s_nop 7
    v_mul_f32 v48, v244, v48
    v_mul_f32 v49, v244, v49
    v_mul_f32 v50, v244, v50
    v_mul_f32 v51, v244, v51
    v_cvt_pk_bf16_f32 v246, v48, v49
    v_cvt_pk_bf16_f32 v247, v50, v51
    buffer_store_dwordx2 v[246:247], v4, s[4:7], s25 offen offset:0 sc1
    v_mul_f32 v52, v244, v52
    v_mul_f32 v53, v244, v53
    v_mul_f32 v54, v244, v54
    v_mul_f32 v55, v244, v55
    v_cvt_pk_bf16_f32 v248, v52, v53
    v_cvt_pk_bf16_f32 v249, v54, v55
    buffer_store_dwordx2 v[248:249], v4, s[4:7], s25 offen offset:512 sc1
    v_mul_f32 v56, v244, v56
    v_mul_f32 v57, v244, v57
    v_mul_f32 v58, v244, v58
    v_mul_f32 v59, v244, v59
    v_cvt_pk_bf16_f32 v246, v56, v57
    v_cvt_pk_bf16_f32 v247, v58, v59
    buffer_store_dwordx2 v[246:247], v4, s[4:7], s25 offen offset:1024 sc1
    v_mul_f32 v60, v244, v60
    v_mul_f32 v61, v244, v61
    v_mul_f32 v62, v244, v62
    v_mul_f32 v63, v244, v63
    v_cvt_pk_bf16_f32 v248, v60, v61
    v_cvt_pk_bf16_f32 v249, v62, v63
    buffer_store_dwordx2 v[248:249], v4, s[4:7], s25 offen offset:1536 sc1
    v_mul_f32 v64, v244, v64
    v_mul_f32 v65, v244, v65
    v_mul_f32 v66, v244, v66
    v_mul_f32 v67, v244, v67
    v_cvt_pk_bf16_f32 v246, v64, v65
    v_cvt_pk_bf16_f32 v247, v66, v67
    buffer_store_dwordx2 v[246:247], v4, s[4:7], s25 offen offset:2048 sc1
    v_mul_f32 v68, v244, v68
    v_mul_f32 v69, v244, v69
    v_mul_f32 v70, v244, v70
    v_mul_f32 v71, v244, v71
    v_cvt_pk_bf16_f32 v248, v68, v69
    v_cvt_pk_bf16_f32 v249, v70, v71
    buffer_store_dwordx2 v[248:249], v4, s[4:7], s25 offen offset:2560 sc1
    v_mul_f32 v72, v244, v72
    v_mul_f32 v73, v244, v73
    v_mul_f32 v74, v244, v74
    v_mul_f32 v75, v244, v75
    v_cvt_pk_bf16_f32 v246, v72, v73
    v_cvt_pk_bf16_f32 v247, v74, v75
    buffer_store_dwordx2 v[246:247], v4, s[4:7], s25 offen offset:3072 sc1
    v_mul_f32 v76, v244, v76
    v_mul_f32 v77, v244, v77
    v_mul_f32 v78, v244, v78
    v_mul_f32 v79, v244, v79
    v_cvt_pk_bf16_f32 v248, v76, v77
    v_cvt_pk_bf16_f32 v249, v78, v79
    buffer_store_dwordx2 v[248:249], v4, s[4:7], s25 offen offset:3584 sc1
    s_add_u32 s26, s25, 4096
    s_nop 3
    v_mfma_f32_16x16x32_bf16 v[48:51], v[196:199], v[180:183], 0
    v_mfma_f32_16x16x32_bf16 v[52:55], v[200:203], v[180:183], 0
    v_mfma_f32_16x16x32_bf16 v[56:59], v[204:207], v[180:183], 0
    v_mfma_f32_16x16x32_bf16 v[60:63], v[208:211], v[180:183], 0
    v_mfma_f32_16x16x32_bf16 v[64:67], v[212:215], v[180:183], 0
    v_mfma_f32_16x16x32_bf16 v[68:71], v[216:219], v[180:183], 0
    v_mfma_f32_16x16x32_bf16 v[72:75], v[220:223], v[180:183], 0
    v_mfma_f32_16x16x32_bf16 v[76:79], v[224:227], v[180:183], 0
    v_mfma_f32_16x16x16_bf16 v[48:51], v[228:229], v[186:187], v[48:51]
    v_mfma_f32_16x16x16_bf16 v[52:55], v[230:231], v[186:187], v[52:55]
    v_mfma_f32_16x16x16_bf16 v[56:59], v[232:233], v[186:187], v[56:59]
    v_mfma_f32_16x16x16_bf16 v[60:63], v[234:235], v[186:187], v[60:63]
    v_mfma_f32_16x16x16_bf16 v[64:67], v[236:237], v[186:187], v[64:67]
    v_mfma_f32_16x16x16_bf16 v[68:71], v[238:239], v[186:187], v[68:71]
    v_mfma_f32_16x16x16_bf16 v[72:75], v[240:241], v[186:187], v[72:75]
    v_mfma_f32_16x16x16_bf16 v[76:79], v[242:243], v[186:187], v[76:79]
    v_rcp_f32 v244, v192
    s_nop 7
    v_mul_f32 v48, v244, v48
    v_mul_f32 v49, v244, v49
    v_mul_f32 v50, v244, v50
    v_mul_f32 v51, v244, v51
    v_cvt_pk_bf16_f32 v246, v48, v49
    v_cvt_pk_bf16_f32 v247, v50, v51
    buffer_store_dwordx2 v[246:247], v4, s[4:7], s26 offen offset:0 sc1
    v_mul_f32 v52, v244, v52
    v_mul_f32 v53, v244, v53
    v_mul_f32 v54, v244, v54
    v_mul_f32 v55, v244, v55
    v_cvt_pk_bf16_f32 v248, v52, v53
    v_cvt_pk_bf16_f32 v249, v54, v55
    buffer_store_dwordx2 v[248:249], v4, s[4:7], s26 offen offset:512 sc1
    v_mul_f32 v56, v244, v56
    v_mul_f32 v57, v244, v57
    v_mul_f32 v58, v244, v58
    v_mul_f32 v59, v244, v59
    v_cvt_pk_bf16_f32 v246, v56, v57
    v_cvt_pk_bf16_f32 v247, v58, v59
    buffer_store_dwordx2 v[246:247], v4, s[4:7], s26 offen offset:1024 sc1
    v_mul_f32 v60, v244, v60
    v_mul_f32 v61, v244, v61
    v_mul_f32 v62, v244, v62
    v_mul_f32 v63, v244, v63
    v_cvt_pk_bf16_f32 v248, v60, v61
    v_cvt_pk_bf16_f32 v249, v62, v63
    buffer_store_dwordx2 v[248:249], v4, s[4:7], s26 offen offset:1536 sc1
    v_mul_f32 v64, v244, v64
    v_mul_f32 v65, v244, v65
    v_mul_f32 v66, v244, v66
    v_mul_f32 v67, v244, v67
    v_cvt_pk_bf16_f32 v246, v64, v65
    v_cvt_pk_bf16_f32 v247, v66, v67
    buffer_store_dwordx2 v[246:247], v4, s[4:7], s26 offen offset:2048 sc1
    v_mul_f32 v68, v244, v68
    v_mul_f32 v69, v244, v69
    v_mul_f32 v70, v244, v70
    v_mul_f32 v71, v244, v71
    v_cvt_pk_bf16_f32 v248, v68, v69
    v_cvt_pk_bf16_f32 v249, v70, v71
    buffer_store_dwordx2 v[248:249], v4, s[4:7], s26 offen offset:2560 sc1
    v_mul_f32 v72, v244, v72
    v_mul_f32 v73, v244, v73
    v_mul_f32 v74, v244, v74
    v_mul_f32 v75, v244, v75
    v_cvt_pk_bf16_f32 v246, v72, v73
    v_cvt_pk_bf16_f32 v247, v74, v75
    buffer_store_dwordx2 v[246:247], v4, s[4:7], s26 offen offset:3072 sc1
    v_mul_f32 v76, v244, v76
    v_mul_f32 v77, v244, v77
    v_mul_f32 v78, v244, v78
    v_mul_f32 v79, v244, v79
    v_cvt_pk_bf16_f32 v248, v76, v77
    v_cvt_pk_bf16_f32 v249, v78, v79
    buffer_store_dwordx2 v[248:249], v4, s[4:7], s26 offen offset:3584 sc1
    s_waitcnt vmcnt(0)
    s_barrier
    s_cmp_lg_u32 s8, 0
    s_cbranch_scc1 CH_sig167
    v_mov_b32 v2, s44
    v_mov_b32 v3, 1
    s_mov_b64 exec, 1
    buffer_atomic_add v3, v2, s[4:7], 0 offen sc1
    s_mov_b64 exec, -1
CH_sig167:
    s_branch CH_wtop86
CH_end:
    s_endpgm
CH_codeend:

.section .rodata,"a"
.p2align 6
.amdhsa_kernel concat_heads__ssm_conv_s4__memory_aug_recurrent_mem_tr__prompt_kernel
  .amdhsa_next_free_vgpr 512
  .amdhsa_next_free_sgpr 102
  .amdhsa_accum_offset 256
  .amdhsa_group_segment_fixed_size 0
  .amdhsa_kernarg_size 152
  .amdhsa_user_sgpr_count 2
  .amdhsa_user_sgpr_kernarg_segment_ptr 1
  .amdhsa_system_sgpr_workgroup_id_x 1
.end_amdhsa_kernel
```
